```python
import torch

def _softmax(x, axis=-1):
    return torch.softmax(x, dim=axis)
def _gelu(x):
    return torch.nn.functional.gelu(x, approximate="tanh")
def _silu(x):
    return torch.nn.functional.silu(x)
def _sigmoid(x):
    return torch.sigmoid(x)
def _layernorm(x, axis=-1, eps=1e-5):
    m = x.mean(dim=axis, keepdim=True)
    v = x.var(dim=axis, keepdim=True, unbiased=False)
    return (x - m) / torch.sqrt(v + eps)
def _scatter_add(tgt, idx, src, axis=0):
    return tgt.clone().index_add_(axis, idx, src)
def _segment_sum(src, seg, n):
    out = torch.zeros((n,) + src.shape[1:], dtype=src.dtype)
    return out.index_add_(0, seg, src)
def _pad(x, pw):
    flat = tuple(v for pair in reversed(pw) for v in pair)
    return torch.nn.functional.pad(x, flat)

kernel_name = 'gated_mix__sliding_block__swiglu_ffn__prompt'

def setup_inputs():

    _w = (lambda a: (lambda t: t.to(torch.bfloat16) if t.is_floating_point() else t)(torch.as_tensor(a)))
    def _A_setup():
        B, S, D = 1, 2048, 512
        return {
            "x": _w((lambda *s: torch.randn(*s, dtype=torch.bfloat16) * 0.05)(B, S, D)),
            "wqkv": _w((lambda *s: torch.randn(*s, dtype=torch.bfloat16) * 0.8)(D, 3 * D)),
            "wo": _w((lambda *s: torch.randn(*s, dtype=torch.bfloat16) * 0.05)(D, D)),
        }
    _A_in = _A_setup()

    def _B_setup():
        B, S, D, F = 1, 2048, 512, 1376
        return {
            "x": _w((lambda *s: torch.randn(*s, dtype=torch.bfloat16) * 0.05)(B, S, D)),
            "w_gate": _w((lambda *s: torch.randn(*s, dtype=torch.bfloat16) * 0.2)(D, F)),
            "w_up": _w((lambda *s: torch.randn(*s, dtype=torch.bfloat16) * 0.2)(D, F)),
            "w_down": _w((lambda *s: torch.randn(*s, dtype=torch.bfloat16) * 0.2)(F, D)),
        }
    _B_in = _B_setup()

    return {
        "A_x": _A_in["x"],
        "A_wqkv": _A_in["wqkv"],
        "A_wo": _A_in["wo"],
        "B_x": _B_in["x"],
        "B_w_gate": _B_in["w_gate"],
        "B_w_up": _B_in["w_up"],
        "B_w_down": _B_in["w_down"],
        "gate_w": _w((lambda *s: torch.randn(*s, dtype=torch.bfloat16) * 0.05)(512) * 16.0),
    }

def reference(A_x, A_wqkv, A_wo, B_x, B_w_gate, B_w_up, B_w_down, gate_w):
    def _A_ref(x, wqkv, wo):
        B, S, D = x.shape
        H = 32; Dh = D // H; W = 256
        qkv = (lambda x, *d: x.permute(*d))((x @ wqkv).reshape(B, S, 3, H, Dh), 2, 0, 3, 1, 4)
        q, k, v = qkv[0], qkv[1], qkv[2]
        scores = torch.einsum("bhqd,bhkd->bhqk", q, k) * (Dh ** -0.5)
        idx = torch.arange(S)
        mask = (idx[:, None] - idx[None, :] >= 0) & (idx[:, None] - idx[None, :] < W)
        scores = torch.where(mask[None, None], scores, -1e9)
        p = _softmax(scores, axis=-1)
        o = torch.einsum("bhqk,bhkd->bhqd", p, v)
        return (lambda x, *d: x.permute(*d))(o, 0, 2, 1, 3).reshape(B, S, D) @ wo

    def _B_ref(x, w_gate, w_up, w_down):
        g = _silu(x @ w_gate)
        u = x @ w_up
        return (g * u) @ w_down

    x = A_x
    g = _sigmoid((x * gate_w).sum(-1, keepdims=True))
    a = _A_ref(x, A_wqkv, A_wo)
    b = _B_ref(x, B_w_gate, B_w_up, B_w_down)
    return g * a + (1 - g) * b
```

```asm
; @launch grid=(256,1,1) block=(512,1,1) lds=162560
.amdgcn_target "amdgcn-amd-amdhsa--gfx950"
.text
.p2align 12
.globl gated_mix__sliding_block__swiglu_ffn__prompt_kernel
.p2align 8
.type gated_mix__sliding_block__swiglu_ffn__prompt_kernel,@function
gated_mix__sliding_block__swiglu_ffn__prompt_kernel:
  s_getpc_b64 s[66:67]
  v_lshrrev_b32 v1, 6, v0
  s_load_dwordx2 s[8:9], s[0:1], 0
  s_load_dwordx2 s[12:13], s[0:1], 8
  s_load_dwordx2 s[36:37], s[0:1], 56
  v_readfirstlane_b32 s44, v1
  s_lshr_b32 s3, s2, 8
  s_cbranch_scc1 END
  s_cmp_ge_u32 s44, 4
  s_cbranch_scc1 G_STUB
  s_mov_b32 s11, 0x20000
  s_mov_b32 s15, s11
  s_mov_b32 s39, s11
  s_lshl_b32 s10, s11, 4
  s_mul_i32 s14, s11, 12
  s_movk_i32 s38, 1024
  s_bfe_u32 s46, s2, 0x10002
  s_lshl_b32 s46, s46, 3
  s_bfe_u32 s50, s2, 0x30003
  s_add_u32 s46, s46, s50
  s_and_b32 s47, s2, 3
  s_lshl_b32 s47, s47, 2
  s_lshr_b32 s50, s2, 6
  s_add_u32 s47, s47, s50
  s_add_u32 s49, s50, s46
  s_lshl_b32 s49, s49, 2
  s_lshr_b32 s50, s47, 2
  s_add_u32 s49, s49, s50
  s_lshr_b32 s50, s46, 3
  s_lshl_b32 s50, s50, 1
  s_add_u32 s49, s49, s50
  s_and_b32 s45, s44, 3
  v_and_b32_e64 v1, 63, v0
  v_lshrrev_b32_e64 v3, 3, v1
  v_lshrrev_b32_e64 v4, 4, v1
  v_and_b32_e64 v228, 7, v1
  v_xor_b32 v228, v228, v4
  v_lshlrev_b32 v228, 4, v228
  v_lshl_add_u32 v228, v3, 10, v228
  v_xor_b32_e64 v229, 64, v228
  v_add_u32 v229, 7168, v229
  v_lshrrev_b32 v3, 2, v1
  v_and_b32 v4, 3, v1
  v_lshrrev_b32 v230, 4, v1
  v_and_b32 v230, 2, v230
  v_xor_b32_e64 v4, v4, v230
  v_mul_u32_u24 v230, 3072, v3
  v_lshl_add_u32 v230, v4, 4, v230
  s_lshl_b32 s55, s46, 2
  s_add_u32 s55, s55, s45
  s_lshl_b32 s55, s55, 15
  s_lshl_b32 s50, s45, 8
  s_add_u32 s50, s50, s47
  s_mul_i32 s56, s50, 192
  s_lshl_b32 s58, s45, 12
  s_mul_i32 s59, s45, 3072
  s_mov_b32 s64, 0
A_L1:
  s_add_u32 s60, s49, s64
  s_and_b32 s60, s60, 7
  s_and_b32 s65, s64, 3
  s_mul_i32 s65, s65, 28672
  s_add_u32 m0, s58, s65
  s_lshl_b32 s50, s60, 7
  s_add_u32 s50, s50, s55
  s_waitcnt lgkmcnt(0)
  buffer_load_dwordx4 v228, s[8:11], s50 offen lds
  buffer_load_dwordx4 v229, s[8:11], s50 offen offset:1024 lds
  s_add_u32 s50, s50, 14336
  buffer_load_dwordx4 v228, s[8:11], s50 offen offset:2048 lds
  buffer_load_dwordx4 v229, s[8:11], s50 offen offset:3072 lds
  s_add_u32 s52, s65, s59
  s_mul_i32 s51, s60, 196608
  s_add_u32 m0, s52, 16384
  s_add_u32 s51, s51, s56
  buffer_load_dwordx4 v230, s[12:15], s51 offen offset:0 lds
  s_add_u32 m0, s52, 17344
  s_nop 0
  buffer_load_dwordx4 v230, s[12:15], s51 offen offset:64 lds
  s_add_u32 m0, s52, 18304
  s_nop 0
  buffer_load_dwordx4 v230, s[12:15], s51 offen offset:128 lds
  s_add_u32 s64, s64, 1
  s_cmp_eq_u32 s64, 1
  s_cbranch_scc1 A_FIRST
  s_waitcnt vmcnt(7)
  s_barrier
  s_cmp_lt_u32 s64, 7
  s_cbranch_scc1 A_L1
  s_branch A_P2
A_FIRST:
  v_lshlrev_b32_e64 v0, 4, v1
  s_lshl_b32 s50, s45, 4
  s_add_u32 s50, s50, s47
  s_cmp_lg_u32 s50, 10
  s_cbranch_scc1 A_L1
  s_mov_b32 m0, 159744
  v_lshlrev_b32_e64 v0, 4, v1
  buffer_load_dwordx4 v0, s[36:39], 0 offen lds
  s_branch A_L1
G_STUB:
  s_lshr_b32 s50, s2, 3
  s_lshl_b32 s50, s50, 7
  s_and_b32 s51, s44, 3
  s_lshl_b32 s51, s51, 14
  s_add_u32 s50, s50, s51
  v_and_b32_e64 v12, 3, v0
  v_lshl_add_u32 v12, v12, 12, s50
  s_mov_b64 exec, 15
  global_load_dword v97, v12, s[66:67]
  s_mov_b64 exec, -1
  v_mov_b64 v[16:17], 0
  v_mov_b64 v[18:19], 0
  v_and_b32 v13, 63, v0
  v_lshlrev_b32 v13, 4, v13
  v_add_u32 v13, 160768, v13
  ds_write_b128 v13, v[16:19] offset:768
  s_and_b32 s47, s2, 3
  s_lshl_b32 s47, s47, 2
  s_lshr_b32 s50, s2, 6
  s_add_u32 s47, s47, s50
  s_cmp_eq_u32 s47, 10
  s_cbranch_scc1 G_V1
  s_cmp_gt_u32 s47, 10
  s_cbranch_scc1 G_V2
  s_branch G_V0
.fill 4, 4, 0xBF800000
A_P2:
  s_add_u32 s60, s49, s64
  s_and_b32 s60, s60, 7
  s_and_b32 s65, s64, 3
  s_mul_i32 s65, s65, 28672
  s_add_u32 m0, s58, s65
  s_lshl_b32 s50, s60, 7
  s_add_u32 s50, s50, s55
  s_waitcnt lgkmcnt(0)
  buffer_load_dwordx4 v228, s[8:11], s50 offen lds
  buffer_load_dwordx4 v229, s[8:11], s50 offen offset:1024 lds
  s_add_u32 s50, s50, 14336
  buffer_load_dwordx4 v228, s[8:11], s50 offen offset:2048 lds
  buffer_load_dwordx4 v229, s[8:11], s50 offen offset:3072 lds
  s_add_u32 s52, s65, s59
  s_mul_i32 s51, s60, 196608
  s_add_u32 m0, s52, 16384
  s_add_u32 s51, s51, s56
  buffer_load_dwordx4 v230, s[12:15], s51 offen offset:0 lds
  s_add_u32 m0, s52, 17344
  s_nop 0
  buffer_load_dwordx4 v230, s[12:15], s51 offen offset:64 lds
  s_add_u32 m0, s52, 18304
  s_nop 0
  buffer_load_dwordx4 v230, s[12:15], s51 offen offset:128 lds
  s_load_dwordx2 s[4:5], s[0:1], 80
  s_load_dwordx2 s[40:41], s[0:1], 72
  s_load_dwordx2 s[16:17], s[0:1], 32
  s_load_dwordx2 s[20:21], s[0:1], 40
  s_load_dwordx2 s[24:25], s[0:1], 48
  s_load_dwordx2 s[28:29], s[0:1], 16
  s_load_dwordx2 s[32:33], s[0:1], 64
  s_mov_b32 s6, 0x1000000
  s_mov_b32 s7, 0x20000
  s_mov_b32 s42, 0x100
  s_mov_b32 s43, 0x20000
  s_mov_b32 s18, 0x158000
  s_mov_b32 s19, 0x20000
  s_mov_b32 s22, 0x158000
  s_mov_b32 s23, 0x20000
  s_mov_b32 s26, 0x158000
  s_mov_b32 s27, 0x20000
  s_mov_b32 s30, 0x80000
  s_mov_b32 s31, 0x20000
  s_mov_b32 s34, 0x200000
  s_mov_b32 s35, 0x20000
  s_movk_i32 s50, 0x4924
  s_bitcmp1_b32 s50, s47
  s_cselect_b32 s63, 0x40000000, 0
  s_bfm_b32 s3, s47, 0
  s_and_b32 s3, s3, s50
  s_bcnt1_i32_b32 s3, s3
  s_mul_i32 s48, s47, 3
  s_sub_u32 s48, s48, s3
  s_and_b32 s53, s2, 7
  s_lshl_b32 s53, s53, 2
  s_bfe_u32 s50, s2, 0x20003
  s_add_u32 s53, s53, s50
  s_lshr_b32 s54, s2, 5
  s_lshl_b32 s98, s45, 10
  s_lshl_b32 s99, s45, 14
  s_lshl_b32 s50, s54, 7
  s_add_u32 s99, s99, s50
  s_lshl_b32 s101, s53, 1
  s_add_u32 s101, s101, s54
  s_and_b32 s101, s101, 7
  s_mul_i32 s62, s101, 21
  s_lshr_b32 s62, s62, 3
  s_lshl_b32 s62, s62, 16
  s_lshl_b32 s101, s101, 16
  v_mul_u32_u24 v231, 2752, v3
  v_lshl_add_u32 v231, v4, 4, v231
  v_add_u32 v233, s63, v231
  s_mul_i32 s57, s45, 44032
  s_lshl_b32 s50, s48, 6
  s_add_u32 s57, s57, s50
  s_waitcnt lgkmcnt(0)
  s_waitcnt vmcnt(7)
  s_barrier
  s_lshl_b32 s59, s59, 1
  s_cmp_eq_u32 s63, 0
  s_cselect_b64 s[0:1], -1, 0
  v_and_b32 v7, 15, v1
  v_lshlrev_b32 v7, 2, v7
  buffer_load_dword v10, v7, s[40:43], 0 offen sc1
  s_add_u32 s60, s49, 0
  s_and_b32 s60, s60, 7
  s_mul_i32 s51, s60, 176128
  s_add_u32 s51, s51, s57
  s_add_u32 m0, s59, 0
  s_nop 0
  buffer_load_dwordx4 v231, s[16:19], s51 offen offset:0 lds
  s_add_u32 m0, s59, 960
  s_nop 0
  buffer_load_dwordx4 v231, s[16:19], s51 offen offset:64 lds
  s_add_u32 m0, s59, 1920
  s_mov_b64 exec, s[0:1]
  buffer_load_dwordx4 v233, s[16:19], s51 offen offset:128 lds
  s_mov_b64 exec, -1
  s_add_u32 m0, s59, 3072
  s_nop 0
  buffer_load_dwordx4 v231, s[20:23], s51 offen offset:0 lds
  s_add_u32 m0, s59, 4032
  s_nop 0
  buffer_load_dwordx4 v231, s[20:23], s51 offen offset:64 lds
  s_add_u32 m0, s59, 4992
  s_mov_b64 exec, s[0:1]
  buffer_load_dwordx4 v233, s[20:23], s51 offen offset:128 lds
  s_mov_b64 exec, -1
  v_bfe_u32 v5, v1, 4, 1
  v_lshlrev_b32 v5, 2, v5
  v_and_b32 v6, 7, v1
  v_xor_b32 v5, v5, v6
  v_lshlrev_b32 v5, 4, v5
  v_lshrrev_b32_e64 v6, 3, v1
  v_lshl_add_u32 v244, v6, 10, v5
  v_add_u32_e64 v244, s99, v244
  v_add_u32 v245, 8192, v244
  v_lshrrev_b32_e64 v6, 5, v1
  v_lshl_add_u32 v254, v6, 12, v244
  v_add_u32 v255, 4096, v254
  s_and_b32 s50, s46, 1
  s_lshl_b32 s100, s47, 1
  s_add_u32 s100, s100, s50
  s_and_b32 s61, s46, 14
  s_lshl_b32 s61, s61, 1
  s_add_u32 s61, s61, s45
  s_lshl_b32 s61, s61, 1
  v_mov_b32 v247, 162304
  v_mov_b32 v248, 1
  s_waitcnt vmcnt(7)
  s_barrier
  s_add_u32 s60, s49, 1
  s_and_b32 s60, s60, 7
  s_mul_i32 s51, s60, 176128
  s_add_u32 s51, s51, s57
  s_add_u32 m0, s59, 28672
  s_nop 0
  buffer_load_dwordx4 v231, s[16:19], s51 offen offset:0 lds
  s_add_u32 m0, s59, 29632
  s_nop 0
  buffer_load_dwordx4 v231, s[16:19], s51 offen offset:64 lds
  s_add_u32 m0, s59, 30592
  s_mov_b64 exec, s[0:1]
  buffer_load_dwordx4 v233, s[16:19], s51 offen offset:128 lds
  s_mov_b64 exec, -1
  s_add_u32 m0, s59, 31744
  s_nop 0
  buffer_load_dwordx4 v231, s[20:23], s51 offen offset:0 lds
  s_add_u32 m0, s59, 32704
  s_nop 0
  buffer_load_dwordx4 v231, s[20:23], s51 offen offset:64 lds
  s_add_u32 m0, s59, 33664
  s_mov_b64 exec, s[0:1]
  buffer_load_dwordx4 v233, s[20:23], s51 offen offset:128 lds
  s_mov_b64 exec, -1
  s_add_u32 m0, s98, 114688
  s_add_u32 s51, s62, 0
  s_add_u32 s52, s62, 0xffeb0000
  s_min_u32 s51, s51, s52
  buffer_load_dwordx4 v254, s[24:27], s51 offen lds
  s_add_u32 m0, s98, 118784
  s_nop 0
  buffer_load_dwordx4 v255, s[24:27], s51 offen lds
  s_waitcnt vmcnt(8)
  v_cmp_ne_u32 vcc, 1, v10
  s_cbranch_vccz PL1_D
  s_mov_b32 s52, 200000
PL1:
  buffer_load_dword v10, v7, s[40:43], 0 offen sc1
  s_waitcnt vmcnt(0)
  v_cmp_ne_u32 vcc, 1, v10
  s_cbranch_vccz PL1_D
  s_sleep 2
  s_sub_u32 s52, s52, 1
  s_cmp_lg_u32 s52, 0
  s_cbranch_scc1 PL1
PL1_D:
  s_barrier
  s_add_u32 s60, s49, 2
  s_and_b32 s60, s60, 7
  s_mul_i32 s51, s60, 176128
  s_add_u32 s51, s51, s57
  s_add_u32 m0, s59, 57344
  s_nop 0
  buffer_load_dwordx4 v231, s[16:19], s51 offen offset:0 lds
  s_add_u32 m0, s59, 58304
  s_nop 0
  buffer_load_dwordx4 v231, s[16:19], s51 offen offset:64 lds
  s_add_u32 m0, s59, 59264
  s_mov_b64 exec, s[0:1]
  buffer_load_dwordx4 v233, s[16:19], s51 offen offset:128 lds
  s_mov_b64 exec, -1
  s_add_u32 m0, s59, 60416
  s_nop 0
  buffer_load_dwordx4 v231, s[20:23], s51 offen offset:0 lds
  s_add_u32 m0, s59, 61376
  s_nop 0
  buffer_load_dwordx4 v231, s[20:23], s51 offen offset:64 lds
  s_add_u32 m0, s59, 62336
  s_mov_b64 exec, s[0:1]
  buffer_load_dwordx4 v233, s[20:23], s51 offen offset:128 lds
  s_mov_b64 exec, -1
  s_add_u32 m0, s98, 122880
  s_add_u32 s51, s62, 65536
  s_add_u32 s52, s62, 0xffec0000
  s_min_u32 s51, s51, s52
  buffer_load_dwordx4 v254, s[24:27], s51 offen lds
  s_add_u32 m0, s98, 126976
  s_nop 0
  buffer_load_dwordx4 v255, s[24:27], s51 offen lds
  v_mov_b32 v8, 0x3f803f80
  v_mov_b32 v9, 0x3f803f80
  v_mov_b64 v[68:69], v[8:9]
  v_mov_b64 v[70:71], v[8:9]
  v_mov_b64 v[72:73], v[8:9]
  v_mov_b64 v[74:75], v[8:9]
  v_mov_b64 v[76:77], v[8:9]
  v_mov_b64 v[78:79], v[8:9]
  v_mov_b64 v[80:81], v[8:9]
  v_mov_b64 v[82:83], v[8:9]
  v_mov_b64 v[84:85], v[8:9]
  v_mov_b64 v[86:87], v[8:9]
  v_mov_b64 v[88:89], v[8:9]
  v_mov_b64 v[90:91], v[8:9]
  v_mov_b64 v[92:93], v[8:9]
  v_mov_b64 v[94:95], v[8:9]
  v_mov_b64 v[96:97], v[8:9]
  v_mov_b64 v[98:99], v[8:9]
  v_mov_b64 v[100:101], v[8:9]
  v_mov_b64 v[102:103], v[8:9]
  v_mov_b64 v[104:105], v[8:9]
  v_mov_b64 v[106:107], v[8:9]
  v_mov_b64 v[108:109], v[8:9]
  v_mov_b64 v[110:111], v[8:9]
  v_mov_b64 v[112:113], v[8:9]
  v_mov_b64 v[114:115], v[8:9]
  v_mov_b64 v[116:117], v[8:9]
  v_mov_b64 v[118:119], v[8:9]
  v_mov_b64 v[120:121], v[8:9]
  v_mov_b64 v[122:123], v[8:9]
  v_mov_b64 v[124:125], v[8:9]
  v_mov_b64 v[126:127], v[8:9]
  v_mov_b64 v[128:129], v[8:9]
  v_mov_b64 v[130:131], v[8:9]
  v_mov_b64 v[132:133], v[8:9]
  v_mov_b64 v[134:135], v[8:9]
  v_mov_b64 v[136:137], v[8:9]
  v_mov_b64 v[138:139], v[8:9]
  v_mov_b64 v[140:141], v[8:9]
  v_mov_b64 v[142:143], v[8:9]
  v_mov_b64 v[144:145], v[8:9]
  v_mov_b64 v[146:147], v[8:9]
  s_waitcnt vmcnt(10)
  s_barrier
  s_add_u32 s60, s49, 3
  s_and_b32 s60, s60, 7
  s_mul_i32 s51, s60, 176128
  s_add_u32 s51, s51, s57
  s_add_u32 m0, s59, 86016
  s_nop 0
  buffer_load_dwordx4 v231, s[16:19], s51 offen offset:0 lds
  s_add_u32 m0, s59, 86976
  s_nop 0
  buffer_load_dwordx4 v231, s[16:19], s51 offen offset:64 lds
  s_add_u32 m0, s59, 87936
  s_mov_b64 exec, s[0:1]
  buffer_load_dwordx4 v233, s[16:19], s51 offen offset:128 lds
  s_mov_b64 exec, -1
  s_add_u32 m0, s59, 89088
  s_nop 0
  buffer_load_dwordx4 v231, s[20:23], s51 offen offset:0 lds
  s_add_u32 m0, s59, 90048
  s_nop 0
  buffer_load_dwordx4 v231, s[20:23], s51 offen offset:64 lds
  s_add_u32 m0, s59, 91008
  s_mov_b64 exec, s[0:1]
  buffer_load_dwordx4 v233, s[20:23], s51 offen offset:128 lds
  s_mov_b64 exec, -1
  v_and_b32 v3, 31, v1
  v_lshrrev_b32_e64 v4, 5, v1
  v_lshlrev_b32 v4, 3, v4
  v_sub_u32 v3, v3, v4
  v_cmp_le_i32 s[64:65], 0, v3
  v_cmp_le_i32 s[66:67], 1, v3
  v_cmp_le_i32 s[68:69], 2, v3
  v_cmp_le_i32 s[70:71], 3, v3
  v_cmp_le_i32 s[72:73], 4, v3
  v_cmp_le_i32 s[74:75], 5, v3
  v_cmp_le_i32 s[76:77], 6, v3
  v_cmp_le_i32 s[78:79], 7, v3
  v_cmp_le_i32 s[80:81], 16, v3
  v_cmp_le_i32 s[82:83], 17, v3
  v_cmp_le_i32 s[84:85], 18, v3
  v_cmp_le_i32 s[86:87], 19, v3
  v_cmp_le_i32 s[88:89], 20, v3
  v_cmp_le_i32 s[90:91], 21, v3
  v_cmp_le_i32 s[92:93], 22, v3
  v_cmp_le_i32 s[94:95], 23, v3
  v_mov_b32 v7, 0xffff
  v_mov_b32 v5, 0xffff0000
  v_cndmask_b32 v12, 0, v7, s[64:65]
  v_cndmask_b32 v4, 0, v5, s[66:67]
  v_or_b32_e64 v12, v12, v4
  v_cndmask_b32 v13, 0, v7, s[68:69]
  v_cndmask_b32 v4, 0, v5, s[70:71]
  v_or_b32_e64 v13, v13, v4
  v_cndmask_b32 v14, 0, v7, s[72:73]
  v_cndmask_b32 v4, 0, v5, s[74:75]
  v_or_b32_e64 v14, v14, v4
  v_cndmask_b32 v15, 0, v7, s[76:77]
  v_cndmask_b32 v4, 0, v5, s[78:79]
  v_or_b32_e64 v15, v15, v4
  v_cndmask_b32 v16, 0, v7, s[80:81]
  v_cndmask_b32 v4, 0, v5, s[82:83]
  v_or_b32_e64 v16, v16, v4
  v_cndmask_b32 v17, 0, v7, s[84:85]
  v_cndmask_b32 v4, 0, v5, s[86:87]
  v_or_b32_e64 v17, v17, v4
  v_cndmask_b32 v18, 0, v7, s[88:89]
  v_cndmask_b32 v4, 0, v5, s[90:91]
  v_or_b32_e64 v18, v18, v4
  v_cndmask_b32 v19, 0, v7, s[92:93]
  v_cndmask_b32 v4, 0, v5, s[94:95]
  v_or_b32_e64 v19, v19, v4
  v_mov_b32 v7, 0xf149f2ca
  v_mov_b32 v246, 0x5d800000
  v_and_b32_e64 v2, 51, v1
  v_bfe_u32 v4, v1, 2, 1
  v_lshl_or_b32 v2, v4, 3, v2
  v_bfe_u32 v4, v1, 3, 1
  v_lshl_or_b32 v2, v4, 2, v2
  v_lshlrev_b32_e64 v2, 4, v2
  s_waitcnt vmcnt(8)
  s_barrier
  s_add_u32 s60, s49, 4
  s_and_b32 s60, s60, 7
  s_mul_i32 s51, s60, 176128
  s_add_u32 s51, s51, s57
  s_add_u32 m0, s59, 0
  s_nop 0
  buffer_load_dwordx4 v231, s[16:19], s51 offen offset:0 lds
  s_add_u32 m0, s59, 960
  s_nop 0
  buffer_load_dwordx4 v231, s[16:19], s51 offen offset:64 lds
  s_add_u32 m0, s59, 1920
  s_mov_b64 exec, s[0:1]
  buffer_load_dwordx4 v233, s[16:19], s51 offen offset:128 lds
  s_mov_b64 exec, -1
  s_add_u32 m0, s59, 3072
  s_nop 0
  buffer_load_dwordx4 v231, s[20:23], s51 offen offset:0 lds
  s_add_u32 m0, s59, 4032
  s_nop 0
  buffer_load_dwordx4 v231, s[20:23], s51 offen offset:64 lds
  s_add_u32 m0, s59, 4992
  s_mov_b64 exec, s[0:1]
  buffer_load_dwordx4 v233, s[20:23], s51 offen offset:128 lds
  s_mov_b64 exec, -1
  s_add_u32 m0, s98, 131072
  s_add_u32 s51, s62, 131072
  s_add_u32 s52, s62, 0xffed0000
  s_min_u32 s51, s51, s52
  buffer_load_dwordx4 v254, s[24:27], s51 offen lds
  s_add_u32 m0, s98, 135168
  s_nop 0
  buffer_load_dwordx4 v255, s[24:27], s51 offen lds
  v_and_b32 v3, 3, v1
  s_lshl_b32 s50, s45, 1
  s_sub_u32 s50, s50, 8
  v_add_u32 v3, s50, v3
  v_and_b32 v4, 1, v1
  v_cmp_le_u32 vcc, 32, v1
  s_nop 1
  v_cndmask_b32 v3, v3, v4, vcc
  v_add_u32 v3, s61, v3
  v_max_i32 v3, 0, v3
  v_add_u32 v4, 16, v1
  v_and_b32 v4, 48, v4
  v_cndmask_b32 v4, v4, 0, vcc
  v_add_u32 v4, s47, v4
  v_mul_u32_u24 v4, 43, v4
  v_lshrrev_b32_e64 v4, 7, v4
  v_cmp_le_u32 vcc, 48, v1
  s_nop 1
  v_cndmask_b32 v4, v4, 10, vcc
  v_lshrrev_b32_e64 v5, 2, v3
  v_lshl_add_u32 v4, v5, 4, v4
  v_lshlrev_b32 v4, 7, v4
  v_and_b32 v3, 3, v3
  v_lshl_add_u32 v6, v3, 2, v4
  s_lshl_b32 s55, s100, 16
  s_add_u32 s56, s55, 4194304
  s_mov_b32 s58, 14680064
  s_waitcnt vmcnt(8)
  s_barrier
  s_add_u32 s60, s49, 5
  s_and_b32 s60, s60, 7
  s_mul_i32 s51, s60, 176128
  s_add_u32 s51, s51, s57
  s_add_u32 m0, s59, 28672
  s_nop 0
  buffer_load_dwordx4 v231, s[16:19], s51 offen offset:0 lds
  s_add_u32 m0, s59, 29632
  s_nop 0
  buffer_load_dwordx4 v231, s[16:19], s51 offen offset:64 lds
  s_add_u32 m0, s59, 30592
  s_mov_b64 exec, s[0:1]
  buffer_load_dwordx4 v233, s[16:19], s51 offen offset:128 lds
  s_mov_b64 exec, -1
  s_add_u32 m0, s59, 31744
  s_nop 0
  buffer_load_dwordx4 v231, s[20:23], s51 offen offset:0 lds
  s_add_u32 m0, s59, 32704
  s_nop 0
  buffer_load_dwordx4 v231, s[20:23], s51 offen offset:64 lds
  s_add_u32 m0, s59, 33664
  s_mov_b64 exec, s[0:1]
  buffer_load_dwordx4 v233, s[20:23], s51 offen offset:128 lds
  s_mov_b64 exec, -1
  s_add_u32 m0, s98, 139264
  s_add_u32 s51, s62, 196608
  s_add_u32 s52, s62, 0xffee0000
  s_min_u32 s51, s51, s52
  buffer_load_dwordx4 v254, s[24:27], s51 offen lds
  s_add_u32 m0, s98, 143360
  s_nop 0
  buffer_load_dwordx4 v255, s[24:27], s51 offen lds
  s_add_u32 m0, s98, 147456
  s_add_u32 s51, s62, 262144
  s_add_u32 s52, s62, 0xffef0000
  s_min_u32 s51, s51, s52
  buffer_load_dwordx4 v254, s[24:27], s51 offen lds
  s_add_u32 m0, s98, 151552
  s_nop 0
  buffer_load_dwordx4 v255, s[24:27], s51 offen lds
  s_waitcnt vmcnt(12)
  s_barrier
  s_add_u32 s60, s49, 6
  s_and_b32 s60, s60, 7
  s_mul_i32 s51, s60, 176128
  s_add_u32 s51, s51, s57
  s_add_u32 m0, s59, 57344
  s_nop 0
  buffer_load_dwordx4 v231, s[16:19], s51 offen offset:0 lds
  s_add_u32 m0, s59, 58304
  s_nop 0
  buffer_load_dwordx4 v231, s[16:19], s51 offen offset:64 lds
  s_add_u32 m0, s59, 59264
  s_mov_b64 exec, s[0:1]
  buffer_load_dwordx4 v233, s[16:19], s51 offen offset:128 lds
  s_mov_b64 exec, -1
  s_add_u32 m0, s59, 60416
  s_nop 0
  buffer_load_dwordx4 v231, s[20:23], s51 offen offset:0 lds
  s_add_u32 m0, s59, 61376
  s_nop 0
  buffer_load_dwordx4 v231, s[20:23], s51 offen offset:64 lds
  s_add_u32 m0, s59, 62336
  s_mov_b64 exec, s[0:1]
  buffer_load_dwordx4 v233, s[20:23], s51 offen offset:128 lds
  s_mov_b64 exec, -1
  s_add_u32 m0, s98, 155648
  s_add_u32 s51, s101, 0
  s_and_b32 s51, s51, 458752
  buffer_load_dwordx4 v244, s[28:31], s51 offen lds
  s_add_u32 m0, s98, 24576
  s_nop 0
  buffer_load_dwordx4 v245, s[28:31], s51 offen lds
  s_add_u32 m0, s98, 53248
  s_add_u32 s51, s101, 65536
  s_and_b32 s51, s51, 458752
  buffer_load_dwordx4 v244, s[28:31], s51 offen lds
  s_add_u32 m0, s98, 81920
  s_nop 0
  buffer_load_dwordx4 v245, s[28:31], s51 offen lds
  s_waitcnt vmcnt(14)
  s_barrier
  s_waitcnt vmcnt(4)
  s_mov_b64 exec, 1
  ds_add_u32 v247, v248 offset:4
  s_mov_b64 exec, -1
  s_add_u32 s60, s49, 7
  s_and_b32 s60, s60, 7
  s_mul_i32 s51, s60, 176128
  s_add_u32 s51, s51, s57
  s_add_u32 m0, s59, 86016
  s_nop 0
  buffer_load_dwordx4 v231, s[16:19], s51 offen offset:0 lds
  s_add_u32 m0, s59, 86976
  s_nop 0
  buffer_load_dwordx4 v231, s[16:19], s51 offen offset:64 lds
  s_add_u32 m0, s59, 87936
  s_mov_b64 exec, s[0:1]
  buffer_load_dwordx4 v233, s[16:19], s51 offen offset:128 lds
  s_mov_b64 exec, -1
  s_add_u32 m0, s59, 89088
  s_nop 0
  buffer_load_dwordx4 v231, s[20:23], s51 offen offset:0 lds
  s_add_u32 m0, s59, 90048
  s_nop 0
  buffer_load_dwordx4 v231, s[20:23], s51 offen offset:64 lds
  s_add_u32 m0, s59, 91008
  s_mov_b64 exec, s[0:1]
  buffer_load_dwordx4 v233, s[20:23], s51 offen offset:128 lds
  s_mov_b64 exec, -1
  buffer_load_dword v10, v6, s[4:7], s58 offen sc1
  s_waitcnt vmcnt(1)
  s_mov_b64 exec, 1
  ds_add_u32 v247, v248 offset:36
  s_mov_b64 exec, -1
  s_waitcnt vmcnt(1)
  s_mov_b64 exec, 1
  ds_add_u32 v247, v248 offset:12
  s_mov_b64 exec, -1
  s_waitcnt vmcnt(0)
  v_cmp_ne_u32 vcc, 1, v10
  s_cbranch_vccz PL2_D
  s_mov_b32 s52, 200000
PL2:
  buffer_load_dword v10, v6, s[4:7], s58 offen sc1
  s_waitcnt vmcnt(0)
  v_cmp_ne_u32 vcc, 1, v10
  s_cbranch_vccz PL2_D
  s_sleep 2
  s_sub_u32 s52, s52, 1
  s_cmp_lg_u32 s52, 0
  s_cbranch_scc1 PL2
PL2_D:
  s_lshl_b32 s50, s61, 7
  s_add_u32 s50, s50, 13631488
  v_lshrrev_b32 v3, 2, v0
  buffer_load_dword v8, v3, s[4:7], s50 offen sc1
  s_lshl_b32 s50, s61, 10
  s_add_u32 s50, s50, s55
  buffer_load_dwordx4 v[20:23], v0, s[4:7], s50 offen offset:0 sc1
  buffer_load_dwordx4 v[24:27], v0, s[4:7], s50 offen offset:1024 sc1
  s_add_u32 s55, s55, 2097152
  s_mov_b32 s52, 3200000
LP3:
  ds_read_b32 v4, v247 offset:8
  s_waitcnt lgkmcnt(0)
  v_cmp_ne_u32 vcc, 4, v4
  s_cbranch_vccz LP3_D
  s_sleep 1
  s_sub_u32 s52, s52, 1
  s_cmp_lg_u32 s52, 0
  s_cbranch_scc1 LP3
LP3_D:
  s_lshl_b32 s59, s45, 12
  s_lshl_b32 s50, s45, 11
  v_add_u32_e64 v6, s50, v0
  s_lshl_b32 s57, s45, 1
  s_add_u32 s57, s57, s61
  s_add_i32 s50, s57, -5
  s_max_i32 s50, s50, 0
  s_lshl_b32 s50, s50, 10
  s_add_u32 m0, s59, 3072
  s_add_u32 s51, s50, s55
  buffer_load_dwordx4 v2, s[4:7], s51 offen sc1 lds
  s_add_u32 m0, s59, 31744
  s_add_u32 s51, s50, s56
  buffer_load_dwordx4 v0, s[4:7], s51 offen sc1 lds
  s_add_i32 s50, s57, -6
  s_max_i32 s50, s50, 0
  s_lshl_b32 s50, s50, 10
  s_add_u32 m0, s59, 2048
  s_add_u32 s51, s50, s55
  buffer_load_dwordx4 v2, s[4:7], s51 offen sc1 lds
  s_add_u32 m0, s59, 30720
  s_add_u32 s51, s50, s56
  buffer_load_dwordx4 v0, s[4:7], s51 offen sc1 lds
  s_add_i32 s50, s57, -7
  s_max_i32 s50, s50, 0
  s_lshl_b32 s50, s50, 10
  s_add_u32 m0, s59, 1024
  s_add_u32 s51, s50, s55
  buffer_load_dwordx4 v2, s[4:7], s51 offen sc1 lds
  s_add_u32 m0, s59, 29696
  s_add_u32 s51, s50, s56
  buffer_load_dwordx4 v0, s[4:7], s51 offen sc1 lds
  s_add_i32 s50, s57, -8
  s_max_i32 s50, s50, 0
  s_lshl_b32 s50, s50, 10
  s_add_u32 m0, s59, 0
  s_add_u32 s51, s50, s55
  buffer_load_dwordx4 v2, s[4:7], s51 offen sc1 lds
  s_add_u32 m0, s59, 28672
  s_add_u32 s51, s50, s56
  buffer_load_dwordx4 v0, s[4:7], s51 offen sc1 lds
  s_lshl_b32 s50, s45, 8
  s_add_u32 s50, s50, 160768
  v_add_u32_e64 v3, s50, v3
  s_waitcnt vmcnt(10)
  ds_write_b32 v3, v8
  s_mov_b64 exec, 1
  ds_add_u32 v247, v248 offset:48
  s_mov_b64 exec, -1
  s_add_u32 m0, s98, 16384
  s_add_u32 s51, s62, 720896
  s_add_u32 s52, s62, 0xfff60000
  s_min_u32 s51, s51, s52
  buffer_load_dwordx4 v254, s[24:27], s51 offen lds
  s_add_u32 m0, s98, 20480
  s_nop 0
  buffer_load_dwordx4 v255, s[24:27], s51 offen lds
  s_add_u32 m0, s98, 45056
  s_add_u32 s51, s62, 786432
  s_add_u32 s52, s62, 0xfff70000
  s_min_u32 s51, s51, s52
  buffer_load_dwordx4 v254, s[24:27], s51 offen lds
  s_add_u32 m0, s98, 49152
  s_nop 0
  buffer_load_dwordx4 v255, s[24:27], s51 offen lds
  s_add_u32 m0, s98, 114688
  s_add_u32 s51, s62, 1114112
  s_add_u32 s52, s62, 0xfffc0000
  s_min_u32 s51, s51, s52
  buffer_load_dwordx4 v254, s[24:27], s51 offen lds
  s_add_u32 m0, s98, 118784
  s_nop 0
  buffer_load_dwordx4 v255, s[24:27], s51 offen lds
  s_add_u32 m0, s98, 122880
  s_add_u32 s51, s62, 1179648
  s_add_u32 s52, s62, 0xfffd0000
  s_min_u32 s51, s51, s52
  buffer_load_dwordx4 v254, s[24:27], s51 offen lds
  s_add_u32 m0, s98, 126976
  s_nop 0
  buffer_load_dwordx4 v255, s[24:27], s51 offen lds
  s_add_u32 m0, s98, 131072
  s_add_u32 s51, s62, 1245184
  s_add_u32 s52, s62, 0xfffe0000
  s_min_u32 s51, s51, s52
  buffer_load_dwordx4 v254, s[24:27], s51 offen lds
  s_add_u32 m0, s98, 135168
  s_nop 0
  buffer_load_dwordx4 v255, s[24:27], s51 offen lds
  s_add_u32 m0, s98, 139264
  s_add_u32 s51, s62, 1310720
  s_add_u32 s52, s62, 0xffff0000
  s_min_u32 s51, s51, s52
  buffer_load_dwordx4 v254, s[24:27], s51 offen lds
  s_add_u32 m0, s98, 143360
  s_nop 0
  buffer_load_dwordx4 v255, s[24:27], s51 offen lds
  s_add_u32 m0, s98, 147456
  s_and_b32 s51, s45, 2
  s_lshl_b32 s51, s51, 14
  s_sub_u32 s51, 1376256, s51
  buffer_load_dwordx4 v254, s[24:27], s51 offen lds
  s_add_u32 m0, s98, 151552
  s_nop 0
  buffer_load_dwordx4 v255, s[24:27], s51 offen lds
  s_setprio 3
  s_waitcnt vmcnt(14)
  s_mov_b64 exec, 1
  ds_add_u32 v247, v248 offset:40
  s_mov_b64 exec, -1
  s_mov_b32 s52, 3200000
LP4:
  ds_read_b32 v4, v247 offset:40
  s_waitcnt lgkmcnt(0)
  v_cmp_ne_u32 vcc, 4, v4
  s_cbranch_vccz LP4_D
  s_sleep 1
  s_sub_u32 s52, s52, 1
  s_cmp_lg_u32 s52, 0
  s_cbranch_scc1 LP4
LP4_D:
  ds_read_b128 v[28:31], v6 offset:0
  ds_read_b128 v[32:35], v6 offset:1024
  ds_read_b128 v[36:39], v6 offset:2048
  ds_read_b128 v[40:43], v6 offset:3072
  ds_read_b128 v[44:47], v6 offset:4096
  ds_read_b128 v[48:51], v6 offset:5120
  ds_read_b128 v[52:55], v6 offset:6144
  ds_read_b128 v[56:59], v6 offset:7168
  ds_read_b128 v[60:63], v6 offset:8192
  ds_read_b128 v[64:67], v6 offset:9216
  s_mov_b32 exec_lo, 0xffff
  s_mov_b32 exec_hi, 0xffff
  ds_read_b128 v[68:71], v6 offset:28672
  ds_read_b128 v[72:75], v6 offset:28928
  ds_read_b128 v[76:79], v6 offset:29696
  ds_read_b128 v[80:83], v6 offset:29952
  ds_read_b128 v[84:87], v6 offset:30720
  ds_read_b128 v[88:91], v6 offset:30976
  ds_read_b128 v[92:95], v6 offset:31744
  ds_read_b128 v[96:99], v6 offset:32000
  ds_read_b128 v[100:103], v6 offset:32768
  ds_read_b128 v[104:107], v6 offset:33024
  ds_read_b128 v[108:111], v6 offset:33792
  ds_read_b128 v[112:115], v6 offset:34048
  ds_read_b128 v[116:119], v6 offset:34816
  ds_read_b128 v[120:123], v6 offset:35072
  ds_read_b128 v[124:127], v6 offset:35840
  ds_read_b128 v[128:131], v6 offset:36096
  ds_read_b128 v[132:135], v6 offset:36864
  ds_read_b128 v[136:139], v6 offset:37120
  ds_read_b128 v[140:143], v6 offset:37888
  ds_read_b128 v[144:147], v6 offset:38144
  s_mov_b64 exec, 1
  ds_add_u32 v247, v248 offset:44
  s_mov_b64 exec, -1
  s_setprio 0
  v_lshlrev_b32 v164, 16, v20
  v_and_b32 v165, 0xffff0000, v20
  v_lshlrev_b32_e64 v166, 16, v21
  v_and_b32 v167, 0xffff0000, v21
  v_lshlrev_b32_e64 v168, 16, v22
  v_and_b32 v169, 0xffff0000, v22
  v_lshlrev_b32_e64 v170, 16, v23
  v_and_b32 v171, 0xffff0000, v23
  v_subrev_u32 v164, 0x8000, v164
  v_mul_f32 v164, 0x3eb8aa3b, v164
  v_mul_f32 v165, 0x3eb8aa3b, v165
  v_mul_f32 v166, 0x3eb8aa3b, v166
  v_mul_f32 v167, 0x3eb8aa3b, v167
  v_mul_f32 v168, 0x3eb8aa3b, v168
  v_mul_f32 v169, 0x3eb8aa3b, v169
  v_mul_f32 v170, 0x3eb8aa3b, v170
  v_mul_f32 v171, 0x3eb8aa3b, v171
  v_cvt_pk_bf16_f32 v20, v164, v165
  v_cvt_pk_bf16_f32 v21, v166, v167
  v_cvt_pk_bf16_f32 v22, v168, v169
  v_cvt_pk_bf16_f32 v23, v170, v171
  v_lshlrev_b32_e64 v172, 16, v24
  v_and_b32 v173, 0xffff0000, v24
  v_lshlrev_b32_e64 v174, 16, v25
  v_and_b32 v175, 0xffff0000, v25
  v_lshlrev_b32_e64 v176, 16, v26
  v_and_b32 v177, 0xffff0000, v26
  v_lshlrev_b32_e64 v178, 16, v27
  v_and_b32 v179, 0xffff0000, v27
  v_subrev_u32 v172, 0x8000, v172
  v_mul_f32 v172, 0x3eb8aa3b, v172
  v_mul_f32 v173, 0x3eb8aa3b, v173
  v_mul_f32 v174, 0x3eb8aa3b, v174
  v_mul_f32 v175, 0x3eb8aa3b, v175
  v_mul_f32 v176, 0x3eb8aa3b, v176
  v_mul_f32 v177, 0x3eb8aa3b, v177
  v_mul_f32 v178, 0x3eb8aa3b, v178
  v_mul_f32 v179, 0x3eb8aa3b, v179
  v_cvt_pk_bf16_f32 v24, v172, v173
  v_cvt_pk_bf16_f32 v25, v174, v175
  v_cvt_pk_bf16_f32 v26, v176, v177
  v_cvt_pk_bf16_f32 v27, v178, v179
  v_exp_f32 v8, -v8
  s_nop 0
  v_add_f32 v8, 1.0, v8
  v_rcp_f32 v8, v8
  s_nop 0
  v_mov_b32_e64 v9, v8
  s_nop 1
  v_permlane32_swap_b32 v8, v9
  s_waitcnt lgkmcnt(0)
  s_setprio 1
  s_cmp_lt_u32 s61, 8
  s_cbranch_scc1 AT_VX
AT_VZ:
  v_mfma_f32_32x32x16_bf16 v[164:179], v[60:63], v[20:23], 0
  v_mfma_f32_32x32x16_bf16 v[148:163], v[28:31], v[20:23], 0
  s_cmp_lt_u32 s61, 8
  s_cbranch_scc1 AT_FX0
AT_FO0:
  s_nop 9
  v_cndmask_b32 v148, v148, v164, s[64:65]
  v_cndmask_b32 v149, v149, v165, s[66:67]
  v_cndmask_b32 v150, v150, v166, s[68:69]
  v_cndmask_b32 v151, v151, v167, s[70:71]
  v_cndmask_b32 v152, v152, v168, s[72:73]
  v_cndmask_b32 v153, v153, v169, s[74:75]
  v_cndmask_b32 v154, v154, v170, s[76:77]
  v_cndmask_b32 v155, v155, v171, s[78:79]
  v_cndmask_b32 v156, v156, v172, s[80:81]
  v_cndmask_b32 v157, v157, v173, s[82:83]
  v_cndmask_b32 v158, v158, v174, s[84:85]
  v_cndmask_b32 v159, v159, v175, s[86:87]
  v_cndmask_b32 v160, v160, v176, s[88:89]
  v_cndmask_b32 v161, v161, v177, s[90:91]
  v_cndmask_b32 v162, v162, v178, s[92:93]
  v_cndmask_b32 v163, v163, v179, s[94:95]
  v_max3_f32 v5, v148, v149, v150
  v_max3_f32 v6, v151, v152, v153
  v_max3_f32 v5, v5, v154, v155
  v_max3_f32 v6, v6, v156, v157
  v_max3_f32 v5, v5, v158, v159
  v_max3_f32 v6, v6, v160, v161
  v_max3_f32 v5, v5, v162, v163
  v_max_f32 v5, v5, v6
  v_mov_b32 v6, v5
  s_lshl_b32 s50, s61, 10
  s_lshl_b32 s51, s100, 16
  v_permlane32_swap_b32 v5, v6
  v_max_f32 v5, v5, v6
  v_sub_f32 v196, 0, v5
  v_sub_f32 v197, 0, v5
  v_mov_b64 v[198:199], v[196:197]
  v_mov_b64 v[200:201], v[196:197]
  v_mov_b64 v[202:203], v[196:197]
  v_mov_b64 v[204:205], v[196:197]
  v_mov_b64 v[206:207], v[196:197]
  v_mov_b64 v[208:209], v[196:197]
  v_mov_b64 v[210:211], v[196:197]
  v_sub_f32 v148, v148, v5
  v_sub_f32 v149, v149, v5
  v_mfma_f32_32x32x16_bf16 v[180:195], v[56:59], v[20:23], v[196:211]
  v_sub_f32 v150, v150, v5
  v_sub_f32 v151, v151, v5
  v_sub_f32 v152, v152, v5
  v_sub_f32 v153, v153, v5
  v_sub_f32 v154, v154, v5
  v_sub_f32 v155, v155, v5
  v_sub_f32 v156, v156, v5
  v_sub_f32 v157, v157, v5
  v_sub_f32 v158, v158, v5
  v_sub_f32 v159, v159, v5
  v_sub_f32 v160, v160, v5
  v_sub_f32 v161, v161, v5
  v_sub_f32 v162, v162, v5
  v_sub_f32 v163, v163, v5
  v_exp_f32 v148, v148
  v_exp_f32 v149, v149
  v_exp_f32 v150, v150
  v_exp_f32 v151, v151
  v_exp_f32 v152, v152
  v_exp_f32 v153, v153
  v_exp_f32 v154, v154
  v_exp_f32 v155, v155
  v_exp_f32 v156, v156
  v_exp_f32 v157, v157
  v_exp_f32 v158, v158
  v_exp_f32 v159, v159
  v_exp_f32 v160, v160
  v_exp_f32 v161, v161
  v_exp_f32 v162, v162
  v_exp_f32 v163, v163
  v_cvt_pk_bf16_f32 v236, v148, v149
  v_cvt_pk_bf16_f32 v237, v150, v151
  v_cvt_pk_bf16_f32 v238, v152, v153
  v_cvt_pk_bf16_f32 v239, v154, v155
  v_cvt_pk_bf16_f32 v240, v156, v157
  v_cvt_pk_bf16_f32 v241, v158, v159
  v_cvt_pk_bf16_f32 v242, v160, v161
  v_cvt_pk_bf16_f32 v243, v162, v163
  v_and_b32 v228, v236, v12
  v_and_b32 v229, v237, v13
  v_and_b32 v230, v238, v14
  v_and_b32 v231, v239, v15
  v_and_b32 v232, v240, v16
  v_and_b32 v233, v241, v17
  v_mfma_f32_32x32x16_bf16 v[212:227], v[132:135], v[228:231], 0
  v_and_b32 v234, v242, v18
  v_and_b32 v235, v243, v19
  v_xor_b32 v236, v236, v228
  v_xor_b32 v237, v237, v229
  v_xor_b32 v238, v238, v230
  v_xor_b32 v239, v239, v231
  v_mfma_f32_32x32x16_bf16 v[212:227], v[136:139], v[232:235], v[212:227]
  v_xor_b32 v240, v240, v232
  v_xor_b32 v241, v241, v233
  v_xor_b32 v242, v242, v234
  v_xor_b32 v243, v243, v235
  v_exp_f32_e64 v180, v180
  v_mfma_f32_32x32x16_bf16 v[212:227], v[68:71], v[236:239], v[212:227]
  v_exp_f32 v181, v181
  v_exp_f32 v182, v182
  v_exp_f32_e64 v183, v183
  v_mfma_f32_32x32x16_bf16 v[212:227], v[72:75], v[240:243], v[212:227]
  v_exp_f32 v184, v184
  v_exp_f32 v185, v185
  v_exp_f32 v186, v186
  v_exp_f32 v187, v187
  v_mfma_f32_32x32x16_bf16 v[164:179], v[52:55], v[20:23], v[196:211]
  s_lshl_b32 s52, s45, 2
  v_add_u32_e64 v3, s52, v247
  s_waitcnt vmcnt(0)
  ds_write_b32 v3, v248 offset:16
  v_exp_f32_e64 v188, v188
  v_cvt_pk_bf16_f32 v228, v180, v181
  v_cvt_pk_bf16_f32 v229, v182, v183
  v_cvt_pk_bf16_f32 v230, v184, v185
  v_cvt_pk_bf16_f32 v231, v186, v187
  v_exp_f32 v189, v189
  v_exp_f32 v190, v190
  v_mfma_f32_32x32x16_bf16 v[212:227], v[124:127], v[228:231], v[212:227]
  v_exp_f32 v191, v191
  v_exp_f32 v192, v192
  v_exp_f32 v193, v193
  v_exp_f32 v194, v194
  v_exp_f32_e64 v195, v195
  v_cvt_pk_bf16_f32 v232, v188, v189
  v_cvt_pk_bf16_f32 v233, v190, v191
  v_cvt_pk_bf16_f32 v234, v192, v193
  v_cvt_pk_bf16_f32 v235, v194, v195
  v_exp_f32 v164, v164
  v_exp_f32 v165, v165
  v_exp_f32 v166, v166
  v_exp_f32 v167, v167
  v_mfma_f32_32x32x16_bf16 v[212:227], v[128:131], v[232:235], v[212:227]
  v_exp_f32 v168, v168
  v_exp_f32 v169, v169
  v_exp_f32 v170, v170
  v_exp_f32 v171, v171
  v_mfma_f32_32x32x16_bf16 v[180:195], v[48:51], v[20:23], v[196:211]
  v_exp_f32_e64 v172, v172
  v_cvt_pk_bf16_f32 v236, v164, v165
  v_cvt_pk_bf16_f32 v237, v166, v167
  v_cvt_pk_bf16_f32 v238, v168, v169
  v_cvt_pk_bf16_f32 v239, v170, v171
  v_exp_f32 v173, v173
  v_exp_f32 v174, v174
  v_mfma_f32_32x32x16_bf16 v[212:227], v[116:119], v[236:239], v[212:227]
  v_exp_f32 v175, v175
  v_exp_f32 v176, v176
  v_exp_f32 v177, v177
  v_exp_f32 v178, v178
  v_exp_f32_e64 v179, v179
  v_cvt_pk_bf16_f32 v240, v172, v173
  v_cvt_pk_bf16_f32 v241, v174, v175
  v_cvt_pk_bf16_f32 v242, v176, v177
  v_cvt_pk_bf16_f32 v243, v178, v179
  v_exp_f32 v180, v180
  v_exp_f32 v181, v181
  v_exp_f32 v182, v182
  v_exp_f32 v183, v183
  v_mfma_f32_32x32x16_bf16 v[212:227], v[120:123], v[240:243], v[212:227]
  v_exp_f32 v184, v184
  v_exp_f32 v185, v185
  v_exp_f32 v186, v186
  v_exp_f32 v187, v187
  v_mfma_f32_32x32x16_bf16 v[164:179], v[44:47], v[20:23], v[196:211]
  v_exp_f32_e64 v188, v188
  v_cvt_pk_bf16_f32 v228, v180, v181
  v_cvt_pk_bf16_f32 v229, v182, v183
  v_cvt_pk_bf16_f32 v230, v184, v185
  v_cvt_pk_bf16_f32 v231, v186, v187
  v_exp_f32 v189, v189
  v_exp_f32 v190, v190
  v_mfma_f32_32x32x16_bf16 v[212:227], v[108:111], v[228:231], v[212:227]
  v_exp_f32 v191, v191
  v_exp_f32 v192, v192
  v_exp_f32 v193, v193
  v_exp_f32 v194, v194
  v_exp_f32_e64 v195, v195
  v_cvt_pk_bf16_f32 v232, v188, v189
  v_cvt_pk_bf16_f32 v233, v190, v191
  v_cvt_pk_bf16_f32 v234, v192, v193
  v_cvt_pk_bf16_f32 v235, v194, v195
  v_exp_f32 v164, v164
  v_exp_f32 v165, v165
  v_exp_f32 v166, v166
  v_exp_f32 v167, v167
  v_mfma_f32_32x32x16_bf16 v[212:227], v[112:115], v[232:235], v[212:227]
  v_exp_f32 v168, v168
  v_exp_f32 v169, v169
  v_exp_f32 v170, v170
  v_exp_f32 v171, v171
  v_mfma_f32_32x32x16_bf16 v[180:195], v[40:43], v[20:23], v[196:211]
  v_exp_f32_e64 v172, v172
  v_cvt_pk_bf16_f32 v236, v164, v165
  v_cvt_pk_bf16_f32 v237, v166, v167
  v_cvt_pk_bf16_f32 v238, v168, v169
  v_cvt_pk_bf16_f32 v239, v170, v171
  v_exp_f32 v173, v173
  v_exp_f32 v174, v174
  v_mfma_f32_32x32x16_bf16 v[212:227], v[100:103], v[236:239], v[212:227]
  v_exp_f32 v175, v175
  v_exp_f32 v176, v176
  v_exp_f32 v177, v177
  v_exp_f32 v178, v178
  v_exp_f32_e64 v179, v179
  v_cvt_pk_bf16_f32 v240, v172, v173
  v_cvt_pk_bf16_f32 v241, v174, v175
  v_cvt_pk_bf16_f32 v242, v176, v177
  v_cvt_pk_bf16_f32 v243, v178, v179
  v_exp_f32 v180, v180
  v_exp_f32 v181, v181
  v_exp_f32 v182, v182
  v_exp_f32 v183, v183
  v_mfma_f32_32x32x16_bf16 v[212:227], v[104:107], v[240:243], v[212:227]
  v_exp_f32 v184, v184
  v_exp_f32 v185, v185
  v_exp_f32 v186, v186
  v_exp_f32 v187, v187
  v_mfma_f32_32x32x16_bf16 v[164:179], v[36:39], v[20:23], v[196:211]
  v_exp_f32_e64 v188, v188
  v_cvt_pk_bf16_f32 v228, v180, v181
  v_cvt_pk_bf16_f32 v229, v182, v183
  v_cvt_pk_bf16_f32 v230, v184, v185
  v_cvt_pk_bf16_f32 v231, v186, v187
  v_exp_f32 v189, v189
  v_exp_f32 v190, v190
  v_mfma_f32_32x32x16_bf16 v[212:227], v[92:95], v[228:231], v[212:227]
  v_exp_f32 v191, v191
  v_exp_f32 v192, v192
  v_exp_f32 v193, v193
  v_exp_f32 v194, v194
  v_exp_f32_e64 v195, v195
  v_cvt_pk_bf16_f32 v232, v188, v189
  v_cvt_pk_bf16_f32 v233, v190, v191
  v_cvt_pk_bf16_f32 v234, v192, v193
  v_cvt_pk_bf16_f32 v235, v194, v195
  v_exp_f32 v164, v164
  v_exp_f32 v165, v165
  v_exp_f32 v166, v166
  v_exp_f32 v167, v167
  v_mfma_f32_32x32x16_bf16 v[212:227], v[96:99], v[232:235], v[212:227]
  v_exp_f32 v168, v168
  v_exp_f32 v169, v169
  v_exp_f32 v170, v170
  v_exp_f32 v171, v171
  v_mfma_f32_32x32x16_bf16 v[180:195], v[32:35], v[20:23], v[196:211]
  v_exp_f32_e64 v172, v172
  v_cvt_pk_bf16_f32 v236, v164, v165
  v_cvt_pk_bf16_f32 v237, v166, v167
  v_cvt_pk_bf16_f32 v238, v168, v169
  v_cvt_pk_bf16_f32 v239, v170, v171
  v_exp_f32 v173, v173
  v_exp_f32 v174, v174
  v_mfma_f32_32x32x16_bf16 v[212:227], v[84:87], v[236:239], v[212:227]
  v_exp_f32 v175, v175
  v_exp_f32 v176, v176
  v_exp_f32 v177, v177
  v_exp_f32 v178, v178
  v_exp_f32_e64 v179, v179
  v_cvt_pk_bf16_f32 v240, v172, v173
  v_cvt_pk_bf16_f32 v241, v174, v175
  v_cvt_pk_bf16_f32 v242, v176, v177
  v_cvt_pk_bf16_f32 v243, v178, v179
  v_exp_f32 v180, v180
  v_exp_f32 v181, v181
  v_exp_f32 v182, v182
  v_exp_f32 v183, v183
  v_mfma_f32_32x32x16_bf16 v[212:227], v[88:91], v[240:243], v[212:227]
  v_exp_f32 v184, v184
  v_exp_f32 v185, v185
  v_exp_f32 v186, v186
  v_exp_f32 v187, v187
  v_mfma_f32_32x32x16_bf16 v[164:179], v[64:67], v[24:27], 0
  v_exp_f32_e64 v188, v188
  v_cvt_pk_bf16_f32 v228, v180, v181
  v_cvt_pk_bf16_f32 v229, v182, v183
  v_cvt_pk_bf16_f32 v230, v184, v185
  v_cvt_pk_bf16_f32 v231, v186, v187
  v_exp_f32 v189, v189
  v_exp_f32 v190, v190
  v_mfma_f32_32x32x16_bf16 v[212:227], v[76:79], v[228:231], v[212:227]
  v_exp_f32 v191, v191
  v_exp_f32 v192, v192
  v_exp_f32_e64 v193, v193
  v_mfma_f32_32x32x16_bf16 v[148:163], v[32:35], v[24:27], 0
  v_exp_f32 v194, v194
  v_exp_f32 v195, v195
  v_cvt_pk_bf16_f32 v232, v188, v189
  v_cvt_pk_bf16_f32 v233, v190, v191
  v_cvt_pk_bf16_f32 v234, v192, v193
  v_cvt_pk_bf16_f32 v235, v194, v195
  s_nop 1
  v_mfma_f32_32x32x16_bf16 v[212:227], v[80:83], v[232:235], v[212:227]
  s_cmp_lt_u32 s61, 8
  s_cbranch_scc1 AT_FX1
AT_FO1:
  s_nop 0
  v_cndmask_b32 v148, v148, v164, s[64:65]
  v_cndmask_b32 v149, v149, v165, s[66:67]
  v_cndmask_b32 v150, v150, v166, s[68:69]
  v_cndmask_b32 v151, v151, v167, s[70:71]
  v_cndmask_b32 v152, v152, v168, s[72:73]
  v_cndmask_b32 v153, v153, v169, s[74:75]
  v_cndmask_b32 v154, v154, v170, s[76:77]
  v_cndmask_b32 v155, v155, v171, s[78:79]
  v_cndmask_b32 v156, v156, v172, s[80:81]
  v_cndmask_b32 v157, v157, v173, s[82:83]
  v_cndmask_b32 v158, v158, v174, s[84:85]
  v_cndmask_b32 v159, v159, v175, s[86:87]
  v_cndmask_b32 v160, v160, v176, s[88:89]
  v_cndmask_b32 v161, v161, v177, s[90:91]
  v_cndmask_b32 v162, v162, v178, s[92:93]
  v_cndmask_b32 v163, v163, v179, s[94:95]
  v_max3_f32 v5, v148, v149, v150
  v_max3_f32 v6, v151, v152, v153
  v_max3_f32 v5, v5, v154, v155
  v_max3_f32 v6, v6, v156, v157
  v_max3_f32 v5, v5, v158, v159
  v_max3_f32 v6, v6, v160, v161
  v_max3_f32 v5, v5, v162, v163
  v_max_f32 v5, v5, v6
  v_mov_b32 v6, v5
  s_lshl_b32 s50, s61, 10
  s_lshl_b32 s51, s100, 16
  v_permlane32_swap_b32 v5, v6
  v_max_f32 v5, v5, v6
  v_sub_f32 v196, 0, v5
  v_sub_f32 v197, 0, v5
  v_mov_b64 v[198:199], v[196:197]
  v_mov_b64 v[200:201], v[196:197]
  v_mov_b64 v[202:203], v[196:197]
  v_mov_b64 v[204:205], v[196:197]
  v_mov_b64 v[206:207], v[196:197]
  v_mov_b64 v[208:209], v[196:197]
  v_mov_b64 v[210:211], v[196:197]
  v_sub_f32 v148, v148, v5
  v_sub_f32_e64 v149, v149, v5
  v_mfma_f32_32x32x16_bf16 v[180:195], v[60:63], v[24:27], v[196:211]
  s_add_u32 s50, s50, s51
  v_rcp_f32 v3, v220
  s_nop 0
  v_max_f32 v4, v3, v220
  v_mul_f32 v3, v3, v8
  v_cmp_ngt_f32 vcc, v246, v4
  s_cbranch_vccnz AT_SLOW
  v_mul_f32 v212, v212, v3
  v_mul_f32 v213, v213, v3
  v_mul_f32 v214, v214, v3
  v_mul_f32 v215, v215, v3
  v_mul_f32 v216, v216, v3
  v_mul_f32 v217, v217, v3
  v_mul_f32 v218, v218, v3
  v_mul_f32_e64 v219, v219, v3
  v_add_u32 v212, 0x10000, v212
  v_and_b32 v212, 0xfffe0000, v212
  v_cvt_pk_bf16_f32 v228, v212, v213
  v_cvt_pk_bf16_f32 v229, v214, v215
  v_cvt_pk_bf16_f32 v230, v216, v217
  v_cvt_pk_bf16_f32 v231, v218, v219
  v_and_b32_e64 v228, -2, v228
  buffer_store_dwordx4 v[228:231], v0, s[4:7], s50 offen offset:0 sc1
  v_sub_f32 v150, v150, v5
  v_sub_f32 v151, v151, v5
  v_sub_f32 v152, v152, v5
  v_sub_f32 v153, v153, v5
  v_sub_f32 v154, v154, v5
  v_sub_f32 v155, v155, v5
  v_sub_f32 v156, v156, v5
  v_sub_f32 v157, v157, v5
  v_sub_f32 v158, v158, v5
  v_sub_f32 v159, v159, v5
  v_sub_f32 v160, v160, v5
  v_sub_f32 v161, v161, v5
  v_sub_f32 v162, v162, v5
  v_sub_f32 v163, v163, v5
  v_exp_f32 v148, v148
  v_exp_f32 v149, v149
  v_exp_f32 v150, v150
  v_exp_f32 v151, v151
  v_exp_f32 v152, v152
  v_exp_f32 v153, v153
  v_exp_f32 v154, v154
  v_exp_f32 v155, v155
  v_exp_f32 v156, v156
  v_exp_f32 v157, v157
  v_exp_f32 v158, v158
  v_exp_f32 v159, v159
  v_exp_f32 v160, v160
  v_exp_f32 v161, v161
  v_exp_f32 v162, v162
  v_exp_f32 v163, v163
  v_cvt_pk_bf16_f32 v236, v148, v149
  v_cvt_pk_bf16_f32 v237, v150, v151
  v_cvt_pk_bf16_f32 v238, v152, v153
  v_cvt_pk_bf16_f32 v239, v154, v155
  v_cvt_pk_bf16_f32 v240, v156, v157
  v_cvt_pk_bf16_f32 v241, v158, v159
  v_cvt_pk_bf16_f32 v242, v160, v161
  v_cvt_pk_bf16_f32 v243, v162, v163
  v_and_b32 v228, v236, v12
  v_and_b32 v229, v237, v13
  v_and_b32 v230, v238, v14
  v_and_b32 v231, v239, v15
  v_and_b32 v232, v240, v16
  v_and_b32 v233, v241, v17
  v_mfma_f32_32x32x16_bf16 v[212:227], v[140:143], v[228:231], 0
  v_and_b32 v234, v242, v18
  v_and_b32 v235, v243, v19
  v_xor_b32 v236, v236, v228
  v_xor_b32 v237, v237, v229
  v_xor_b32 v238, v238, v230
  v_xor_b32 v239, v239, v231
  v_mfma_f32_32x32x16_bf16 v[212:227], v[144:147], v[232:235], v[212:227]
  v_xor_b32 v240, v240, v232
  v_xor_b32 v241, v241, v233
  v_xor_b32 v242, v242, v234
  v_xor_b32 v243, v243, v235
  v_exp_f32_e64 v180, v180
  v_mfma_f32_32x32x16_bf16 v[212:227], v[76:79], v[236:239], v[212:227]
  v_exp_f32 v181, v181
  v_exp_f32 v182, v182
  v_exp_f32_e64 v183, v183
  v_mfma_f32_32x32x16_bf16 v[212:227], v[80:83], v[240:243], v[212:227]
  v_exp_f32 v184, v184
  v_exp_f32 v185, v185
  v_exp_f32 v186, v186
  v_exp_f32 v187, v187
  v_mfma_f32_32x32x16_bf16 v[164:179], v[56:59], v[24:27], v[196:211]
  v_exp_f32_e64 v188, v188
  v_cvt_pk_bf16_f32 v228, v180, v181
  v_cvt_pk_bf16_f32 v229, v182, v183
  v_cvt_pk_bf16_f32 v230, v184, v185
  v_cvt_pk_bf16_f32 v231, v186, v187
  v_exp_f32 v189, v189
  v_exp_f32 v190, v190
  v_mfma_f32_32x32x16_bf16 v[212:227], v[132:135], v[228:231], v[212:227]
  v_exp_f32 v191, v191
  v_exp_f32 v192, v192
  v_exp_f32 v193, v193
  v_exp_f32 v194, v194
  v_exp_f32_e64 v195, v195
  v_cvt_pk_bf16_f32 v232, v188, v189
  v_cvt_pk_bf16_f32 v233, v190, v191
  v_cvt_pk_bf16_f32 v234, v192, v193
  v_cvt_pk_bf16_f32 v235, v194, v195
  v_exp_f32 v164, v164
  v_exp_f32 v165, v165
  v_exp_f32 v166, v166
  v_exp_f32 v167, v167
  v_mfma_f32_32x32x16_bf16 v[212:227], v[136:139], v[232:235], v[212:227]
  v_exp_f32 v168, v168
  v_exp_f32 v169, v169
  v_exp_f32 v170, v170
  v_exp_f32 v171, v171
  v_mfma_f32_32x32x16_bf16 v[180:195], v[52:55], v[24:27], v[196:211]
  v_exp_f32_e64 v172, v172
  v_cvt_pk_bf16_f32 v236, v164, v165
  v_cvt_pk_bf16_f32 v237, v166, v167
  v_cvt_pk_bf16_f32 v238, v168, v169
  v_cvt_pk_bf16_f32 v239, v170, v171
  v_exp_f32 v173, v173
  v_exp_f32 v174, v174
  v_mfma_f32_32x32x16_bf16 v[212:227], v[124:127], v[236:239], v[212:227]
  v_exp_f32 v175, v175
  v_exp_f32 v176, v176
  v_exp_f32 v177, v177
  v_exp_f32 v178, v178
  v_exp_f32_e64 v179, v179
  v_cvt_pk_bf16_f32 v240, v172, v173
  v_cvt_pk_bf16_f32 v241, v174, v175
  v_cvt_pk_bf16_f32 v242, v176, v177
  v_cvt_pk_bf16_f32 v243, v178, v179
  v_exp_f32 v180, v180
  v_exp_f32 v181, v181
  v_exp_f32 v182, v182
  v_exp_f32 v183, v183
  v_mfma_f32_32x32x16_bf16 v[212:227], v[128:131], v[240:243], v[212:227]
  v_exp_f32 v184, v184
  v_exp_f32 v185, v185
  v_exp_f32 v186, v186
  v_exp_f32 v187, v187
  v_mfma_f32_32x32x16_bf16 v[164:179], v[48:51], v[24:27], v[196:211]
  v_exp_f32_e64 v188, v188
  v_cvt_pk_bf16_f32 v228, v180, v181
  v_cvt_pk_bf16_f32 v229, v182, v183
  v_cvt_pk_bf16_f32 v230, v184, v185
  v_cvt_pk_bf16_f32 v231, v186, v187
  v_exp_f32 v189, v189
  v_exp_f32 v190, v190
  v_mfma_f32_32x32x16_bf16 v[212:227], v[116:119], v[228:231], v[212:227]
  v_exp_f32 v191, v191
  v_exp_f32 v192, v192
  v_exp_f32 v193, v193
  v_exp_f32 v194, v194
  v_exp_f32_e64 v195, v195
  v_cvt_pk_bf16_f32 v232, v188, v189
  v_cvt_pk_bf16_f32 v233, v190, v191
  v_cvt_pk_bf16_f32 v234, v192, v193
  v_cvt_pk_bf16_f32 v235, v194, v195
  v_exp_f32 v164, v164
  v_exp_f32 v165, v165
  v_exp_f32 v166, v166
  v_exp_f32 v167, v167
  v_mfma_f32_32x32x16_bf16 v[212:227], v[120:123], v[232:235], v[212:227]
  v_exp_f32 v168, v168
  v_exp_f32 v169, v169
  v_exp_f32 v170, v170
  v_exp_f32 v171, v171
  v_mfma_f32_32x32x16_bf16 v[180:195], v[44:47], v[24:27], v[196:211]
  v_exp_f32_e64 v172, v172
  v_cvt_pk_bf16_f32 v236, v164, v165
  v_cvt_pk_bf16_f32 v237, v166, v167
  v_cvt_pk_bf16_f32 v238, v168, v169
  v_cvt_pk_bf16_f32 v239, v170, v171
  v_exp_f32 v173, v173
  v_exp_f32 v174, v174
  v_mfma_f32_32x32x16_bf16 v[212:227], v[108:111], v[236:239], v[212:227]
  v_exp_f32 v175, v175
  v_exp_f32 v176, v176
  v_exp_f32 v177, v177
  v_exp_f32 v178, v178
  v_exp_f32_e64 v179, v179
  v_cvt_pk_bf16_f32 v240, v172, v173
  v_cvt_pk_bf16_f32 v241, v174, v175
  v_cvt_pk_bf16_f32 v242, v176, v177
  v_cvt_pk_bf16_f32 v243, v178, v179
  v_exp_f32 v180, v180
  v_exp_f32 v181, v181
  v_exp_f32 v182, v182
  v_exp_f32 v183, v183
  v_mfma_f32_32x32x16_bf16 v[212:227], v[112:115], v[240:243], v[212:227]
  v_exp_f32 v184, v184
  v_exp_f32 v185, v185
  v_exp_f32 v186, v186
  v_exp_f32 v187, v187
  v_mfma_f32_32x32x16_bf16 v[164:179], v[40:43], v[24:27], v[196:211]
  v_exp_f32_e64 v188, v188
  v_cvt_pk_bf16_f32 v228, v180, v181
  v_cvt_pk_bf16_f32 v229, v182, v183
  v_cvt_pk_bf16_f32 v230, v184, v185
  v_cvt_pk_bf16_f32 v231, v186, v187
  v_exp_f32 v189, v189
  v_exp_f32 v190, v190
  v_mfma_f32_32x32x16_bf16 v[212:227], v[100:103], v[228:231], v[212:227]
  v_exp_f32 v191, v191
  v_exp_f32 v192, v192
  v_exp_f32 v193, v193
  v_exp_f32 v194, v194
  v_exp_f32_e64 v195, v195
  v_cvt_pk_bf16_f32 v232, v188, v189
  v_cvt_pk_bf16_f32 v233, v190, v191
  v_cvt_pk_bf16_f32 v234, v192, v193
  v_cvt_pk_bf16_f32 v235, v194, v195
  v_exp_f32 v164, v164
  v_exp_f32 v165, v165
  v_exp_f32 v166, v166
  v_exp_f32 v167, v167
  v_mfma_f32_32x32x16_bf16 v[212:227], v[104:107], v[232:235], v[212:227]
  v_exp_f32 v168, v168
  v_exp_f32 v169, v169
  v_exp_f32 v170, v170
  v_exp_f32 v171, v171
  v_mfma_f32_32x32x16_bf16 v[180:195], v[36:39], v[24:27], v[196:211]
  v_exp_f32_e64 v172, v172
  v_cvt_pk_bf16_f32 v236, v164, v165
  v_cvt_pk_bf16_f32 v237, v166, v167
  v_cvt_pk_bf16_f32 v238, v168, v169
  v_cvt_pk_bf16_f32 v239, v170, v171
  v_exp_f32 v173, v173
  v_exp_f32 v174, v174
  v_mfma_f32_32x32x16_bf16 v[212:227], v[92:95], v[236:239], v[212:227]
  v_exp_f32 v175, v175
  v_exp_f32 v176, v176
  v_exp_f32 v177, v177
  v_exp_f32 v178, v178
  v_exp_f32_e64 v179, v179
  v_cvt_pk_bf16_f32 v240, v172, v173
  v_cvt_pk_bf16_f32 v241, v174, v175
  v_cvt_pk_bf16_f32 v242, v176, v177
  v_cvt_pk_bf16_f32 v243, v178, v179
  v_exp_f32 v180, v180
  v_exp_f32 v181, v181
  v_exp_f32 v182, v182
  v_exp_f32 v183, v183
  v_mfma_f32_32x32x16_bf16 v[212:227], v[96:99], v[240:243], v[212:227]
  v_exp_f32 v184, v184
  v_exp_f32 v185, v185
  v_exp_f32 v186, v186
  v_exp_f32 v187, v187
  v_exp_f32_e64 v188, v188
  v_cvt_pk_bf16_f32 v228, v180, v181
  v_cvt_pk_bf16_f32 v229, v182, v183
  v_cvt_pk_bf16_f32 v230, v184, v185
  v_cvt_pk_bf16_f32 v231, v186, v187
  v_exp_f32 v189, v189
  v_exp_f32 v190, v190
  v_mfma_f32_32x32x16_bf16 v[212:227], v[84:87], v[228:231], v[212:227]
  v_exp_f32 v191, v191
  v_exp_f32 v192, v192
  v_exp_f32 v193, v193
  v_exp_f32 v194, v194
  v_exp_f32_e64 v195, v195
  v_cvt_pk_bf16_f32 v232, v188, v189
  v_cvt_pk_bf16_f32 v233, v190, v191
  v_cvt_pk_bf16_f32 v234, v192, v193
  v_cvt_pk_bf16_f32 v235, v194, v195
  s_nop 1
  v_mfma_f32_32x32x16_bf16 v[212:227], v[88:91], v[232:235], v[212:227]
  s_nop 11
  v_rcp_f32 v3, v220
  s_nop 0
  v_max_f32 v4, v3, v220
  v_mul_f32 v3, v3, v9
  v_cmp_ngt_f32 vcc, v246, v4
  s_cbranch_vccnz AT_SLOW
  v_mul_f32 v212, v212, v3
  v_mul_f32 v213, v213, v3
  v_mul_f32 v214, v214, v3
  v_mul_f32 v215, v215, v3
  v_mul_f32 v216, v216, v3
  v_mul_f32 v217, v217, v3
  v_mul_f32 v218, v218, v3
  v_mul_f32 v219, v219, v3
  v_add_u32 v212, 0x10000, v212
  v_and_b32 v212, 0xfffe0000, v212
  v_cvt_pk_bf16_f32 v228, v212, v213
  v_cvt_pk_bf16_f32 v229, v214, v215
  v_cvt_pk_bf16_f32 v230, v216, v217
  v_cvt_pk_bf16_f32 v231, v218, v219
  v_and_b32_e64 v228, -2, v228
  buffer_store_dwordx4 v[228:231], v0, s[4:7], s50 offen offset:1024 sc1
AT_DONE:
FINAL:
  v_mbcnt_lo_u32_b32 v1, -1, 0
  v_mbcnt_hi_u32_b32 v1, -1, v1
  v_lshrrev_b32_e64 v4, 4, v1
  v_bfe_u32 v5, v1, 3, 1
  v_lshl_add_u32 v3, v5, 2, v4
  v_lshlrev_b32_e64 v2, 8, v4
  v_lshl_add_u32 v2, v5, 7, v2
  v_and_b32_e64 v5, 3, v1
  v_lshl_add_u32 v2, v5, 5, v2
  v_and_b32 v5, 16, v1
  v_add_u32 v2, v2, v5
  v_cmp_ne_u32 s[56:57], 0, v5
  v_bfe_u32 v5, v1, 2, 1
  v_lshl_add_u32 v2, v5, 14, v2
  s_lshr_b32 s50, s44, 2
  s_lshl_b32 s50, s50, 15
  s_lshl_b32 s58, s45, 12
  s_add_u32 s50, s50, s58
  v_add_u32 v2, s50, v2
  v_and_b32 v5, 7, v1
  v_lshlrev_b32_e64 v5, 4, v5
  v_lshl_add_u32 v6, v3, 10, v5
  v_xor_b32 v3, 16, v2
  s_lshl_b32 s58, s53, 16
  s_lshl_b32 s50, s54, 7
  s_add_u32 s58, s58, s50
  s_lshl_b32 s50, s44, 13
  s_add_u32 s58, s58, s50
  s_waitcnt lgkmcnt(0)
  s_barrier
  ds_read_b128 v[16:19], v2 offset:0
  ds_read_b128 v[20:23], v3 offset:0
  ds_read_b128 v[24:27], v2 offset:1024
  ds_read_b128 v[28:31], v3 offset:1024
  ds_read_b128 v[32:35], v2 offset:2048
  ds_read_b128 v[36:39], v3 offset:2048
  ds_read_b128 v[40:43], v2 offset:3072
  ds_read_b128 v[44:47], v3 offset:3072
  s_waitcnt lgkmcnt(4)
  v_pk_add_f32 v[16:17], v[16:17], v[24:25]
  v_pk_add_f32 v[18:19], v[18:19], v[26:27]
  v_pk_add_f32 v[20:21], v[20:21], v[28:29]
  v_pk_add_f32 v[22:23], v[22:23], v[30:31]
  s_waitcnt lgkmcnt(0)
  v_pk_add_f32 v[32:33], v[32:33], v[40:41]
  v_pk_add_f32 v[34:35], v[34:35], v[42:43]
  v_pk_add_f32 v[36:37], v[36:37], v[44:45]
  v_pk_add_f32 v[38:39], v[38:39], v[46:47]
  v_pk_add_f32 v[16:17], v[16:17], v[32:33]
  v_pk_add_f32 v[18:19], v[18:19], v[34:35]
  v_pk_add_f32 v[20:21], v[20:21], v[36:37]
  v_pk_add_f32 v[22:23], v[22:23], v[38:39]
  v_cvt_pk_bf16_f32 v28, v16, v17
  v_cvt_pk_bf16_f32 v29, v18, v19
  v_cvt_pk_bf16_f32 v30, v20, v21
  v_cvt_pk_bf16_f32 v31, v22, v23
  v_cndmask_b32 v24, v28, v30, s[56:57]
  v_cndmask_b32 v25, v29, v31, s[56:57]
  v_cndmask_b32 v26, v30, v28, s[56:57]
  v_cndmask_b32 v27, v31, v29, s[56:57]
  buffer_store_dwordx4 v[24:27], v6, s[32:35], s58 offen nt
END:
  s_endpgm
AT_VX:
  v_mov_b64 v[68:69], 0
  v_mov_b64 v[70:71], 0
  v_mov_b64 v[72:73], 0
  v_mov_b64 v[74:75], 0
  v_mov_b64 v[76:77], 0
  v_mov_b64 v[78:79], 0
  v_mov_b64 v[80:81], 0
  v_mov_b64 v[82:83], 0
  s_cmp_ge_u32 s61, 6
  s_cbranch_scc1 AT_VZ
  v_mov_b64 v[84:85], 0
  v_mov_b64 v[86:87], 0
  v_mov_b64 v[88:89], 0
  v_mov_b64 v[90:91], 0
  v_mov_b64 v[92:93], 0
  v_mov_b64 v[94:95], 0
  v_mov_b64 v[96:97], 0
  v_mov_b64 v[98:99], 0
  s_cmp_ge_u32 s61, 4
  s_cbranch_scc1 AT_VZ
  v_mov_b64 v[100:101], 0
  v_mov_b64 v[102:103], 0
  v_mov_b64 v[104:105], 0
  v_mov_b64 v[106:107], 0
  v_mov_b64 v[108:109], 0
  v_mov_b64 v[110:111], 0
  v_mov_b64 v[112:113], 0
  v_mov_b64 v[114:115], 0
  s_cmp_ge_u32 s61, 2
  s_cbranch_scc1 AT_VZ
  v_mov_b64 v[116:117], 0
  v_mov_b64 v[118:119], 0
  v_mov_b64 v[120:121], 0
  v_mov_b64 v[122:123], 0
  v_mov_b64 v[124:125], 0
  v_mov_b64 v[126:127], 0
  v_mov_b64 v[128:129], 0
  v_mov_b64 v[130:131], 0
  s_branch AT_VZ
AT_FX0:
  s_nop 9
  v_mov_b32 v148, v7
  v_mov_b32 v149, v7
  v_mov_b32 v150, v7
  v_mov_b32 v151, v7
  v_mov_b32 v152, v7
  v_mov_b32 v153, v7
  v_mov_b32 v154, v7
  v_mov_b32 v155, v7
  v_mov_b32 v156, v7
  v_mov_b32 v157, v7
  v_mov_b32 v158, v7
  v_mov_b32 v159, v7
  v_mov_b32 v160, v7
  v_mov_b32 v161, v7
  v_mov_b32 v162, v7
  v_mov_b32 v163, v7
  s_branch AT_FO0
AT_FX1:
  s_nop 0
  v_mov_b32 v148, v7
  v_mov_b32 v149, v7
  v_mov_b32 v150, v7
  v_mov_b32 v151, v7
  v_mov_b32 v152, v7
  v_mov_b32 v153, v7
  v_mov_b32 v154, v7
  v_mov_b32 v155, v7
  v_mov_b32 v156, v7
  v_mov_b32 v157, v7
  v_mov_b32 v158, v7
  v_mov_b32 v159, v7
  v_mov_b32 v160, v7
  v_mov_b32 v161, v7
  v_mov_b32 v162, v7
  v_mov_b32_e64 v163, v7
  s_branch AT_FO1
AT_SLOW:
  s_add_u32 s58, s61, 0
  v_mfma_f32_32x32x16_bf16 v[164:179], v[60:63], v[20:23], 0
  v_mfma_f32_32x32x16_bf16 v[180:195], v[28:31], v[20:23], 0
  v_mfma_f32_32x32x16_bf16 v[196:211], v[56:59], v[20:23], 0
  v_mfma_f32_32x32x16_bf16 v[212:227], v[52:55], v[20:23], 0
  s_cmp_ge_u32 s58, 8
  s_cbranch_scc1 AT_OLD0
  s_nop 7
  v_mov_b32 v180, v7
  v_mov_b32 v181, v7
  v_mov_b32 v182, v7
  v_mov_b32 v183, v7
  v_mov_b32 v184, v7
  v_mov_b32 v185, v7
  v_mov_b32 v186, v7
  v_mov_b32 v187, v7
  v_mov_b32 v188, v7
  v_mov_b32 v189, v7
  v_mov_b32 v190, v7
  v_mov_b32 v191, v7
  v_mov_b32 v192, v7
  v_mov_b32 v193, v7
  v_mov_b32 v194, v7
  v_mov_b32 v195, v7
AT_OLD0:
  s_nop 7
  v_cndmask_b32 v148, v180, v164, s[64:65]
  v_cndmask_b32 v149, v181, v165, s[66:67]
  v_cndmask_b32 v150, v182, v166, s[68:69]
  v_cndmask_b32 v151, v183, v167, s[70:71]
  v_cndmask_b32 v152, v184, v168, s[72:73]
  v_cndmask_b32 v153, v185, v169, s[74:75]
  v_cndmask_b32 v154, v186, v170, s[76:77]
  v_cndmask_b32 v155, v187, v171, s[78:79]
  v_cndmask_b32 v156, v188, v172, s[80:81]
  v_cndmask_b32 v157, v189, v173, s[82:83]
  v_cndmask_b32 v158, v190, v174, s[84:85]
  v_cndmask_b32 v159, v191, v175, s[86:87]
  v_cndmask_b32 v160, v192, v176, s[88:89]
  v_cndmask_b32 v161, v193, v177, s[90:91]
  v_cndmask_b32 v162, v194, v178, s[92:93]
  v_cndmask_b32 v163, v195, v179, s[94:95]
  v_max3_f32 v5, v148, v149, v150
  v_max3_f32 v6, v151, v152, v153
  v_max3_f32 v5, v5, v154, v155
  v_max3_f32 v6, v6, v156, v157
  v_max3_f32 v5, v5, v158, v159
  v_max3_f32 v6, v6, v160, v161
  v_max3_f32 v5, v5, v162, v163
  s_cmp_lt_u32 s58, 1
  s_cbranch_scc1 AT_MX0
  v_mfma_f32_32x32x16_bf16 v[164:179], v[48:51], v[20:23], 0
  v_max3_f32 v5, v5, v196, v197
  v_max3_f32 v6, v6, v198, v199
  v_max3_f32 v5, v5, v200, v201
  v_max3_f32 v6, v6, v202, v203
  v_max3_f32 v5, v5, v204, v205
  v_max3_f32 v6, v6, v206, v207
  v_max3_f32 v5, v5, v208, v209
  v_max3_f32 v6, v6, v210, v211
  s_cmp_lt_u32 s58, 2
  s_cbranch_scc1 AT_MX0
  v_mfma_f32_32x32x16_bf16 v[180:195], v[44:47], v[20:23], 0
  v_max3_f32 v5, v5, v212, v213
  v_max3_f32 v6, v6, v214, v215
  v_max3_f32 v5, v5, v216, v217
  v_max3_f32 v6, v6, v218, v219
  v_max3_f32 v5, v5, v220, v221
  v_max3_f32 v6, v6, v222, v223
  v_max3_f32 v5, v5, v224, v225
  v_max3_f32 v6, v6, v226, v227
  s_cmp_lt_u32 s58, 3
  s_cbranch_scc1 AT_MX0
  v_mfma_f32_32x32x16_bf16 v[196:211], v[40:43], v[20:23], 0
  v_max3_f32 v5, v5, v164, v165
  v_max3_f32 v6, v6, v166, v167
  v_max3_f32 v5, v5, v168, v169
  v_max3_f32 v6, v6, v170, v171
  v_max3_f32 v5, v5, v172, v173
  v_max3_f32 v6, v6, v174, v175
  v_max3_f32 v5, v5, v176, v177
  v_max3_f32 v6, v6, v178, v179
  s_cmp_lt_u32 s58, 4
  s_cbranch_scc1 AT_MX0
  v_mfma_f32_32x32x16_bf16 v[212:227], v[36:39], v[20:23], 0
  v_max3_f32 v5, v5, v180, v181
  v_max3_f32 v6, v6, v182, v183
  v_max3_f32 v5, v5, v184, v185
  v_max3_f32 v6, v6, v186, v187
  v_max3_f32 v5, v5, v188, v189
  v_max3_f32 v6, v6, v190, v191
  v_max3_f32 v5, v5, v192, v193
  v_max3_f32 v6, v6, v194, v195
  s_cmp_lt_u32 s58, 5
  s_cbranch_scc1 AT_MX0
  v_mfma_f32_32x32x16_bf16 v[164:179], v[32:35], v[20:23], 0
  v_max3_f32 v5, v5, v196, v197
  v_max3_f32 v6, v6, v198, v199
  v_max3_f32 v5, v5, v200, v201
  v_max3_f32 v6, v6, v202, v203
  v_max3_f32 v5, v5, v204, v205
  v_max3_f32 v6, v6, v206, v207
  v_max3_f32 v5, v5, v208, v209
  v_max3_f32 v6, v6, v210, v211
  s_cmp_lt_u32 s58, 6
  s_cbranch_scc1 AT_MX0
  v_max3_f32 v5, v5, v212, v213
  v_max3_f32 v6, v6, v214, v215
  v_max3_f32 v5, v5, v216, v217
  v_max3_f32 v6, v6, v218, v219
  v_max3_f32 v5, v5, v220, v221
  v_max3_f32 v6, v6, v222, v223
  v_max3_f32 v5, v5, v224, v225
  v_max3_f32 v6, v6, v226, v227
  s_cmp_lt_u32 s58, 7
  s_cbranch_scc1 AT_MX0
  v_max3_f32 v5, v5, v164, v165
  v_max3_f32 v6, v6, v166, v167
  v_max3_f32 v5, v5, v168, v169
  v_max3_f32 v6, v6, v170, v171
  v_max3_f32 v5, v5, v172, v173
  v_max3_f32 v6, v6, v174, v175
  v_max3_f32 v5, v5, v176, v177
  v_max3_f32 v6, v6, v178, v179
AT_MX0:
  v_max_f32_e64 v5, v5, v6
  v_mov_b32 v6, v5
  s_lshl_b32 s52, s45, 2
  v_add_u32 v3, s52, v247
  s_waitcnt vmcnt(0)
  ds_write_b32 v3, v248 offset:16
  v_permlane32_swap_b32 v5, v6
  v_max_f32 v5, v5, v6
  v_sub_f32 v196, 0, v5
  v_mov_b32 v197, v196
  v_mov_b64 v[198:199], v[196:197]
  v_mov_b64 v[200:201], v[196:197]
  v_mov_b64 v[202:203], v[196:197]
  v_mov_b64 v[204:205], v[196:197]
  v_mov_b64 v[206:207], v[196:197]
  v_mov_b64 v[208:209], v[196:197]
  v_mov_b64 v[210:211], v[196:197]
  v_sub_f32 v148, v148, v5
  v_sub_f32_e64 v149, v149, v5
  v_mfma_f32_32x32x16_bf16 v[180:195], v[56:59], v[20:23], v[196:211]
  v_sub_f32 v150, v150, v5
  v_sub_f32 v151, v151, v5
  v_sub_f32 v152, v152, v5
  v_sub_f32 v153, v153, v5
  v_sub_f32 v154, v154, v5
  v_sub_f32 v155, v155, v5
  v_sub_f32 v156, v156, v5
  v_sub_f32 v157, v157, v5
  v_sub_f32 v158, v158, v5
  v_sub_f32 v159, v159, v5
  v_sub_f32 v160, v160, v5
  v_sub_f32 v161, v161, v5
  v_sub_f32 v162, v162, v5
  v_sub_f32 v163, v163, v5
  v_exp_f32 v148, v148
  v_exp_f32 v149, v149
  v_exp_f32 v150, v150
  v_exp_f32 v151, v151
  v_exp_f32 v152, v152
  v_exp_f32 v153, v153
  v_exp_f32 v154, v154
  v_exp_f32 v155, v155
  v_exp_f32 v156, v156
  v_exp_f32 v157, v157
  v_exp_f32 v158, v158
  v_exp_f32 v159, v159
  v_exp_f32 v160, v160
  v_exp_f32 v161, v161
  v_exp_f32 v162, v162
  v_exp_f32 v163, v163
  v_cvt_pk_bf16_f32 v236, v148, v149
  v_cvt_pk_bf16_f32 v237, v150, v151
  v_cvt_pk_bf16_f32 v238, v152, v153
  v_cvt_pk_bf16_f32 v239, v154, v155
  v_cvt_pk_bf16_f32 v240, v156, v157
  v_cvt_pk_bf16_f32 v241, v158, v159
  v_cvt_pk_bf16_f32 v242, v160, v161
  v_cvt_pk_bf16_f32 v243, v162, v163
  v_and_b32 v228, v236, v12
  v_and_b32 v229, v237, v13
  v_and_b32 v230, v238, v14
  v_and_b32 v231, v239, v15
  v_and_b32 v232, v240, v16
  v_and_b32 v233, v241, v17
  v_and_b32 v234, v242, v18
  v_and_b32 v235, v243, v19
  v_mfma_f32_32x32x16_bf16 v[212:227], v[132:135], v[228:231], 0
  v_xor_b32 v236, v236, v228
  v_xor_b32 v237, v237, v229
  v_xor_b32 v238, v238, v230
  v_xor_b32 v239, v239, v231
  v_mfma_f32_32x32x16_bf16 v[212:227], v[136:139], v[232:235], v[212:227]
  v_xor_b32 v240, v240, v232
  v_xor_b32 v241, v241, v233
  v_xor_b32 v242, v242, v234
  v_xor_b32 v243, v243, v235
  v_mfma_f32_32x32x16_bf16 v[212:227], v[68:71], v[236:239], v[212:227]
  s_nop 0
  v_mfma_f32_32x32x16_bf16 v[212:227], v[72:75], v[240:243], v[212:227]
  s_cmp_lt_u32 s58, 1
  s_cbranch_scc1 AT_FIN0
  v_exp_f32 v180, v180
  v_exp_f32 v181, v181
  v_exp_f32 v182, v182
  v_exp_f32_e64 v183, v183
  v_mfma_f32_32x32x16_bf16 v[164:179], v[52:55], v[20:23], v[196:211]
  v_exp_f32 v184, v184
  v_exp_f32 v185, v185
  v_exp_f32 v186, v186
  v_exp_f32 v187, v187
  v_exp_f32_e64 v188, v188
  v_cvt_pk_bf16_f32 v228, v180, v181
  v_cvt_pk_bf16_f32 v229, v182, v183
  v_cvt_pk_bf16_f32 v230, v184, v185
  v_cvt_pk_bf16_f32 v231, v186, v187
  v_exp_f32 v189, v189
  v_exp_f32 v190, v190
  v_mfma_f32_32x32x16_bf16 v[212:227], v[124:127], v[228:231], v[212:227]
  v_exp_f32 v191, v191
  v_exp_f32 v192, v192
  v_exp_f32 v193, v193
  v_exp_f32 v194, v194
  v_exp_f32_e64 v195, v195
  v_cvt_pk_bf16_f32 v232, v188, v189
  v_cvt_pk_bf16_f32 v233, v190, v191
  v_cvt_pk_bf16_f32 v234, v192, v193
  v_cvt_pk_bf16_f32 v235, v194, v195
  s_nop 1
  v_mfma_f32_32x32x16_bf16 v[212:227], v[128:131], v[232:235], v[212:227]
  s_cmp_lt_u32 s58, 2
  s_cbranch_scc1 AT_FIN0
  v_exp_f32 v164, v164
  v_exp_f32 v165, v165
  v_exp_f32 v166, v166
  v_exp_f32_e64 v167, v167
  v_mfma_f32_32x32x16_bf16 v[180:195], v[48:51], v[20:23], v[196:211]
  v_exp_f32 v168, v168
  v_exp_f32 v169, v169
  v_exp_f32 v170, v170
  v_exp_f32 v171, v171
  v_exp_f32_e64 v172, v172
  v_cvt_pk_bf16_f32 v236, v164, v165
  v_cvt_pk_bf16_f32 v237, v166, v167
  v_cvt_pk_bf16_f32 v238, v168, v169
  v_cvt_pk_bf16_f32 v239, v170, v171
  v_exp_f32 v173, v173
  v_exp_f32 v174, v174
  v_mfma_f32_32x32x16_bf16 v[212:227], v[116:119], v[236:239], v[212:227]
  v_exp_f32 v175, v175
  v_exp_f32 v176, v176
  v_exp_f32 v177, v177
  v_exp_f32 v178, v178
  v_exp_f32_e64 v179, v179
  v_cvt_pk_bf16_f32 v240, v172, v173
  v_cvt_pk_bf16_f32 v241, v174, v175
  v_cvt_pk_bf16_f32 v242, v176, v177
  v_cvt_pk_bf16_f32 v243, v178, v179
  s_nop 1
  v_mfma_f32_32x32x16_bf16 v[212:227], v[120:123], v[240:243], v[212:227]
  s_cmp_lt_u32 s58, 3
  s_cbranch_scc1 AT_FIN0
  v_exp_f32 v180, v180
  v_exp_f32 v181, v181
  v_exp_f32 v182, v182
  v_exp_f32_e64 v183, v183
  v_mfma_f32_32x32x16_bf16 v[164:179], v[44:47], v[20:23], v[196:211]
  v_exp_f32 v184, v184
  v_exp_f32 v185, v185
  v_exp_f32 v186, v186
  v_exp_f32 v187, v187
  v_exp_f32_e64 v188, v188
  v_cvt_pk_bf16_f32 v228, v180, v181
  v_cvt_pk_bf16_f32 v229, v182, v183
  v_cvt_pk_bf16_f32 v230, v184, v185
  v_cvt_pk_bf16_f32 v231, v186, v187
  v_exp_f32 v189, v189
  v_exp_f32 v190, v190
  v_mfma_f32_32x32x16_bf16 v[212:227], v[108:111], v[228:231], v[212:227]
  v_exp_f32 v191, v191
  v_exp_f32 v192, v192
  v_exp_f32 v193, v193
  v_exp_f32 v194, v194
  v_exp_f32_e64 v195, v195
  v_cvt_pk_bf16_f32 v232, v188, v189
  v_cvt_pk_bf16_f32 v233, v190, v191
  v_cvt_pk_bf16_f32 v234, v192, v193
  v_cvt_pk_bf16_f32 v235, v194, v195
  s_nop 1
  v_mfma_f32_32x32x16_bf16 v[212:227], v[112:115], v[232:235], v[212:227]
  s_cmp_lt_u32 s58, 4
  s_cbranch_scc1 AT_FIN0
  v_exp_f32 v164, v164
  v_exp_f32 v165, v165
  v_exp_f32 v166, v166
  v_exp_f32_e64 v167, v167
  v_mfma_f32_32x32x16_bf16 v[180:195], v[40:43], v[20:23], v[196:211]
  v_exp_f32 v168, v168
  v_exp_f32 v169, v169
  v_exp_f32 v170, v170
  v_exp_f32 v171, v171
  v_exp_f32_e64 v172, v172
  v_cvt_pk_bf16_f32 v236, v164, v165
  v_cvt_pk_bf16_f32 v237, v166, v167
  v_cvt_pk_bf16_f32 v238, v168, v169
  v_cvt_pk_bf16_f32 v239, v170, v171
  v_exp_f32 v173, v173
  v_exp_f32 v174, v174
  v_mfma_f32_32x32x16_bf16 v[212:227], v[100:103], v[236:239], v[212:227]
  v_exp_f32 v175, v175
  v_exp_f32 v176, v176
  v_exp_f32 v177, v177
  v_exp_f32 v178, v178
  v_exp_f32_e64 v179, v179
  v_cvt_pk_bf16_f32 v240, v172, v173
  v_cvt_pk_bf16_f32 v241, v174, v175
  v_cvt_pk_bf16_f32 v242, v176, v177
  v_cvt_pk_bf16_f32 v243, v178, v179
  s_nop 1
  v_mfma_f32_32x32x16_bf16 v[212:227], v[104:107], v[240:243], v[212:227]
  s_cmp_lt_u32 s58, 5
  s_cbranch_scc1 AT_FIN0
  v_exp_f32 v180, v180
  v_exp_f32 v181, v181
  v_exp_f32 v182, v182
  v_exp_f32_e64 v183, v183
  v_mfma_f32_32x32x16_bf16 v[164:179], v[36:39], v[20:23], v[196:211]
  v_exp_f32 v184, v184
  v_exp_f32 v185, v185
  v_exp_f32 v186, v186
  v_exp_f32 v187, v187
  v_exp_f32_e64 v188, v188
  v_cvt_pk_bf16_f32 v228, v180, v181
  v_cvt_pk_bf16_f32 v229, v182, v183
  v_cvt_pk_bf16_f32 v230, v184, v185
  v_cvt_pk_bf16_f32 v231, v186, v187
  v_exp_f32 v189, v189
  v_exp_f32 v190, v190
  v_mfma_f32_32x32x16_bf16 v[212:227], v[92:95], v[228:231], v[212:227]
  v_exp_f32 v191, v191
  v_exp_f32 v192, v192
  v_exp_f32 v193, v193
  v_exp_f32 v194, v194
  v_exp_f32_e64 v195, v195
  v_cvt_pk_bf16_f32 v232, v188, v189
  v_cvt_pk_bf16_f32 v233, v190, v191
  v_cvt_pk_bf16_f32 v234, v192, v193
  v_cvt_pk_bf16_f32 v235, v194, v195
  s_nop 1
  v_mfma_f32_32x32x16_bf16 v[212:227], v[96:99], v[232:235], v[212:227]
  s_cmp_lt_u32 s58, 6
  s_cbranch_scc1 AT_FIN0
  v_exp_f32 v164, v164
  v_exp_f32 v165, v165
  v_exp_f32 v166, v166
  v_exp_f32_e64 v167, v167
  v_mfma_f32_32x32x16_bf16 v[180:195], v[32:35], v[20:23], v[196:211]
  v_exp_f32 v168, v168
  v_exp_f32 v169, v169
  v_exp_f32 v170, v170
  v_exp_f32 v171, v171
  v_exp_f32_e64 v172, v172
  v_cvt_pk_bf16_f32 v236, v164, v165
  v_cvt_pk_bf16_f32 v237, v166, v167
  v_cvt_pk_bf16_f32 v238, v168, v169
  v_cvt_pk_bf16_f32 v239, v170, v171
  v_exp_f32 v173, v173
  v_exp_f32 v174, v174
  v_mfma_f32_32x32x16_bf16 v[212:227], v[84:87], v[236:239], v[212:227]
  v_exp_f32 v175, v175
  v_exp_f32 v176, v176
  v_exp_f32 v177, v177
  v_exp_f32 v178, v178
  v_exp_f32_e64 v179, v179
  v_cvt_pk_bf16_f32 v240, v172, v173
  v_cvt_pk_bf16_f32 v241, v174, v175
  v_cvt_pk_bf16_f32 v242, v176, v177
  v_cvt_pk_bf16_f32 v243, v178, v179
  s_nop 1
  v_mfma_f32_32x32x16_bf16 v[212:227], v[88:91], v[240:243], v[212:227]
  s_cmp_lt_u32 s58, 7
  s_cbranch_scc1 AT_FIN0
  v_exp_f32 v180, v180
  v_exp_f32 v181, v181
  v_exp_f32 v182, v182
  v_exp_f32 v183, v183
  v_exp_f32 v184, v184
  v_exp_f32 v185, v185
  v_exp_f32 v186, v186
  v_exp_f32 v187, v187
  v_exp_f32 v188, v188
  v_cvt_pk_bf16_f32 v228, v180, v181
  v_cvt_pk_bf16_f32 v229, v182, v183
  v_cvt_pk_bf16_f32 v230, v184, v185
  v_cvt_pk_bf16_f32 v231, v186, v187
  v_exp_f32 v189, v189
  v_exp_f32 v190, v190
  v_mfma_f32_32x32x16_bf16 v[212:227], v[76:79], v[228:231], v[212:227]
  v_exp_f32 v191, v191
  v_exp_f32 v192, v192
  v_exp_f32 v193, v193
  v_exp_f32 v194, v194
  v_exp_f32_e64 v195, v195
  v_cvt_pk_bf16_f32 v232, v188, v189
  v_cvt_pk_bf16_f32 v233, v190, v191
  v_cvt_pk_bf16_f32 v234, v192, v193
  v_cvt_pk_bf16_f32 v235, v194, v195
  s_nop 1
  v_mfma_f32_32x32x16_bf16 v[212:227], v[80:83], v[232:235], v[212:227]
AT_FIN0:
  s_lshl_b32 s50, s58, 10
  s_lshl_b32 s51, s100, 16
  s_add_u32 s50, s50, s51
  s_nop 8
  v_rcp_f32 v3, v220
  s_nop 0
  v_mul_f32 v3, v3, v8
  v_mul_f32 v212, v212, v3
  v_mul_f32 v213, v213, v3
  v_mul_f32 v214, v214, v3
  v_mul_f32 v215, v215, v3
  v_mul_f32 v216, v216, v3
  v_mul_f32 v217, v217, v3
  v_mul_f32 v218, v218, v3
  v_mul_f32 v219, v219, v3
  v_add_u32 v212, 0x10000, v212
  v_and_b32 v212, 0xfffe0000, v212
  v_cvt_pk_bf16_f32 v148, v212, v213
  v_cvt_pk_bf16_f32 v149, v214, v215
  v_cvt_pk_bf16_f32 v150, v216, v217
  v_cvt_pk_bf16_f32 v151, v218, v219
  v_and_b32_e64 v148, -2, v148
  buffer_store_dwordx4 v[148:151], v0, s[4:7], s50 offen sc1
  s_add_u32 s58, s61, 1
  v_mfma_f32_32x32x16_bf16 v[164:179], v[64:67], v[24:27], 0
  v_mfma_f32_32x32x16_bf16 v[180:195], v[32:35], v[24:27], 0
  v_mfma_f32_32x32x16_bf16 v[196:211], v[60:63], v[24:27], 0
  v_mfma_f32_32x32x16_bf16 v[212:227], v[56:59], v[24:27], 0
  s_cmp_ge_u32 s58, 8
  s_cbranch_scc1 AT_OLD1
  s_nop 7
  v_mov_b32 v180, v7
  v_mov_b32 v181, v7
  v_mov_b32 v182, v7
  v_mov_b32 v183, v7
  v_mov_b32 v184, v7
  v_mov_b32 v185, v7
  v_mov_b32 v186, v7
  v_mov_b32 v187, v7
  v_mov_b32 v188, v7
  v_mov_b32 v189, v7
  v_mov_b32 v190, v7
  v_mov_b32 v191, v7
  v_mov_b32 v192, v7
  v_mov_b32 v193, v7
  v_mov_b32_e64 v194, v7
  v_mov_b32 v195, v7
AT_OLD1:
  s_nop 7
  v_cndmask_b32 v148, v180, v164, s[64:65]
  v_cndmask_b32 v149, v181, v165, s[66:67]
  v_cndmask_b32 v150, v182, v166, s[68:69]
  v_cndmask_b32 v151, v183, v167, s[70:71]
  v_cndmask_b32 v152, v184, v168, s[72:73]
  v_cndmask_b32 v153, v185, v169, s[74:75]
  v_cndmask_b32 v154, v186, v170, s[76:77]
  v_cndmask_b32 v155, v187, v171, s[78:79]
  v_cndmask_b32 v156, v188, v172, s[80:81]
  v_cndmask_b32 v157, v189, v173, s[82:83]
  v_cndmask_b32 v158, v190, v174, s[84:85]
  v_cndmask_b32 v159, v191, v175, s[86:87]
  v_cndmask_b32 v160, v192, v176, s[88:89]
  v_cndmask_b32 v161, v193, v177, s[90:91]
  v_cndmask_b32 v162, v194, v178, s[92:93]
  v_cndmask_b32 v163, v195, v179, s[94:95]
  v_max3_f32 v5, v148, v149, v150
  v_max3_f32 v6, v151, v152, v153
  v_max3_f32 v5, v5, v154, v155
  v_max3_f32 v6, v6, v156, v157
  v_max3_f32 v5, v5, v158, v159
  v_max3_f32 v6, v6, v160, v161
  v_max3_f32 v5, v5, v162, v163
  s_cmp_lt_u32 s58, 1
  s_cbranch_scc1 AT_MX1
  v_mfma_f32_32x32x16_bf16 v[164:179], v[52:55], v[24:27], 0
  v_max3_f32 v5, v5, v196, v197
  v_max3_f32 v6, v6, v198, v199
  v_max3_f32 v5, v5, v200, v201
  v_max3_f32 v6, v6, v202, v203
  v_max3_f32 v5, v5, v204, v205
  v_max3_f32 v6, v6, v206, v207
  v_max3_f32 v5, v5, v208, v209
  v_max3_f32 v6, v6, v210, v211
  s_cmp_lt_u32 s58, 2
  s_cbranch_scc1 AT_MX1
  v_mfma_f32_32x32x16_bf16 v[180:195], v[48:51], v[24:27], 0
  v_max3_f32 v5, v5, v212, v213
  v_max3_f32 v6, v6, v214, v215
  v_max3_f32 v5, v5, v216, v217
  v_max3_f32 v6, v6, v218, v219
  v_max3_f32 v5, v5, v220, v221
  v_max3_f32 v6, v6, v222, v223
  v_max3_f32 v5, v5, v224, v225
  v_max3_f32 v6, v6, v226, v227
  s_cmp_lt_u32 s58, 3
  s_cbranch_scc1 AT_MX1
  v_mfma_f32_32x32x16_bf16 v[196:211], v[44:47], v[24:27], 0
  v_max3_f32 v5, v5, v164, v165
  v_max3_f32 v6, v6, v166, v167
  v_max3_f32 v5, v5, v168, v169
  v_max3_f32 v6, v6, v170, v171
  v_max3_f32 v5, v5, v172, v173
  v_max3_f32 v6, v6, v174, v175
  v_max3_f32 v5, v5, v176, v177
  v_max3_f32 v6, v6, v178, v179
  s_cmp_lt_u32 s58, 4
  s_cbranch_scc1 AT_MX1
  v_mfma_f32_32x32x16_bf16 v[212:227], v[40:43], v[24:27], 0
  v_max3_f32 v5, v5, v180, v181
  v_max3_f32 v6, v6, v182, v183
  v_max3_f32 v5, v5, v184, v185
  v_max3_f32 v6, v6, v186, v187
  v_max3_f32 v5, v5, v188, v189
  v_max3_f32 v6, v6, v190, v191
  v_max3_f32 v5, v5, v192, v193
  v_max3_f32 v6, v6, v194, v195
  s_cmp_lt_u32 s58, 5
  s_cbranch_scc1 AT_MX1
  v_mfma_f32_32x32x16_bf16 v[164:179], v[36:39], v[24:27], 0
  v_max3_f32 v5, v5, v196, v197
  v_max3_f32 v6, v6, v198, v199
  v_max3_f32 v5, v5, v200, v201
  v_max3_f32 v6, v6, v202, v203
  v_max3_f32 v5, v5, v204, v205
  v_max3_f32 v6, v6, v206, v207
  v_max3_f32 v5, v5, v208, v209
  v_max3_f32 v6, v6, v210, v211
  s_cmp_lt_u32 s58, 6
  s_cbranch_scc1 AT_MX1
  v_max3_f32 v5, v5, v212, v213
  v_max3_f32 v6, v6, v214, v215
  v_max3_f32 v5, v5, v216, v217
  v_max3_f32 v6, v6, v218, v219
  v_max3_f32 v5, v5, v220, v221
  v_max3_f32 v6, v6, v222, v223
  v_max3_f32 v5, v5, v224, v225
  v_max3_f32 v6, v6, v226, v227
  s_cmp_lt_u32 s58, 7
  s_cbranch_scc1 AT_MX1
  v_max3_f32 v5, v5, v164, v165
  v_max3_f32 v6, v6, v166, v167
  v_max3_f32 v5, v5, v168, v169
  v_max3_f32 v6, v6, v170, v171
  v_max3_f32 v5, v5, v172, v173
  v_max3_f32 v6, v6, v174, v175
  v_max3_f32 v5, v5, v176, v177
  v_max3_f32 v6, v6, v178, v179
AT_MX1:
  v_max_f32 v5, v5, v6
  v_mov_b32 v6, v5
  s_nop 1
  v_permlane32_swap_b32 v5, v6
  v_max_f32 v5, v5, v6
  v_sub_f32 v196, 0, v5
  v_mov_b32 v197, v196
  v_mov_b64 v[198:199], v[196:197]
  v_mov_b64 v[200:201], v[196:197]
  v_mov_b64 v[202:203], v[196:197]
  v_mov_b64 v[204:205], v[196:197]
  v_mov_b64 v[206:207], v[196:197]
  v_mov_b64 v[208:209], v[196:197]
  v_mov_b64 v[210:211], v[196:197]
  v_sub_f32 v148, v148, v5
  v_sub_f32 v149, v149, v5
  v_mfma_f32_32x32x16_bf16 v[180:195], v[60:63], v[24:27], v[196:211]
  v_sub_f32 v150, v150, v5
  v_sub_f32 v151, v151, v5
  v_sub_f32 v152, v152, v5
  v_sub_f32 v153, v153, v5
  v_sub_f32 v154, v154, v5
  v_sub_f32 v155, v155, v5
  v_sub_f32 v156, v156, v5
  v_sub_f32 v157, v157, v5
  v_sub_f32 v158, v158, v5
  v_sub_f32 v159, v159, v5
  v_sub_f32 v160, v160, v5
  v_sub_f32 v161, v161, v5
  v_sub_f32 v162, v162, v5
  v_sub_f32 v163, v163, v5
  v_exp_f32 v148, v148
  v_exp_f32 v149, v149
  v_exp_f32 v150, v150
  v_exp_f32 v151, v151
  v_exp_f32 v152, v152
  v_exp_f32 v153, v153
  v_exp_f32 v154, v154
  v_exp_f32 v155, v155
  v_exp_f32 v156, v156
  v_exp_f32 v157, v157
  v_exp_f32 v158, v158
  v_exp_f32 v159, v159
  v_exp_f32 v160, v160
  v_exp_f32 v161, v161
  v_exp_f32 v162, v162
  v_exp_f32 v163, v163
  v_cvt_pk_bf16_f32 v236, v148, v149
  v_cvt_pk_bf16_f32 v237, v150, v151
  v_cvt_pk_bf16_f32 v238, v152, v153
  v_cvt_pk_bf16_f32 v239, v154, v155
  v_cvt_pk_bf16_f32 v240, v156, v157
  v_cvt_pk_bf16_f32 v241, v158, v159
  v_cvt_pk_bf16_f32 v242, v160, v161
  v_cvt_pk_bf16_f32 v243, v162, v163
  v_and_b32 v228, v236, v12
  v_and_b32 v229, v237, v13
  v_and_b32 v230, v238, v14
  v_and_b32 v231, v239, v15
  v_and_b32 v232, v240, v16
  v_and_b32 v233, v241, v17
  v_and_b32 v234, v242, v18
  v_and_b32 v235, v243, v19
  v_mfma_f32_32x32x16_bf16 v[212:227], v[140:143], v[228:231], 0
  v_xor_b32 v236, v236, v228
  v_xor_b32 v237, v237, v229
  v_xor_b32 v238, v238, v230
  v_xor_b32 v239, v239, v231
  v_mfma_f32_32x32x16_bf16 v[212:227], v[144:147], v[232:235], v[212:227]
  v_xor_b32 v240, v240, v232
  v_xor_b32 v241, v241, v233
  v_xor_b32 v242, v242, v234
  v_xor_b32 v243, v243, v235
  v_mfma_f32_32x32x16_bf16 v[212:227], v[76:79], v[236:239], v[212:227]
  s_nop 0
  v_mfma_f32_32x32x16_bf16 v[212:227], v[80:83], v[240:243], v[212:227]
  s_cmp_lt_u32 s58, 1
  s_cbranch_scc1 AT_FIN1
  v_exp_f32 v180, v180
  v_exp_f32 v181, v181
  v_exp_f32 v182, v182
  v_exp_f32_e64 v183, v183
  v_mfma_f32_32x32x16_bf16 v[164:179], v[56:59], v[24:27], v[196:211]
  v_exp_f32 v184, v184
  v_exp_f32 v185, v185
  v_exp_f32 v186, v186
  v_exp_f32 v187, v187
  v_exp_f32_e64 v188, v188
  v_cvt_pk_bf16_f32 v228, v180, v181
  v_cvt_pk_bf16_f32 v229, v182, v183
  v_cvt_pk_bf16_f32 v230, v184, v185
  v_cvt_pk_bf16_f32 v231, v186, v187
  v_exp_f32 v189, v189
  v_exp_f32 v190, v190
  v_mfma_f32_32x32x16_bf16 v[212:227], v[132:135], v[228:231], v[212:227]
  v_exp_f32 v191, v191
  v_exp_f32 v192, v192
  v_exp_f32 v193, v193
  v_exp_f32 v194, v194
  v_exp_f32_e64 v195, v195
  v_cvt_pk_bf16_f32 v232, v188, v189
  v_cvt_pk_bf16_f32 v233, v190, v191
  v_cvt_pk_bf16_f32 v234, v192, v193
  v_cvt_pk_bf16_f32 v235, v194, v195
  s_nop 1
  v_mfma_f32_32x32x16_bf16 v[212:227], v[136:139], v[232:235], v[212:227]
  s_cmp_lt_u32 s58, 2
  s_cbranch_scc1 AT_FIN1
  v_exp_f32 v164, v164
  v_exp_f32 v165, v165
  v_exp_f32 v166, v166
  v_exp_f32_e64 v167, v167
  v_mfma_f32_32x32x16_bf16 v[180:195], v[52:55], v[24:27], v[196:211]
  v_exp_f32 v168, v168
  v_exp_f32 v169, v169
  v_exp_f32 v170, v170
  v_exp_f32 v171, v171
  v_exp_f32_e64 v172, v172
  v_cvt_pk_bf16_f32 v236, v164, v165
  v_cvt_pk_bf16_f32 v237, v166, v167
  v_cvt_pk_bf16_f32 v238, v168, v169
  v_cvt_pk_bf16_f32 v239, v170, v171
  v_exp_f32 v173, v173
  v_exp_f32 v174, v174
  v_mfma_f32_32x32x16_bf16 v[212:227], v[124:127], v[236:239], v[212:227]
  v_exp_f32 v175, v175
  v_exp_f32 v176, v176
  v_exp_f32 v177, v177
  v_exp_f32 v178, v178
  v_exp_f32_e64 v179, v179
  v_cvt_pk_bf16_f32 v240, v172, v173
  v_cvt_pk_bf16_f32 v241, v174, v175
  v_cvt_pk_bf16_f32 v242, v176, v177
  v_cvt_pk_bf16_f32 v243, v178, v179
  s_nop 1
  v_mfma_f32_32x32x16_bf16 v[212:227], v[128:131], v[240:243], v[212:227]
  s_cmp_lt_u32 s58, 3
  s_cbranch_scc1 AT_FIN1
  v_exp_f32 v180, v180
  v_exp_f32 v181, v181
  v_exp_f32 v182, v182
  v_exp_f32_e64 v183, v183
  v_mfma_f32_32x32x16_bf16 v[164:179], v[48:51], v[24:27], v[196:211]
  v_exp_f32 v184, v184
  v_exp_f32 v185, v185
  v_exp_f32 v186, v186
  v_exp_f32 v187, v187
  v_exp_f32_e64 v188, v188
  v_cvt_pk_bf16_f32 v228, v180, v181
  v_cvt_pk_bf16_f32 v229, v182, v183
  v_cvt_pk_bf16_f32 v230, v184, v185
  v_cvt_pk_bf16_f32 v231, v186, v187
  v_exp_f32 v189, v189
  v_exp_f32 v190, v190
  v_mfma_f32_32x32x16_bf16 v[212:227], v[116:119], v[228:231], v[212:227]
  v_exp_f32 v191, v191
  v_exp_f32 v192, v192
  v_exp_f32 v193, v193
  v_exp_f32 v194, v194
  v_exp_f32_e64 v195, v195
  v_cvt_pk_bf16_f32 v232, v188, v189
  v_cvt_pk_bf16_f32 v233, v190, v191
  v_cvt_pk_bf16_f32 v234, v192, v193
  v_cvt_pk_bf16_f32 v235, v194, v195
  s_nop 1
  v_mfma_f32_32x32x16_bf16 v[212:227], v[120:123], v[232:235], v[212:227]
  s_cmp_lt_u32 s58, 4
  s_cbranch_scc1 AT_FIN1
  v_exp_f32 v164, v164
  v_exp_f32 v165, v165
  v_exp_f32 v166, v166
  v_exp_f32_e64 v167, v167
  v_mfma_f32_32x32x16_bf16 v[180:195], v[44:47], v[24:27], v[196:211]
  v_exp_f32 v168, v168
  v_exp_f32 v169, v169
  v_exp_f32 v170, v170
  v_exp_f32 v171, v171
  v_exp_f32_e64 v172, v172
  v_cvt_pk_bf16_f32 v236, v164, v165
  v_cvt_pk_bf16_f32 v237, v166, v167
  v_cvt_pk_bf16_f32 v238, v168, v169
  v_cvt_pk_bf16_f32 v239, v170, v171
  v_exp_f32 v173, v173
  v_exp_f32 v174, v174
  v_mfma_f32_32x32x16_bf16 v[212:227], v[108:111], v[236:239], v[212:227]
  v_exp_f32 v175, v175
  v_exp_f32 v176, v176
  v_exp_f32 v177, v177
  v_exp_f32 v178, v178
  v_exp_f32_e64 v179, v179
  v_cvt_pk_bf16_f32 v240, v172, v173
  v_cvt_pk_bf16_f32 v241, v174, v175
  v_cvt_pk_bf16_f32 v242, v176, v177
  v_cvt_pk_bf16_f32 v243, v178, v179
  s_nop 1
  v_mfma_f32_32x32x16_bf16 v[212:227], v[112:115], v[240:243], v[212:227]
  s_cmp_lt_u32 s58, 5
  s_cbranch_scc1 AT_FIN1
  v_exp_f32 v180, v180
  v_exp_f32 v181, v181
  v_exp_f32 v182, v182
  v_exp_f32_e64 v183, v183
  v_mfma_f32_32x32x16_bf16 v[164:179], v[40:43], v[24:27], v[196:211]
  v_exp_f32 v184, v184
  v_exp_f32 v185, v185
  v_exp_f32 v186, v186
  v_exp_f32 v187, v187
  v_exp_f32_e64 v188, v188
  v_cvt_pk_bf16_f32 v228, v180, v181
  v_cvt_pk_bf16_f32 v229, v182, v183
  v_cvt_pk_bf16_f32 v230, v184, v185
  v_cvt_pk_bf16_f32 v231, v186, v187
  v_exp_f32 v189, v189
  v_exp_f32 v190, v190
  v_mfma_f32_32x32x16_bf16 v[212:227], v[100:103], v[228:231], v[212:227]
  v_exp_f32 v191, v191
  v_exp_f32 v192, v192
  v_exp_f32 v193, v193
  v_exp_f32 v194, v194
  v_exp_f32_e64 v195, v195
  v_cvt_pk_bf16_f32 v232, v188, v189
  v_cvt_pk_bf16_f32 v233, v190, v191
  v_cvt_pk_bf16_f32 v234, v192, v193
  v_cvt_pk_bf16_f32 v235, v194, v195
  s_nop 1
  v_mfma_f32_32x32x16_bf16 v[212:227], v[104:107], v[232:235], v[212:227]
  s_cmp_lt_u32 s58, 6
  s_cbranch_scc1 AT_FIN1
  v_exp_f32 v164, v164
  v_exp_f32 v165, v165
  v_exp_f32 v166, v166
  v_exp_f32_e64 v167, v167
  v_mfma_f32_32x32x16_bf16 v[180:195], v[36:39], v[24:27], v[196:211]
  v_exp_f32 v168, v168
  v_exp_f32 v169, v169
  v_exp_f32 v170, v170
  v_exp_f32 v171, v171
  v_exp_f32_e64 v172, v172
  v_cvt_pk_bf16_f32 v236, v164, v165
  v_cvt_pk_bf16_f32 v237, v166, v167
  v_cvt_pk_bf16_f32 v238, v168, v169
  v_cvt_pk_bf16_f32 v239, v170, v171
  v_exp_f32 v173, v173
  v_exp_f32 v174, v174
  v_mfma_f32_32x32x16_bf16 v[212:227], v[92:95], v[236:239], v[212:227]
  v_exp_f32 v175, v175
  v_exp_f32 v176, v176
  v_exp_f32 v177, v177
  v_exp_f32 v178, v178
  v_exp_f32_e64 v179, v179
  v_cvt_pk_bf16_f32 v240, v172, v173
  v_cvt_pk_bf16_f32 v241, v174, v175
  v_cvt_pk_bf16_f32 v242, v176, v177
  v_cvt_pk_bf16_f32 v243, v178, v179
  s_nop 1
  v_mfma_f32_32x32x16_bf16 v[212:227], v[96:99], v[240:243], v[212:227]
  s_cmp_lt_u32 s58, 7
  s_cbranch_scc1 AT_FIN1
  v_exp_f32 v180, v180
  v_exp_f32 v181, v181
  v_exp_f32 v182, v182
  v_exp_f32 v183, v183
  v_exp_f32 v184, v184
  v_exp_f32 v185, v185
  v_exp_f32 v186, v186
  v_exp_f32 v187, v187
  v_exp_f32 v188, v188
  v_cvt_pk_bf16_f32 v228, v180, v181
  v_cvt_pk_bf16_f32 v229, v182, v183
  v_cvt_pk_bf16_f32 v230, v184, v185
  v_cvt_pk_bf16_f32 v231, v186, v187
  v_exp_f32 v189, v189
  v_exp_f32 v190, v190
  v_mfma_f32_32x32x16_bf16 v[212:227], v[84:87], v[228:231], v[212:227]
  v_exp_f32 v191, v191
  v_exp_f32 v192, v192
  v_exp_f32 v193, v193
  v_exp_f32 v194, v194
  v_exp_f32_e64 v195, v195
  v_cvt_pk_bf16_f32 v232, v188, v189
  v_cvt_pk_bf16_f32 v233, v190, v191
  v_cvt_pk_bf16_f32 v234, v192, v193
  v_cvt_pk_bf16_f32 v235, v194, v195
  s_nop 1
  v_mfma_f32_32x32x16_bf16 v[212:227], v[88:91], v[232:235], v[212:227]
AT_FIN1:
  s_lshl_b32 s50, s58, 10
  s_lshl_b32 s51, s100, 16
  s_add_u32 s50, s50, s51
  s_nop 8
  v_rcp_f32 v3, v220
  s_nop 0
  v_mul_f32 v3, v3, v9
  v_mul_f32 v212, v212, v3
  v_mul_f32 v213, v213, v3
  v_mul_f32 v214, v214, v3
  v_mul_f32 v215, v215, v3
  v_mul_f32 v216, v216, v3
  v_mul_f32 v217, v217, v3
  v_mul_f32 v218, v218, v3
  v_mul_f32 v219, v219, v3
  v_add_u32 v212, 0x10000, v212
  v_and_b32 v212, 0xfffe0000, v212
  v_cvt_pk_bf16_f32 v148, v212, v213
  v_cvt_pk_bf16_f32 v149, v214, v215
  v_cvt_pk_bf16_f32 v150, v216, v217
  v_cvt_pk_bf16_f32 v151, v218, v219
  v_and_b32_e64 v148, -2, v148
  buffer_store_dwordx4 v[148:151], v0, s[4:7], s50 offen sc1
  s_branch AT_DONE
.p2align 12
.fill 2, 4, 0xBF800000
G_V1:
  v_and_b32_e64 v14, 63, v0
  s_load_dwordx2 s[4:5], s[0:1], 80
  s_load_dwordx2 s[40:41], s[0:1], 72
  s_load_dwordx2 s[16:17], s[0:1], 32
  s_load_dwordx2 s[20:21], s[0:1], 40
  s_load_dwordx2 s[24:25], s[0:1], 48
  s_load_dwordx2 s[28:29], s[0:1], 16
  s_load_dwordx2 s[32:33], s[0:1], 64
  s_bfe_u32 s46, s2, 0x10002
  s_lshl_b32 s46, s46, 3
  s_bfe_u32 s50, s2, 0x30003
  s_add_u32 s46, s46, s50
  s_and_b32 s47, s2, 3
  s_lshl_b32 s47, s47, 2
  s_lshr_b32 s50, s2, 6
  s_add_u32 s47, s47, s50
  s_add_u32 s49, s50, s46
  s_lshl_b32 s49, s49, 2
  s_lshr_b32 s50, s47, 2
  s_add_u32 s49, s49, s50
  s_lshr_b32 s50, s46, 3
  s_lshl_b32 s50, s50, 1
  s_add_u32 s49, s49, s50
  s_and_b32 s45, s44, 3
  s_mov_b32 s6, 0x1000000
  s_mov_b32 s7, 0x20000
  s_mov_b32 s42, 0x100
  s_mov_b32 s43, 0x20000
  s_mov_b32 s18, 0x158000
  s_mov_b32 s19, 0x20000
  s_mov_b32 s22, 0x158000
  s_mov_b32 s23, 0x20000
  s_mov_b32 s26, 0x158000
  s_mov_b32 s27, 0x20000
  s_mov_b32 s30, 0x80000
  s_mov_b32 s31, 0x20000
  s_mov_b32 s34, 0x200000
  s_mov_b32 s35, 0x20000
  s_movk_i32 s50, 0x4924
  s_bitcmp1_b32 s50, s47
  s_cselect_b32 s63, 0x40000000, 0
  s_bfm_b32 s3, s47, 0
  s_and_b32 s3, s3, s50
  s_bcnt1_i32_b32 s3, s3
  s_mul_i32 s48, s47, 3
  s_sub_u32 s48, s48, s3
  s_and_b32 s53, s2, 7
  s_lshl_b32 s53, s53, 2
  s_bfe_u32 s50, s2, 0x20003
  s_add_u32 s53, s53, s50
  s_lshr_b32 s54, s2, 5
  s_lshl_b32 s98, s45, 10
  s_lshl_b32 s99, s45, 14
  s_lshl_b32 s50, s54, 7
  s_add_u32 s99, s99, s50
  s_lshl_b32 s101, s53, 1
  s_add_u32 s101, s101, s54
  s_and_b32 s101, s101, 7
  s_mul_i32 s62, s101, 21
  s_lshr_b32 s62, s62, 3
  s_lshl_b32 s62, s62, 16
  s_lshl_b32 s101, s101, 16
  v_lshlrev_b32 v0, 4, v14
  v_and_b32 v12, 15, v14
  v_lshrrev_b32 v13, 4, v14
  v_bfe_u32 v1, v14, 1, 3
  v_xor_b32 v1, v1, v13
  v_lshlrev_b32 v1, 4, v1
  v_lshl_add_u32 v1, v12, 7, v1
  s_lshl_b32 s50, s45, 12
  v_add_u32 v1, s50, v1
  v_xor_b32_e64 v2, 64, v1
  v_add_u32 v3, 57344, v1
  v_add_u32 v4, 57344, v2
  v_lshlrev_b32_e64 v108, 4, v13
  v_add_u32 v108, 159744, v108
  v_bfe_u32 v12, v14, 2, 2
  v_lshlrev_b32 v12, 6, v12
  v_and_b32 v13, 3, v14
  v_lshl_add_u32 v12, v13, 3, v12
  v_bfe_u32 v13, v14, 4, 1
  v_cmp_ne_u32 s[64:65], 0, v13
  v_mul_u32_u24 v13, 544, v13
  v_add_u32 v12, v12, v13
  v_lshrrev_b32 v13, 5, v14
  v_mul_u32_u24 v13, 3072, v13
  v_add_u32_e64 v12, v12, v13
  v_add_u32 v112, 16384, v12
  v_add_u32 v7, v12, v13
  v_xor_b32 v113, 32, v112
  v_add_u32 v114, 57344, v112
  v_add_u32 v115, 57344, v113
  v_xor_b32_e64 v8, 32, v7
  v_add_u32 v9, 57344, v7
  v_add_u32 v10, 57344, v8
  s_waitcnt lgkmcnt(0)
  s_cmp_eq_u32 s45, 1
  s_cselect_b32 s68, s20, s16
  s_cselect_b32 s69, s21, s17
  s_cmp_eq_u32 s45, 2
  s_cselect_b32 s68, s24, s68
  s_cselect_b32 s69, s25, s69
  s_mov_b32 s70, 1409024
  s_cmp_eq_u32 s45, 3
  s_cselect_b32 s68, s28, s68
  s_cselect_b32 s69, s29, s69
  s_cselect_b32 s70, 524288, s70
  s_mov_b32 s71, 0x20000
  s_mov_b32 s50, s3
  s_lshr_b32 s85, s45, 1
  s_cmp_eq_u32 s63, 0
  s_cbranch_scc1 GH5
  s_mul_i32 s51, s46, 5
  s_add_u32 s50, s50, s51
  s_mul_i32 s50, s50, 3
  s_cmp_eq_u32 s45, 2
  s_cselect_b32 s88, 46, 46
  s_cmp_eq_u32 s45, 3
  s_cselect_b32 s88, 18, s88
  s_add_u32 s85, s85, 1
  s_cmp_eq_u32 s45, 3
  s_cselect_b32 s85, 0, s85
  s_mov_b32 s52, 0
  s_branch GH5J
GH5:
  s_sub_u32 s50, s47, s50
  s_mul_i32 s51, s46, 11
  s_add_u32 s50, s50, s51
  s_mul_i32 s85, s85, 3
  s_cmp_eq_u32 s45, 3
  s_cselect_b32 s88, 24, 1
  s_cselect_b32 s52, 0, 1413120
  s_cselect_b32 s85, s85, 0
GH5J:
  s_bfm_b64 s[86:87], s88, 0
  s_lshl_b32 s88, s88, 7
  s_lshl_b32 s89, s88, 1
  s_mul_i32 s50, s50, s88
  s_add_u32 s50, s50, s52
  v_lshl_add_u32 v98, v14, 7, s50
  s_cmp_lg_u32 s85, 3
  s_cbranch_scc1 GL6
  s_mov_b64 exec, s[86:87]
  buffer_load_dword v99, v98, s[68:71], 0 offen
  s_mov_b64 exec, -1
GL6:
  s_lshr_b32 s84, s2, 3
  s_and_b32 s84, s84, 7
  s_lshl_b32 s51, s46, 12
  s_add_u32 s51, s51, s98
  s_mul_i32 s76, s47, 393216
  s_add_u32 s76, s76, s51
  s_add_u32 s77, s76, 65536
  s_add_u32 s78, s76, 131072
  s_add_u32 s79, s76, 196608
  s_add_u32 s80, s76, 262144
  s_add_u32 s81, s76, 327680
  s_lshr_b32 s93, s51, 3
  s_add_u32 s93, s93, 13631488
  s_cmp_lt_u32 s76, 2097152
  s_cselect_b32 s90, 1, 0
  s_cmp_lt_u32 s78, 2097152
  s_cselect_b32 s91, 1, 0
  s_cmp_lt_u32 s80, 2097152
  s_cselect_b32 s92, 1, 0
  s_setprio 2
  s_barrier
  s_add_u32 s57, s49, 0
  s_and_b32 s57, s57, 7
  s_lshl_b32 s57, s57, 7
  v_add_u32_e64 v109, s57, v108
  ds_read_b128 v[128:131], v1 offset:0
  ds_read_b128 v[132:135], v1 offset:2048
  ds_read_b128 v[80:83], v109 offset:0
  ds_read_b64_tr_b16 v[12:13], v112 offset:0
  ds_read_b64_tr_b16 v[14:15], v112 offset:256
  ds_read_b64_tr_b16 v[16:17], v112 offset:1024
  ds_read_b64_tr_b16 v[18:19], v112 offset:1280
  ds_read_b64_tr_b16 v[20:21], v112 offset:2048
  ds_read_b64_tr_b16 v[22:23], v112 offset:2304
  ds_read_b64_tr_b16 v[24:25], v113 offset:0
  ds_read_b64_tr_b16 v[26:27], v113 offset:256
  s_waitcnt lgkmcnt(6)
  v_mfma_f32_16x16x32_bf16 v[32:35], v[12:15], v[128:131], 0
  ds_read_b64_tr_b16 v[28:29], v113 offset:1024
  ds_read_b64_tr_b16 v[30:31], v113 offset:1280
  v_mfma_f32_16x16x32_bf16 v[36:39], v[12:15], v[132:135], 0
  v_mfma_f32_16x16x32_bf16 v[88:91], v[80:83], v[128:131], 0
  s_waitcnt lgkmcnt(6)
  v_mfma_f32_16x16x32_bf16 v[48:51], v[16:19], v[128:131], 0
  ds_read_b64_tr_b16 v[12:13], v113 offset:2048
  ds_read_b64_tr_b16 v[14:15], v113 offset:2304
  v_mfma_f32_16x16x32_bf16 v[52:55], v[16:19], v[132:135], 0
  s_waitcnt lgkmcnt(6)
  v_mfma_f32_16x16x32_bf16 v[64:67], v[128:131], v[20:23], 0
  ds_read_b128 v[136:139], v2 offset:0
  ds_read_b128 v[140:143], v2 offset:2048
  ds_read_b128 v[84:87], v109 offset:64
  v_mfma_f32_16x16x32_bf16 v[68:71], v[132:135], v[20:23], 0
  ds_read_b64_tr_b16 v[16:17], v112 offset:6144
  ds_read_b64_tr_b16 v[18:19], v112 offset:6400
  s_waitcnt lgkmcnt(9)
  v_mfma_f32_16x16x32_bf16 v[40:43], v[24:27], v[128:131], 0
  ds_read_b64_tr_b16 v[20:21], v112 offset:7168
  ds_read_b64_tr_b16 v[22:23], v112 offset:7424
  v_mfma_f32_16x16x32_bf16 v[44:47], v[24:27], v[132:135], 0
  v_mfma_f32_16x16x32_bf16 v[92:95], v[80:83], v[132:135], 0
  s_waitcnt lgkmcnt(9)
  v_mfma_f32_16x16x32_bf16 v[56:59], v[28:31], v[128:131], 0
  ds_read_b64_tr_b16 v[24:25], v112 offset:8192
  ds_read_b64_tr_b16 v[26:27], v112 offset:8448
  v_mfma_f32_16x16x32_bf16 v[60:63], v[28:31], v[132:135], 0
  s_waitcnt lgkmcnt(9)
  v_mfma_f32_16x16x32_bf16 v[72:75], v[128:131], v[12:15], 0
  ds_read_b64_tr_b16 v[28:29], v113 offset:6144
  ds_read_b64_tr_b16 v[30:31], v113 offset:6400
  v_mfma_f32_16x16x32_bf16 v[76:79], v[132:135], v[12:15], 0
  s_waitcnt lgkmcnt(6)
  v_mfma_f32_16x16x32_bf16 v[32:35], v[16:19], v[136:139], v[32:35]
  ds_read_b64_tr_b16 v[12:13], v113 offset:7168
  ds_read_b64_tr_b16 v[14:15], v113 offset:7424
  v_mfma_f32_16x16x32_bf16 v[36:39], v[16:19], v[140:143], v[36:39]
  v_mfma_f32_16x16x32_bf16 v[88:91], v[84:87], v[136:139], v[88:91]
  s_waitcnt lgkmcnt(6)
  v_mfma_f32_16x16x32_bf16 v[48:51], v[20:23], v[136:139], v[48:51]
  ds_read_b64_tr_b16 v[16:17], v113 offset:8192
  ds_read_b64_tr_b16 v[18:19], v113 offset:8448
  v_mfma_f32_16x16x32_bf16 v[52:55], v[20:23], v[140:143], v[52:55]
  s_waitcnt lgkmcnt(6)
  v_mfma_f32_16x16x32_bf16 v[64:67], v[136:139], v[24:27], v[64:67]
  s_barrier
  s_add_u32 s57, s49, 1
  s_and_b32 s57, s57, 7
  s_lshl_b32 s57, s57, 7
  v_add_u32 v109, s57, v108
  v_mfma_f32_16x16x32_bf16 v[68:71], v[140:143], v[24:27], v[68:71]
  ds_read_b128 v[144:147], v1 offset:28672
  ds_read_b128 v[148:151], v1 offset:30720
  ds_read_b128 v[80:83], v109 offset:0
  ds_read_b64_tr_b16 v[20:21], v112 offset:28672
  ds_read_b64_tr_b16 v[22:23], v112 offset:28928
  s_waitcnt lgkmcnt(9)
  v_mfma_f32_16x16x32_bf16 v[40:43], v[28:31], v[136:139], v[40:43]
  ds_read_b64_tr_b16 v[24:25], v112 offset:29696
  ds_read_b64_tr_b16 v[26:27], v112 offset:29952
  v_mfma_f32_16x16x32_bf16 v[44:47], v[28:31], v[140:143], v[44:47]
  v_mfma_f32_16x16x32_bf16 v[92:95], v[84:87], v[140:143], v[92:95]
  s_waitcnt lgkmcnt(9)
  v_mfma_f32_16x16x32_bf16 v[56:59], v[12:15], v[136:139], v[56:59]
  ds_read_b64_tr_b16 v[28:29], v112 offset:30720
  ds_read_b64_tr_b16 v[30:31], v112 offset:30976
  v_mfma_f32_16x16x32_bf16 v[60:63], v[12:15], v[140:143], v[60:63]
  s_waitcnt lgkmcnt(9)
  v_mfma_f32_16x16x32_bf16 v[72:75], v[136:139], v[16:19], v[72:75]
  ds_read_b64_tr_b16 v[12:13], v113 offset:28672
  ds_read_b64_tr_b16 v[14:15], v113 offset:28928
  v_mfma_f32_16x16x32_bf16 v[76:79], v[140:143], v[16:19], v[76:79]
  s_waitcnt lgkmcnt(6)
  v_mfma_f32_16x16x32_bf16 v[32:35], v[20:23], v[144:147], v[32:35]
  ds_read_b64_tr_b16 v[16:17], v113 offset:29696
  ds_read_b64_tr_b16 v[18:19], v113 offset:29952
  v_mfma_f32_16x16x32_bf16 v[36:39], v[20:23], v[148:151], v[36:39]
  v_mfma_f32_16x16x32_bf16 v[88:91], v[80:83], v[144:147], v[88:91]
  s_waitcnt lgkmcnt(6)
  v_mfma_f32_16x16x32_bf16 v[48:51], v[24:27], v[144:147], v[48:51]
  ds_read_b64_tr_b16 v[20:21], v113 offset:30720
  ds_read_b64_tr_b16 v[22:23], v113 offset:30976
  v_mfma_f32_16x16x32_bf16 v[52:55], v[24:27], v[148:151], v[52:55]
  s_waitcnt lgkmcnt(6)
  v_mfma_f32_16x16x32_bf16 v[64:67], v[144:147], v[28:31], v[64:67]
  ds_read_b128 v[152:155], v2 offset:28672
  ds_read_b128 v[156:159], v2 offset:30720
  ds_read_b128 v[84:87], v109 offset:64
  v_mfma_f32_16x16x32_bf16 v[68:71], v[148:151], v[28:31], v[68:71]
  ds_read_b64_tr_b16 v[24:25], v112 offset:34816
  ds_read_b64_tr_b16 v[26:27], v112 offset:35072
  s_waitcnt lgkmcnt(9)
  v_mfma_f32_16x16x32_bf16 v[40:43], v[12:15], v[144:147], v[40:43]
  ds_read_b64_tr_b16 v[28:29], v112 offset:35840
  ds_read_b64_tr_b16 v[30:31], v112 offset:36096
  v_mfma_f32_16x16x32_bf16 v[44:47], v[12:15], v[148:151], v[44:47]
  v_mfma_f32_16x16x32_bf16 v[92:95], v[80:83], v[148:151], v[92:95]
  s_waitcnt lgkmcnt(9)
  v_mfma_f32_16x16x32_bf16 v[56:59], v[16:19], v[144:147], v[56:59]
  ds_read_b64_tr_b16 v[12:13], v112 offset:36864
  ds_read_b64_tr_b16 v[14:15], v112 offset:37120
  v_mfma_f32_16x16x32_bf16 v[60:63], v[16:19], v[148:151], v[60:63]
  s_waitcnt lgkmcnt(9)
  v_mfma_f32_16x16x32_bf16 v[72:75], v[144:147], v[20:23], v[72:75]
  ds_read_b64_tr_b16 v[16:17], v113 offset:34816
  ds_read_b64_tr_b16 v[18:19], v113 offset:35072
  v_mfma_f32_16x16x32_bf16 v[76:79], v[148:151], v[20:23], v[76:79]
  s_waitcnt lgkmcnt(6)
  v_mfma_f32_16x16x32_bf16 v[32:35], v[24:27], v[152:155], v[32:35]
  ds_read_b64_tr_b16 v[20:21], v113 offset:35840
  ds_read_b64_tr_b16 v[22:23], v113 offset:36096
  v_mfma_f32_16x16x32_bf16 v[36:39], v[24:27], v[156:159], v[36:39]
  v_mfma_f32_16x16x32_bf16 v[88:91], v[84:87], v[152:155], v[88:91]
  s_waitcnt lgkmcnt(6)
  v_mfma_f32_16x16x32_bf16 v[48:51], v[28:31], v[152:155], v[48:51]
  ds_read_b64_tr_b16 v[24:25], v113 offset:36864
  ds_read_b64_tr_b16 v[26:27], v113 offset:37120
  v_mfma_f32_16x16x32_bf16 v[52:55], v[28:31], v[156:159], v[52:55]
  s_waitcnt lgkmcnt(6)
  v_mfma_f32_16x16x32_bf16 v[64:67], v[152:155], v[12:15], v[64:67]
  s_barrier
  s_add_u32 s57, s49, 2
  s_and_b32 s57, s57, 7
  s_lshl_b32 s57, s57, 7
  v_add_u32_e64 v109, s57, v108
  v_mfma_f32_16x16x32_bf16 v[68:71], v[156:159], v[12:15], v[68:71]
  ds_read_b128 v[160:163], v3 offset:0
  ds_read_b128 v[164:167], v3 offset:2048
  ds_read_b128 v[80:83], v109 offset:0
  ds_read_b64_tr_b16 v[28:29], v114 offset:0
  ds_read_b64_tr_b16 v[30:31], v114 offset:256
  s_waitcnt lgkmcnt(9)
  v_mfma_f32_16x16x32_bf16 v[40:43], v[16:19], v[152:155], v[40:43]
  ds_read_b64_tr_b16 v[12:13], v114 offset:1024
  ds_read_b64_tr_b16 v[14:15], v114 offset:1280
  v_mfma_f32_16x16x32_bf16 v[44:47], v[16:19], v[156:159], v[44:47]
  v_mfma_f32_16x16x32_bf16 v[92:95], v[84:87], v[156:159], v[92:95]
  s_waitcnt lgkmcnt(9)
  v_mfma_f32_16x16x32_bf16 v[56:59], v[20:23], v[152:155], v[56:59]
  ds_read_b64_tr_b16 v[16:17], v114 offset:2048
  ds_read_b64_tr_b16 v[18:19], v114 offset:2304
  v_mfma_f32_16x16x32_bf16 v[60:63], v[20:23], v[156:159], v[60:63]
  s_waitcnt lgkmcnt(9)
  v_mfma_f32_16x16x32_bf16 v[72:75], v[152:155], v[24:27], v[72:75]
  ds_read_b64_tr_b16 v[20:21], v115 offset:0
  ds_read_b64_tr_b16 v[22:23], v115 offset:256
  v_mfma_f32_16x16x32_bf16 v[76:79], v[156:159], v[24:27], v[76:79]
  s_waitcnt lgkmcnt(6)
  v_mfma_f32_16x16x32_bf16 v[32:35], v[28:31], v[160:163], v[32:35]
  ds_read_b64_tr_b16 v[24:25], v115 offset:1024
  ds_read_b64_tr_b16 v[26:27], v115 offset:1280
  v_mfma_f32_16x16x32_bf16 v[36:39], v[28:31], v[164:167], v[36:39]
  v_mfma_f32_16x16x32_bf16 v[88:91], v[80:83], v[160:163], v[88:91]
  s_waitcnt lgkmcnt(6)
  v_mfma_f32_16x16x32_bf16 v[48:51], v[12:15], v[160:163], v[48:51]
  ds_read_b64_tr_b16 v[28:29], v115 offset:2048
  ds_read_b64_tr_b16 v[30:31], v115 offset:2304
  v_mfma_f32_16x16x32_bf16 v[52:55], v[12:15], v[164:167], v[52:55]
  s_waitcnt lgkmcnt(6)
  v_mfma_f32_16x16x32_bf16 v[64:67], v[160:163], v[16:19], v[64:67]
  ds_read_b128 v[168:171], v4 offset:0
  ds_read_b128 v[172:175], v4 offset:2048
  ds_read_b128 v[84:87], v109 offset:64
  v_mfma_f32_16x16x32_bf16 v[68:71], v[164:167], v[16:19], v[68:71]
  ds_read_b64_tr_b16 v[12:13], v114 offset:6144
  ds_read_b64_tr_b16 v[14:15], v114 offset:6400
  s_waitcnt lgkmcnt(9)
  v_mfma_f32_16x16x32_bf16 v[40:43], v[20:23], v[160:163], v[40:43]
  ds_read_b64_tr_b16 v[16:17], v114 offset:7168
  ds_read_b64_tr_b16 v[18:19], v114 offset:7424
  v_mfma_f32_16x16x32_bf16 v[44:47], v[20:23], v[164:167], v[44:47]
  v_mfma_f32_16x16x32_bf16 v[92:95], v[80:83], v[164:167], v[92:95]
  s_waitcnt lgkmcnt(9)
  v_mfma_f32_16x16x32_bf16 v[56:59], v[24:27], v[160:163], v[56:59]
  ds_read_b64_tr_b16 v[20:21], v114 offset:8192
  ds_read_b64_tr_b16 v[22:23], v114 offset:8448
  v_mfma_f32_16x16x32_bf16 v[60:63], v[24:27], v[164:167], v[60:63]
  s_waitcnt lgkmcnt(9)
  v_mfma_f32_16x16x32_bf16 v[72:75], v[160:163], v[28:31], v[72:75]
  ds_read_b64_tr_b16 v[24:25], v115 offset:6144
  ds_read_b64_tr_b16 v[26:27], v115 offset:6400
  v_mfma_f32_16x16x32_bf16 v[76:79], v[164:167], v[28:31], v[76:79]
  s_waitcnt lgkmcnt(6)
  v_mfma_f32_16x16x32_bf16 v[32:35], v[12:15], v[168:171], v[32:35]
  ds_read_b64_tr_b16 v[28:29], v115 offset:7168
  ds_read_b64_tr_b16 v[30:31], v115 offset:7424
  v_mfma_f32_16x16x32_bf16 v[36:39], v[12:15], v[172:175], v[36:39]
  v_mfma_f32_16x16x32_bf16 v[88:91], v[84:87], v[168:171], v[88:91]
  s_waitcnt lgkmcnt(6)
  v_mfma_f32_16x16x32_bf16 v[48:51], v[16:19], v[168:171], v[48:51]
  ds_read_b64_tr_b16 v[12:13], v115 offset:8192
  ds_read_b64_tr_b16 v[14:15], v115 offset:8448
  v_mfma_f32_16x16x32_bf16 v[52:55], v[16:19], v[172:175], v[52:55]
  s_waitcnt lgkmcnt(6)
  v_mfma_f32_16x16x32_bf16 v[64:67], v[168:171], v[20:23], v[64:67]
  s_barrier
  s_add_u32 s57, s49, 3
  s_and_b32 s57, s57, 7
  s_lshl_b32 s57, s57, 7
  v_add_u32_e64 v109, s57, v108
  v_mfma_f32_16x16x32_bf16 v[68:71], v[172:175], v[20:23], v[68:71]
  ds_read_b128 v[176:179], v3 offset:28672
  ds_read_b128 v[180:183], v3 offset:30720
  ds_read_b128 v[80:83], v109 offset:0
  ds_read_b64_tr_b16 v[16:17], v114 offset:28672
  ds_read_b64_tr_b16 v[18:19], v114 offset:28928
  s_waitcnt lgkmcnt(9)
  v_mfma_f32_16x16x32_bf16 v[40:43], v[24:27], v[168:171], v[40:43]
  ds_read_b64_tr_b16 v[20:21], v114 offset:29696
  ds_read_b64_tr_b16 v[22:23], v114 offset:29952
  v_mfma_f32_16x16x32_bf16 v[44:47], v[24:27], v[172:175], v[44:47]
  v_mfma_f32_16x16x32_bf16 v[92:95], v[84:87], v[172:175], v[92:95]
  s_waitcnt lgkmcnt(9)
  v_mfma_f32_16x16x32_bf16 v[56:59], v[28:31], v[168:171], v[56:59]
  ds_read_b64_tr_b16 v[24:25], v114 offset:30720
  ds_read_b64_tr_b16 v[26:27], v114 offset:30976
  v_mfma_f32_16x16x32_bf16 v[60:63], v[28:31], v[172:175], v[60:63]
  s_waitcnt lgkmcnt(9)
  v_mfma_f32_16x16x32_bf16 v[72:75], v[168:171], v[12:15], v[72:75]
  ds_read_b64_tr_b16 v[28:29], v115 offset:28672
  ds_read_b64_tr_b16 v[30:31], v115 offset:28928
  v_mfma_f32_16x16x32_bf16 v[76:79], v[172:175], v[12:15], v[76:79]
  s_waitcnt lgkmcnt(6)
  v_mfma_f32_16x16x32_bf16 v[32:35], v[16:19], v[176:179], v[32:35]
  ds_read_b64_tr_b16 v[12:13], v115 offset:29696
  ds_read_b64_tr_b16 v[14:15], v115 offset:29952
  v_mfma_f32_16x16x32_bf16 v[36:39], v[16:19], v[180:183], v[36:39]
  v_mfma_f32_16x16x32_bf16 v[88:91], v[80:83], v[176:179], v[88:91]
  s_waitcnt lgkmcnt(6)
  v_mfma_f32_16x16x32_bf16 v[48:51], v[20:23], v[176:179], v[48:51]
  ds_read_b64_tr_b16 v[16:17], v115 offset:30720
  ds_read_b64_tr_b16 v[18:19], v115 offset:30976
  v_mfma_f32_16x16x32_bf16 v[52:55], v[20:23], v[180:183], v[52:55]
  s_waitcnt lgkmcnt(6)
  v_mfma_f32_16x16x32_bf16 v[64:67], v[176:179], v[24:27], v[64:67]
  ds_read_b128 v[184:187], v4 offset:28672
  ds_read_b128 v[188:191], v4 offset:30720
  ds_read_b128 v[84:87], v109 offset:64
  v_mfma_f32_16x16x32_bf16 v[68:71], v[180:183], v[24:27], v[68:71]
  ds_read_b64_tr_b16 v[20:21], v114 offset:34816
  ds_read_b64_tr_b16 v[22:23], v114 offset:35072
  s_waitcnt lgkmcnt(9)
  v_mfma_f32_16x16x32_bf16 v[40:43], v[28:31], v[176:179], v[40:43]
  ds_read_b64_tr_b16 v[24:25], v114 offset:35840
  ds_read_b64_tr_b16 v[26:27], v114 offset:36096
  v_mfma_f32_16x16x32_bf16 v[44:47], v[28:31], v[180:183], v[44:47]
  v_mfma_f32_16x16x32_bf16 v[92:95], v[80:83], v[180:183], v[92:95]
  s_waitcnt lgkmcnt(9)
  v_mfma_f32_16x16x32_bf16 v[56:59], v[12:15], v[176:179], v[56:59]
  ds_read_b64_tr_b16 v[28:29], v114 offset:36864
  ds_read_b64_tr_b16 v[30:31], v114 offset:37120
  v_mfma_f32_16x16x32_bf16 v[60:63], v[12:15], v[180:183], v[60:63]
  s_waitcnt lgkmcnt(9)
  v_mfma_f32_16x16x32_bf16 v[72:75], v[176:179], v[16:19], v[72:75]
  ds_read_b64_tr_b16 v[12:13], v115 offset:34816
  ds_read_b64_tr_b16 v[14:15], v115 offset:35072
  v_mfma_f32_16x16x32_bf16 v[76:79], v[180:183], v[16:19], v[76:79]
  s_waitcnt lgkmcnt(6)
  v_mfma_f32_16x16x32_bf16 v[32:35], v[20:23], v[184:187], v[32:35]
  ds_read_b64_tr_b16 v[16:17], v115 offset:35840
  ds_read_b64_tr_b16 v[18:19], v115 offset:36096
  v_mfma_f32_16x16x32_bf16 v[36:39], v[20:23], v[188:191], v[36:39]
  v_mfma_f32_16x16x32_bf16 v[88:91], v[84:87], v[184:187], v[88:91]
  s_waitcnt lgkmcnt(6)
  v_mfma_f32_16x16x32_bf16 v[48:51], v[24:27], v[184:187], v[48:51]
  ds_read_b64_tr_b16 v[20:21], v115 offset:36864
  ds_read_b64_tr_b16 v[22:23], v115 offset:37120
  v_mfma_f32_16x16x32_bf16 v[52:55], v[24:27], v[188:191], v[52:55]
  s_waitcnt lgkmcnt(6)
  v_mfma_f32_16x16x32_bf16 v[64:67], v[184:187], v[28:31], v[64:67]
  s_barrier
  s_add_u32 s57, s49, 4
  s_and_b32 s57, s57, 7
  s_lshl_b32 s57, s57, 7
  v_add_u32_e64 v109, s57, v108
  v_mfma_f32_16x16x32_bf16 v[68:71], v[188:191], v[28:31], v[68:71]
  ds_read_b128 v[192:195], v1 offset:0
  ds_read_b128 v[196:199], v1 offset:2048
  ds_read_b128 v[80:83], v109 offset:0
  ds_read_b64_tr_b16 v[24:25], v112 offset:0
  ds_read_b64_tr_b16 v[26:27], v112 offset:256
  s_waitcnt lgkmcnt(9)
  v_mfma_f32_16x16x32_bf16 v[40:43], v[12:15], v[184:187], v[40:43]
  ds_read_b64_tr_b16 v[28:29], v112 offset:1024
  ds_read_b64_tr_b16 v[30:31], v112 offset:1280
  v_mfma_f32_16x16x32_bf16 v[44:47], v[12:15], v[188:191], v[44:47]
  v_mfma_f32_16x16x32_bf16 v[92:95], v[84:87], v[188:191], v[92:95]
  s_waitcnt lgkmcnt(9)
  v_mfma_f32_16x16x32_bf16 v[56:59], v[16:19], v[184:187], v[56:59]
  ds_read_b64_tr_b16 v[12:13], v112 offset:2048
  ds_read_b64_tr_b16 v[14:15], v112 offset:2304
  v_mfma_f32_16x16x32_bf16 v[60:63], v[16:19], v[188:191], v[60:63]
  s_waitcnt lgkmcnt(9)
  v_mfma_f32_16x16x32_bf16 v[72:75], v[184:187], v[20:23], v[72:75]
  ds_read_b64_tr_b16 v[16:17], v113 offset:0
  ds_read_b64_tr_b16 v[18:19], v113 offset:256
  v_mfma_f32_16x16x32_bf16 v[76:79], v[188:191], v[20:23], v[76:79]
  s_waitcnt lgkmcnt(6)
  v_mfma_f32_16x16x32_bf16 v[32:35], v[24:27], v[192:195], v[32:35]
  ds_read_b64_tr_b16 v[20:21], v113 offset:1024
  ds_read_b64_tr_b16 v[22:23], v113 offset:1280
  v_mfma_f32_16x16x32_bf16 v[36:39], v[24:27], v[196:199], v[36:39]
  v_mfma_f32_16x16x32_bf16 v[88:91], v[80:83], v[192:195], v[88:91]
  s_waitcnt lgkmcnt(6)
  v_mfma_f32_16x16x32_bf16 v[48:51], v[28:31], v[192:195], v[48:51]
  ds_read_b64_tr_b16 v[24:25], v113 offset:2048
  ds_read_b64_tr_b16 v[26:27], v113 offset:2304
  v_mfma_f32_16x16x32_bf16 v[52:55], v[28:31], v[196:199], v[52:55]
  s_waitcnt lgkmcnt(6)
  v_mfma_f32_16x16x32_bf16 v[64:67], v[192:195], v[12:15], v[64:67]
  ds_read_b128 v[200:203], v2 offset:0
  ds_read_b128 v[204:207], v2 offset:2048
  ds_read_b128 v[84:87], v109 offset:64
  v_mfma_f32_16x16x32_bf16 v[68:71], v[196:199], v[12:15], v[68:71]
  ds_read_b64_tr_b16 v[28:29], v112 offset:6144
  ds_read_b64_tr_b16 v[30:31], v112 offset:6400
  s_waitcnt lgkmcnt(9)
  v_mfma_f32_16x16x32_bf16 v[40:43], v[16:19], v[192:195], v[40:43]
  ds_read_b64_tr_b16 v[12:13], v112 offset:7168
  ds_read_b64_tr_b16 v[14:15], v112 offset:7424
  v_mfma_f32_16x16x32_bf16 v[44:47], v[16:19], v[196:199], v[44:47]
  v_mfma_f32_16x16x32_bf16 v[92:95], v[80:83], v[196:199], v[92:95]
  s_waitcnt lgkmcnt(9)
  v_mfma_f32_16x16x32_bf16 v[56:59], v[20:23], v[192:195], v[56:59]
  ds_read_b64_tr_b16 v[16:17], v112 offset:8192
  ds_read_b64_tr_b16 v[18:19], v112 offset:8448
  v_mfma_f32_16x16x32_bf16 v[60:63], v[20:23], v[196:199], v[60:63]
  s_waitcnt lgkmcnt(9)
  v_mfma_f32_16x16x32_bf16 v[72:75], v[192:195], v[24:27], v[72:75]
  ds_read_b64_tr_b16 v[20:21], v113 offset:6144
  ds_read_b64_tr_b16 v[22:23], v113 offset:6400
  v_mfma_f32_16x16x32_bf16 v[76:79], v[196:199], v[24:27], v[76:79]
  s_waitcnt lgkmcnt(6)
  v_mfma_f32_16x16x32_bf16 v[32:35], v[28:31], v[200:203], v[32:35]
  ds_read_b64_tr_b16 v[24:25], v113 offset:7168
  ds_read_b64_tr_b16 v[26:27], v113 offset:7424
  v_mfma_f32_16x16x32_bf16 v[36:39], v[28:31], v[204:207], v[36:39]
  v_mfma_f32_16x16x32_bf16 v[88:91], v[84:87], v[200:203], v[88:91]
  s_waitcnt lgkmcnt(6)
  v_mfma_f32_16x16x32_bf16 v[48:51], v[12:15], v[200:203], v[48:51]
  ds_read_b64_tr_b16 v[28:29], v113 offset:8192
  ds_read_b64_tr_b16 v[30:31], v113 offset:8448
  v_mfma_f32_16x16x32_bf16 v[52:55], v[12:15], v[204:207], v[52:55]
  s_waitcnt lgkmcnt(6)
  v_mfma_f32_16x16x32_bf16 v[64:67], v[200:203], v[16:19], v[64:67]
  s_barrier
  s_add_u32 s57, s49, 5
  s_and_b32 s57, s57, 7
  s_lshl_b32 s57, s57, 7
  v_add_u32_e64 v109, s57, v108
  v_mfma_f32_16x16x32_bf16 v[68:71], v[204:207], v[16:19], v[68:71]
  ds_read_b128 v[208:211], v1 offset:28672
  ds_read_b128 v[212:215], v1 offset:30720
  ds_read_b128 v[80:83], v109 offset:0
  ds_read_b64_tr_b16 v[12:13], v112 offset:28672
  ds_read_b64_tr_b16 v[14:15], v112 offset:28928
  s_waitcnt lgkmcnt(9)
  v_mfma_f32_16x16x32_bf16 v[40:43], v[20:23], v[200:203], v[40:43]
  ds_read_b64_tr_b16 v[16:17], v112 offset:29696
  ds_read_b64_tr_b16 v[18:19], v112 offset:29952
  v_mfma_f32_16x16x32_bf16 v[44:47], v[20:23], v[204:207], v[44:47]
  v_mfma_f32_16x16x32_bf16 v[92:95], v[84:87], v[204:207], v[92:95]
  s_waitcnt lgkmcnt(9)
  v_mfma_f32_16x16x32_bf16 v[56:59], v[24:27], v[200:203], v[56:59]
  ds_read_b64_tr_b16 v[20:21], v112 offset:30720
  ds_read_b64_tr_b16 v[22:23], v112 offset:30976
  v_mfma_f32_16x16x32_bf16 v[60:63], v[24:27], v[204:207], v[60:63]
  s_waitcnt lgkmcnt(9)
  v_mfma_f32_16x16x32_bf16 v[72:75], v[200:203], v[28:31], v[72:75]
  ds_read_b64_tr_b16 v[24:25], v113 offset:28672
  ds_read_b64_tr_b16 v[26:27], v113 offset:28928
  v_mfma_f32_16x16x32_bf16 v[76:79], v[204:207], v[28:31], v[76:79]
  s_waitcnt lgkmcnt(6)
  v_mfma_f32_16x16x32_bf16 v[32:35], v[12:15], v[208:211], v[32:35]
  ds_read_b64_tr_b16 v[28:29], v113 offset:29696
  ds_read_b64_tr_b16 v[30:31], v113 offset:29952
  v_mfma_f32_16x16x32_bf16 v[36:39], v[12:15], v[212:215], v[36:39]
  v_mfma_f32_16x16x32_bf16 v[88:91], v[80:83], v[208:211], v[88:91]
  s_waitcnt lgkmcnt(6)
  v_mfma_f32_16x16x32_bf16 v[48:51], v[16:19], v[208:211], v[48:51]
  ds_read_b64_tr_b16 v[12:13], v113 offset:30720
  ds_read_b64_tr_b16 v[14:15], v113 offset:30976
  v_mfma_f32_16x16x32_bf16 v[52:55], v[16:19], v[212:215], v[52:55]
  s_waitcnt lgkmcnt(6)
  v_mfma_f32_16x16x32_bf16 v[64:67], v[208:211], v[20:23], v[64:67]
  ds_read_b128 v[216:219], v2 offset:28672
  ds_read_b128 v[220:223], v2 offset:30720
  ds_read_b128 v[84:87], v109 offset:64
  v_mfma_f32_16x16x32_bf16 v[68:71], v[212:215], v[20:23], v[68:71]
  ds_read_b64_tr_b16 v[16:17], v112 offset:34816
  ds_read_b64_tr_b16 v[18:19], v112 offset:35072
  s_waitcnt lgkmcnt(9)
  v_mfma_f32_16x16x32_bf16 v[40:43], v[24:27], v[208:211], v[40:43]
  ds_read_b64_tr_b16 v[20:21], v112 offset:35840
  ds_read_b64_tr_b16 v[22:23], v112 offset:36096
  v_mfma_f32_16x16x32_bf16 v[44:47], v[24:27], v[212:215], v[44:47]
  v_mfma_f32_16x16x32_bf16 v[92:95], v[80:83], v[212:215], v[92:95]
  s_waitcnt lgkmcnt(9)
  v_mfma_f32_16x16x32_bf16 v[56:59], v[28:31], v[208:211], v[56:59]
  ds_read_b64_tr_b16 v[24:25], v112 offset:36864
  ds_read_b64_tr_b16 v[26:27], v112 offset:37120
  v_mfma_f32_16x16x32_bf16 v[60:63], v[28:31], v[212:215], v[60:63]
  s_waitcnt lgkmcnt(9)
  v_mfma_f32_16x16x32_bf16 v[72:75], v[208:211], v[12:15], v[72:75]
  ds_read_b64_tr_b16 v[28:29], v113 offset:34816
  ds_read_b64_tr_b16 v[30:31], v113 offset:35072
  v_mfma_f32_16x16x32_bf16 v[76:79], v[212:215], v[12:15], v[76:79]
  s_waitcnt lgkmcnt(6)
  v_mfma_f32_16x16x32_bf16 v[32:35], v[16:19], v[216:219], v[32:35]
  ds_read_b64_tr_b16 v[12:13], v113 offset:35840
  ds_read_b64_tr_b16 v[14:15], v113 offset:36096
  v_mfma_f32_16x16x32_bf16 v[36:39], v[16:19], v[220:223], v[36:39]
  v_mfma_f32_16x16x32_bf16 v[88:91], v[84:87], v[216:219], v[88:91]
  s_waitcnt lgkmcnt(6)
  v_mfma_f32_16x16x32_bf16 v[48:51], v[20:23], v[216:219], v[48:51]
  ds_read_b64_tr_b16 v[16:17], v113 offset:36864
  ds_read_b64_tr_b16 v[18:19], v113 offset:37120
  v_mfma_f32_16x16x32_bf16 v[52:55], v[20:23], v[220:223], v[52:55]
  s_waitcnt lgkmcnt(6)
  v_mfma_f32_16x16x32_bf16 v[64:67], v[216:219], v[24:27], v[64:67]
  s_barrier
  s_add_u32 s57, s49, 6
  s_and_b32 s57, s57, 7
  s_lshl_b32 s57, s57, 7
  v_add_u32_e64 v109, s57, v108
  v_mfma_f32_16x16x32_bf16 v[68:71], v[220:223], v[24:27], v[68:71]
  ds_read_b128 v[224:227], v3 offset:0
  ds_read_b128 v[228:231], v3 offset:2048
  ds_read_b128 v[80:83], v109 offset:0
  ds_read_b64_tr_b16 v[20:21], v114 offset:0
  ds_read_b64_tr_b16 v[22:23], v114 offset:256
  s_waitcnt lgkmcnt(9)
  v_mfma_f32_16x16x32_bf16 v[40:43], v[28:31], v[216:219], v[40:43]
  ds_read_b64_tr_b16 v[24:25], v114 offset:1024
  ds_read_b64_tr_b16 v[26:27], v114 offset:1280
  v_mfma_f32_16x16x32_bf16 v[44:47], v[28:31], v[220:223], v[44:47]
  v_mfma_f32_16x16x32_bf16 v[92:95], v[84:87], v[220:223], v[92:95]
  s_waitcnt lgkmcnt(9)
  v_mfma_f32_16x16x32_bf16 v[56:59], v[12:15], v[216:219], v[56:59]
  ds_read_b64_tr_b16 v[28:29], v114 offset:2048
  ds_read_b64_tr_b16 v[30:31], v114 offset:2304
  v_mfma_f32_16x16x32_bf16 v[60:63], v[12:15], v[220:223], v[60:63]
  s_waitcnt lgkmcnt(9)
  v_mfma_f32_16x16x32_bf16 v[72:75], v[216:219], v[16:19], v[72:75]
  ds_read_b64_tr_b16 v[12:13], v115 offset:0
  ds_read_b64_tr_b16 v[14:15], v115 offset:256
  v_mfma_f32_16x16x32_bf16 v[76:79], v[220:223], v[16:19], v[76:79]
  s_waitcnt lgkmcnt(6)
  v_mfma_f32_16x16x32_bf16 v[32:35], v[20:23], v[224:227], v[32:35]
  ds_read_b64_tr_b16 v[16:17], v115 offset:1024
  ds_read_b64_tr_b16 v[18:19], v115 offset:1280
  v_mfma_f32_16x16x32_bf16 v[36:39], v[20:23], v[228:231], v[36:39]
  v_mfma_f32_16x16x32_bf16 v[88:91], v[80:83], v[224:227], v[88:91]
  s_waitcnt lgkmcnt(6)
  v_mfma_f32_16x16x32_bf16 v[48:51], v[24:27], v[224:227], v[48:51]
  ds_read_b64_tr_b16 v[20:21], v115 offset:2048
  ds_read_b64_tr_b16 v[22:23], v115 offset:2304
  v_mfma_f32_16x16x32_bf16 v[52:55], v[24:27], v[228:231], v[52:55]
  s_waitcnt lgkmcnt(6)
  v_mfma_f32_16x16x32_bf16 v[64:67], v[224:227], v[28:31], v[64:67]
  ds_read_b128 v[232:235], v4 offset:0
  ds_read_b128 v[236:239], v4 offset:2048
  ds_read_b128 v[84:87], v109 offset:64
  v_mfma_f32_16x16x32_bf16 v[68:71], v[228:231], v[28:31], v[68:71]
  ds_read_b64_tr_b16 v[24:25], v114 offset:6144
  ds_read_b64_tr_b16 v[26:27], v114 offset:6400
  s_waitcnt lgkmcnt(9)
  v_mfma_f32_16x16x32_bf16 v[40:43], v[12:15], v[224:227], v[40:43]
  ds_read_b64_tr_b16 v[28:29], v114 offset:7168
  ds_read_b64_tr_b16 v[30:31], v114 offset:7424
  v_mfma_f32_16x16x32_bf16 v[44:47], v[12:15], v[228:231], v[44:47]
  v_mfma_f32_16x16x32_bf16 v[92:95], v[80:83], v[228:231], v[92:95]
  s_waitcnt lgkmcnt(9)
  v_mfma_f32_16x16x32_bf16 v[56:59], v[16:19], v[224:227], v[56:59]
  ds_read_b64_tr_b16 v[12:13], v114 offset:8192
  ds_read_b64_tr_b16 v[14:15], v114 offset:8448
  v_mfma_f32_16x16x32_bf16 v[60:63], v[16:19], v[228:231], v[60:63]
  s_waitcnt lgkmcnt(9)
  v_mfma_f32_16x16x32_bf16 v[72:75], v[224:227], v[20:23], v[72:75]
  ds_read_b64_tr_b16 v[16:17], v115 offset:6144
  ds_read_b64_tr_b16 v[18:19], v115 offset:6400
  v_mfma_f32_16x16x32_bf16 v[76:79], v[228:231], v[20:23], v[76:79]
  s_waitcnt lgkmcnt(6)
  v_mfma_f32_16x16x32_bf16 v[32:35], v[24:27], v[232:235], v[32:35]
  ds_read_b64_tr_b16 v[20:21], v115 offset:7168
  ds_read_b64_tr_b16 v[22:23], v115 offset:7424
  v_mfma_f32_16x16x32_bf16 v[36:39], v[24:27], v[236:239], v[36:39]
  v_mfma_f32_16x16x32_bf16 v[88:91], v[84:87], v[232:235], v[88:91]
  s_waitcnt lgkmcnt(6)
  v_mfma_f32_16x16x32_bf16 v[48:51], v[28:31], v[232:235], v[48:51]
  ds_read_b64_tr_b16 v[24:25], v115 offset:8192
  ds_read_b64_tr_b16 v[26:27], v115 offset:8448
  v_mfma_f32_16x16x32_bf16 v[52:55], v[28:31], v[236:239], v[52:55]
  s_waitcnt lgkmcnt(6)
  v_mfma_f32_16x16x32_bf16 v[64:67], v[232:235], v[12:15], v[64:67]
  s_barrier
  s_add_u32 s57, s49, 7
  s_and_b32 s57, s57, 7
  s_lshl_b32 s57, s57, 7
  v_add_u32_e64 v109, s57, v108
  v_mfma_f32_16x16x32_bf16 v[68:71], v[236:239], v[12:15], v[68:71]
  ds_read_b128 v[240:243], v3 offset:28672
  ds_read_b128 v[244:247], v3 offset:30720
  ds_read_b128 v[80:83], v109 offset:0
  ds_read_b64_tr_b16 v[28:29], v114 offset:28672
  ds_read_b64_tr_b16 v[30:31], v114 offset:28928
  s_waitcnt lgkmcnt(9)
  v_mfma_f32_16x16x32_bf16 v[40:43], v[16:19], v[232:235], v[40:43]
  ds_read_b64_tr_b16 v[12:13], v114 offset:29696
  ds_read_b64_tr_b16 v[14:15], v114 offset:29952
  v_mfma_f32_16x16x32_bf16 v[44:47], v[16:19], v[236:239], v[44:47]
  v_mfma_f32_16x16x32_bf16 v[92:95], v[84:87], v[236:239], v[92:95]
  s_waitcnt lgkmcnt(9)
  v_mfma_f32_16x16x32_bf16 v[56:59], v[20:23], v[232:235], v[56:59]
  ds_read_b64_tr_b16 v[16:17], v114 offset:30720
  ds_read_b64_tr_b16 v[18:19], v114 offset:30976
  v_mfma_f32_16x16x32_bf16 v[60:63], v[20:23], v[236:239], v[60:63]
  s_waitcnt lgkmcnt(9)
  v_mfma_f32_16x16x32_bf16 v[72:75], v[232:235], v[24:27], v[72:75]
  ds_read_b64_tr_b16 v[20:21], v115 offset:28672
  ds_read_b64_tr_b16 v[22:23], v115 offset:28928
  v_mfma_f32_16x16x32_bf16 v[76:79], v[236:239], v[24:27], v[76:79]
  s_waitcnt lgkmcnt(6)
  v_mfma_f32_16x16x32_bf16 v[32:35], v[28:31], v[240:243], v[32:35]
  ds_read_b64_tr_b16 v[24:25], v115 offset:29696
  ds_read_b64_tr_b16 v[26:27], v115 offset:29952
  v_mfma_f32_16x16x32_bf16 v[36:39], v[28:31], v[244:247], v[36:39]
  v_mfma_f32_16x16x32_bf16 v[88:91], v[80:83], v[240:243], v[88:91]
  s_waitcnt lgkmcnt(6)
  v_mfma_f32_16x16x32_bf16 v[48:51], v[12:15], v[240:243], v[48:51]
  ds_read_b64_tr_b16 v[28:29], v115 offset:30720
  ds_read_b64_tr_b16 v[30:31], v115 offset:30976
  v_mfma_f32_16x16x32_bf16 v[52:55], v[12:15], v[244:247], v[52:55]
  s_waitcnt lgkmcnt(6)
  v_mfma_f32_16x16x32_bf16 v[64:67], v[240:243], v[16:19], v[64:67]
  ds_read_b128 v[248:251], v4 offset:28672
  ds_read_b128 v[252:255], v4 offset:30720
  ds_read_b128 v[84:87], v109 offset:64
  v_mfma_f32_16x16x32_bf16 v[68:71], v[244:247], v[16:19], v[68:71]
  ds_read_b64_tr_b16 v[12:13], v114 offset:34816
  ds_read_b64_tr_b16 v[14:15], v114 offset:35072
  s_waitcnt lgkmcnt(9)
  v_mfma_f32_16x16x32_bf16 v[40:43], v[20:23], v[240:243], v[40:43]
  ds_read_b64_tr_b16 v[16:17], v114 offset:35840
  ds_read_b64_tr_b16 v[18:19], v114 offset:36096
  v_mfma_f32_16x16x32_bf16 v[44:47], v[20:23], v[244:247], v[44:47]
  v_mfma_f32_16x16x32_bf16 v[92:95], v[80:83], v[244:247], v[92:95]
  s_waitcnt lgkmcnt(9)
  v_mfma_f32_16x16x32_bf16 v[56:59], v[24:27], v[240:243], v[56:59]
  ds_read_b64_tr_b16 v[20:21], v114 offset:36864
  ds_read_b64_tr_b16 v[22:23], v114 offset:37120
  v_mfma_f32_16x16x32_bf16 v[60:63], v[24:27], v[244:247], v[60:63]
  s_waitcnt lgkmcnt(9)
  v_mfma_f32_16x16x32_bf16 v[72:75], v[240:243], v[28:31], v[72:75]
  ds_read_b64_tr_b16 v[24:25], v115 offset:34816
  ds_read_b64_tr_b16 v[26:27], v115 offset:35072
  v_mfma_f32_16x16x32_bf16 v[76:79], v[244:247], v[28:31], v[76:79]
  s_waitcnt vmcnt(0)
  s_waitcnt lgkmcnt(6)
  v_mfma_f32_16x16x32_bf16 v[32:35], v[12:15], v[248:251], v[32:35]
  ds_read_b64_tr_b16 v[28:29], v115 offset:35840
  ds_read_b64_tr_b16 v[30:31], v115 offset:36096
  v_mfma_f32_16x16x32_bf16 v[36:39], v[12:15], v[252:255], v[36:39]
  v_mfma_f32_16x16x32_bf16 v[88:91], v[84:87], v[248:251], v[88:91]
  s_waitcnt lgkmcnt(6)
  v_mfma_f32_16x16x32_bf16 v[48:51], v[16:19], v[248:251], v[48:51]
  ds_read_b64_tr_b16 v[12:13], v115 offset:36864
  ds_read_b64_tr_b16 v[14:15], v115 offset:37120
  v_mfma_f32_16x16x32_bf16 v[52:55], v[16:19], v[252:255], v[52:55]
  s_waitcnt lgkmcnt(6)
  v_mfma_f32_16x16x32_bf16 v[64:67], v[248:251], v[20:23], v[64:67]
  s_barrier
  ds_read_b64_tr_b16 v[16:17], v7 offset:0
  v_mfma_f32_16x16x32_bf16 v[68:71], v[252:255], v[20:23], v[68:71]
  ds_read_b64_tr_b16 v[18:19], v7 offset:256
  s_waitcnt lgkmcnt(6)
  v_mfma_f32_16x16x32_bf16 v[40:43], v[24:27], v[248:251], v[40:43]
  ds_read_b64_tr_b16 v[20:21], v8 offset:0
  ds_read_b64_tr_b16 v[22:23], v8 offset:256
  v_mfma_f32_16x16x32_bf16 v[44:47], v[24:27], v[252:255], v[44:47]
  v_mfma_f32_16x16x32_bf16 v[92:95], v[84:87], v[252:255], v[92:95]
  s_waitcnt lgkmcnt(6)
  v_mfma_f32_16x16x32_bf16 v[56:59], v[28:31], v[248:251], v[56:59]
  ds_read_b64_tr_b16 v[24:25], v7 offset:1024
  ds_read_b64_tr_b16 v[26:27], v7 offset:1280
  v_mfma_f32_16x16x32_bf16 v[60:63], v[28:31], v[252:255], v[60:63]
  s_waitcnt lgkmcnt(6)
  v_mfma_f32_16x16x32_bf16 v[72:75], v[248:251], v[12:15], v[72:75]
  ds_read_b64_tr_b16 v[28:29], v7 offset:3072
  ds_read_b64_tr_b16 v[30:31], v7 offset:3328
  v_mfma_f32_16x16x32_bf16 v[76:79], v[252:255], v[12:15], v[76:79]
  v_cndmask_b32 v1, v88, v92, s[64:65]
  v_lshrrev_b32 v2, 2, v0
  v_mul_f32 v1, 0x3fb8aa3b, v1
  s_mov_b32 exec_hi, 0
  buffer_store_dword v1, v2, s[4:7], s93 offen sc1
  s_mov_b32 exec_hi, -1
  s_branch G_P2
.p2align 12
.fill 2, 4, 0xBF800000
G_V2:
  v_and_b32_e64 v14, 63, v0
  s_load_dwordx2 s[4:5], s[0:1], 80
  s_load_dwordx2 s[40:41], s[0:1], 72
  s_load_dwordx2 s[16:17], s[0:1], 32
  s_load_dwordx2 s[20:21], s[0:1], 40
  s_load_dwordx2 s[24:25], s[0:1], 48
  s_load_dwordx2 s[28:29], s[0:1], 16
  s_load_dwordx2 s[32:33], s[0:1], 64
  s_bfe_u32 s46, s2, 0x10002
  s_lshl_b32 s46, s46, 3
  s_bfe_u32 s50, s2, 0x30003
  s_add_u32 s46, s46, s50
  s_and_b32 s47, s2, 3
  s_lshl_b32 s47, s47, 2
  s_lshr_b32 s50, s2, 6
  s_add_u32 s47, s47, s50
  s_add_u32 s49, s50, s46
  s_lshl_b32 s49, s49, 2
  s_lshr_b32 s50, s47, 2
  s_add_u32 s49, s49, s50
  s_lshr_b32 s50, s46, 3
  s_lshl_b32 s50, s50, 1
  s_add_u32 s49, s49, s50
  s_and_b32 s45, s44, 3
  s_mov_b32 s6, 0x1000000
  s_mov_b32 s7, 0x20000
  s_mov_b32 s42, 0x100
  s_mov_b32 s43, 0x20000
  s_mov_b32 s18, 0x158000
  s_mov_b32 s19, 0x20000
  s_mov_b32 s22, 0x158000
  s_mov_b32 s23, 0x20000
  s_mov_b32 s26, 0x158000
  s_mov_b32 s27, 0x20000
  s_mov_b32 s30, 0x80000
  s_mov_b32 s31, 0x20000
  s_mov_b32 s34, 0x200000
  s_mov_b32 s35, 0x20000
  s_movk_i32 s50, 0x4924
  s_bitcmp1_b32 s50, s47
  s_cselect_b32 s63, 0x40000000, 0
  s_bfm_b32 s3, s47, 0
  s_and_b32 s3, s3, s50
  s_bcnt1_i32_b32 s3, s3
  s_mul_i32 s48, s47, 3
  s_sub_u32 s48, s48, s3
  s_and_b32 s53, s2, 7
  s_lshl_b32 s53, s53, 2
  s_bfe_u32 s50, s2, 0x20003
  s_add_u32 s53, s53, s50
  s_lshr_b32 s54, s2, 5
  s_lshl_b32 s98, s45, 10
  s_lshl_b32 s99, s45, 14
  s_lshl_b32 s50, s54, 7
  s_add_u32 s99, s99, s50
  s_lshl_b32 s101, s53, 1
  s_add_u32 s101, s101, s54
  s_and_b32 s101, s101, 7
  s_mul_i32 s62, s101, 21
  s_lshr_b32 s62, s62, 3
  s_lshl_b32 s62, s62, 16
  s_lshl_b32 s101, s101, 16
  v_lshlrev_b32 v0, 4, v14
  v_and_b32 v12, 15, v14
  v_lshrrev_b32 v13, 4, v14
  v_bfe_u32 v1, v14, 1, 3
  v_xor_b32 v1, v1, v13
  v_lshlrev_b32 v1, 4, v1
  v_lshl_add_u32 v1, v12, 7, v1
  s_lshl_b32 s50, s45, 12
  v_add_u32 v1, s50, v1
  v_xor_b32_e64 v2, 64, v1
  v_add_u32 v3, 57344, v1
  v_add_u32 v4, 57344, v2
  v_bfe_u32 v12, v14, 2, 2
  v_lshlrev_b32 v12, 6, v12
  v_and_b32 v13, 3, v14
  v_lshl_add_u32 v12, v13, 3, v12
  v_bfe_u32 v13, v14, 4, 1
  v_cmp_ne_u32 s[64:65], 0, v13
  v_mul_u32_u24 v13, 544, v13
  v_add_u32 v12, v12, v13
  v_lshrrev_b32 v13, 5, v14
  v_mul_u32_u24 v13, 3072, v13
  v_add_u32_e64 v12, v12, v13
  v_add_u32 v112, 16384, v12
  v_add_u32 v7, v12, v13
  v_xor_b32 v113, 32, v112
  v_add_u32 v114, 57344, v112
  v_add_u32 v115, 57344, v113
  v_xor_b32_e64 v8, 32, v7
  v_add_u32 v9, 57344, v7
  v_add_u32 v10, 57344, v8
  s_waitcnt lgkmcnt(0)
  s_cmp_eq_u32 s45, 1
  s_cselect_b32 s68, s20, s16
  s_cselect_b32 s69, s21, s17
  s_cmp_eq_u32 s45, 2
  s_cselect_b32 s68, s24, s68
  s_cselect_b32 s69, s25, s69
  s_mov_b32 s70, 1409024
  s_cmp_eq_u32 s45, 3
  s_cselect_b32 s68, s28, s68
  s_cselect_b32 s69, s29, s69
  s_cselect_b32 s70, 524288, s70
  s_mov_b32 s71, 0x20000
  s_mov_b32 s50, s3
  s_lshr_b32 s85, s45, 1
  s_cmp_eq_u32 s63, 0
  s_cbranch_scc1 GH7
  s_mul_i32 s51, s46, 5
  s_add_u32 s50, s50, s51
  s_mul_i32 s50, s50, 3
  s_cmp_eq_u32 s45, 2
  s_cselect_b32 s88, 46, 46
  s_cmp_eq_u32 s45, 3
  s_cselect_b32 s88, 18, s88
  s_add_u32 s85, s85, 1
  s_cmp_eq_u32 s45, 3
  s_cselect_b32 s85, 0, s85
  s_mov_b32 s52, 0
  s_branch GH7J
GH7:
  s_sub_u32 s50, s47, s50
  s_mul_i32 s51, s46, 11
  s_add_u32 s50, s50, s51
  s_mul_i32 s85, s85, 3
  s_cmp_eq_u32 s45, 3
  s_cselect_b32 s88, 24, 1
  s_cselect_b32 s52, 0, 1413120
  s_cselect_b32 s85, s85, 0
GH7J:
  s_bfm_b64 s[86:87], s88, 0
  s_lshl_b32 s88, s88, 7
  s_lshl_b32 s89, s88, 1
  s_mul_i32 s50, s50, s88
  s_add_u32 s50, s50, s52
  v_lshl_add_u32 v98, v14, 7, s50
  s_cmp_lg_u32 s85, 3
  s_cbranch_scc1 GL8
  s_mov_b64 exec, s[86:87]
  buffer_load_dword v99, v98, s[68:71], 0 offen
  s_mov_b64 exec, -1
GL8:
  s_lshr_b32 s84, s2, 3
  s_and_b32 s84, s84, 7
  s_lshl_b32 s51, s46, 12
  s_add_u32 s51, s51, s98
  s_mul_i32 s76, s47, 393216
  s_add_u32 s76, s76, s51
  s_add_u32 s77, s76, 65536
  s_add_u32 s78, s76, 131072
  s_add_u32 s79, s76, 196608
  s_add_u32 s80, s76, 262144
  s_add_u32 s81, s76, 327680
  s_cmp_lt_u32 s76, 2097152
  s_cselect_b32 s90, 1, 0
  s_cmp_lt_u32 s78, 2097152
  s_cselect_b32 s91, 1, 0
  s_cmp_lt_u32 s80, 2097152
  s_cselect_b32 s92, 1, 0
  s_setprio 2
  s_barrier
  ds_read_b128 v[128:131], v1 offset:0
  ds_read_b128 v[132:135], v1 offset:2048
  ds_read_b64_tr_b16 v[12:13], v112 offset:0
  ds_read_b64_tr_b16 v[14:15], v112 offset:256
  ds_read_b64_tr_b16 v[16:17], v112 offset:1024
  ds_read_b64_tr_b16 v[18:19], v112 offset:1280
  ds_read_b64_tr_b16 v[20:21], v112 offset:2048
  ds_read_b64_tr_b16 v[22:23], v112 offset:2304
  ds_read_b64_tr_b16 v[24:25], v113 offset:0
  ds_read_b64_tr_b16 v[26:27], v113 offset:256
  s_waitcnt lgkmcnt(6)
  v_mfma_f32_16x16x32_bf16 v[32:35], v[128:131], v[12:15], 0
  ds_read_b64_tr_b16 v[28:29], v113 offset:1024
  ds_read_b64_tr_b16 v[30:31], v113 offset:1280
  v_mfma_f32_16x16x32_bf16 v[36:39], v[132:135], v[12:15], 0
  s_waitcnt lgkmcnt(6)
  v_mfma_f32_16x16x32_bf16 v[48:51], v[128:131], v[16:19], 0
  ds_read_b64_tr_b16 v[12:13], v113 offset:2048
  ds_read_b64_tr_b16 v[14:15], v113 offset:2304
  v_mfma_f32_16x16x32_bf16 v[52:55], v[132:135], v[16:19], 0
  s_waitcnt lgkmcnt(6)
  v_mfma_f32_16x16x32_bf16 v[64:67], v[128:131], v[20:23], 0
  ds_read_b128 v[136:139], v2 offset:0
  ds_read_b128 v[140:143], v2 offset:2048
  v_mfma_f32_16x16x32_bf16 v[68:71], v[132:135], v[20:23], 0
  ds_read_b64_tr_b16 v[16:17], v112 offset:6144
  ds_read_b64_tr_b16 v[18:19], v112 offset:6400
  s_waitcnt lgkmcnt(8)
  v_mfma_f32_16x16x32_bf16 v[40:43], v[128:131], v[24:27], 0
  ds_read_b64_tr_b16 v[20:21], v112 offset:7168
  ds_read_b64_tr_b16 v[22:23], v112 offset:7424
  v_mfma_f32_16x16x32_bf16 v[44:47], v[132:135], v[24:27], 0
  s_waitcnt lgkmcnt(8)
  v_mfma_f32_16x16x32_bf16 v[56:59], v[128:131], v[28:31], 0
  ds_read_b64_tr_b16 v[24:25], v112 offset:8192
  ds_read_b64_tr_b16 v[26:27], v112 offset:8448
  v_mfma_f32_16x16x32_bf16 v[60:63], v[132:135], v[28:31], 0
  s_waitcnt lgkmcnt(8)
  v_mfma_f32_16x16x32_bf16 v[72:75], v[128:131], v[12:15], 0
  ds_read_b64_tr_b16 v[28:29], v113 offset:6144
  ds_read_b64_tr_b16 v[30:31], v113 offset:6400
  v_mfma_f32_16x16x32_bf16 v[76:79], v[132:135], v[12:15], 0
  s_waitcnt lgkmcnt(6)
  v_mfma_f32_16x16x32_bf16 v[32:35], v[136:139], v[16:19], v[32:35]
  ds_read_b64_tr_b16 v[12:13], v113 offset:7168
  ds_read_b64_tr_b16 v[14:15], v113 offset:7424
  v_mfma_f32_16x16x32_bf16 v[36:39], v[140:143], v[16:19], v[36:39]
  s_waitcnt lgkmcnt(6)
  v_mfma_f32_16x16x32_bf16 v[48:51], v[136:139], v[20:23], v[48:51]
  ds_read_b64_tr_b16 v[16:17], v113 offset:8192
  ds_read_b64_tr_b16 v[18:19], v113 offset:8448
  v_mfma_f32_16x16x32_bf16 v[52:55], v[140:143], v[20:23], v[52:55]
  s_waitcnt lgkmcnt(6)
  v_mfma_f32_16x16x32_bf16 v[64:67], v[136:139], v[24:27], v[64:67]
  s_barrier
  ds_read_b128 v[144:147], v1 offset:28672
  ds_read_b128 v[148:151], v1 offset:30720
  v_mfma_f32_16x16x32_bf16 v[68:71], v[140:143], v[24:27], v[68:71]
  ds_read_b64_tr_b16 v[20:21], v112 offset:28672
  ds_read_b64_tr_b16 v[22:23], v112 offset:28928
  s_waitcnt lgkmcnt(8)
  v_mfma_f32_16x16x32_bf16 v[40:43], v[136:139], v[28:31], v[40:43]
  ds_read_b64_tr_b16 v[24:25], v112 offset:29696
  ds_read_b64_tr_b16 v[26:27], v112 offset:29952
  v_mfma_f32_16x16x32_bf16 v[44:47], v[140:143], v[28:31], v[44:47]
  s_waitcnt lgkmcnt(8)
  v_mfma_f32_16x16x32_bf16 v[56:59], v[136:139], v[12:15], v[56:59]
  ds_read_b64_tr_b16 v[28:29], v112 offset:30720
  ds_read_b64_tr_b16 v[30:31], v112 offset:30976
  v_mfma_f32_16x16x32_bf16 v[60:63], v[140:143], v[12:15], v[60:63]
  s_waitcnt lgkmcnt(8)
  v_mfma_f32_16x16x32_bf16 v[72:75], v[136:139], v[16:19], v[72:75]
  ds_read_b64_tr_b16 v[12:13], v113 offset:28672
  ds_read_b64_tr_b16 v[14:15], v113 offset:28928
  v_mfma_f32_16x16x32_bf16 v[76:79], v[140:143], v[16:19], v[76:79]
  s_waitcnt lgkmcnt(6)
  v_mfma_f32_16x16x32_bf16 v[32:35], v[144:147], v[20:23], v[32:35]
  ds_read_b64_tr_b16 v[16:17], v113 offset:29696
  ds_read_b64_tr_b16 v[18:19], v113 offset:29952
  v_mfma_f32_16x16x32_bf16 v[36:39], v[148:151], v[20:23], v[36:39]
  s_waitcnt lgkmcnt(6)
  v_mfma_f32_16x16x32_bf16 v[48:51], v[144:147], v[24:27], v[48:51]
  ds_read_b64_tr_b16 v[20:21], v113 offset:30720
  ds_read_b64_tr_b16 v[22:23], v113 offset:30976
  v_mfma_f32_16x16x32_bf16 v[52:55], v[148:151], v[24:27], v[52:55]
  s_waitcnt lgkmcnt(6)
  v_mfma_f32_16x16x32_bf16 v[64:67], v[144:147], v[28:31], v[64:67]
  ds_read_b128 v[152:155], v2 offset:28672
  ds_read_b128 v[156:159], v2 offset:30720
  v_mfma_f32_16x16x32_bf16 v[68:71], v[148:151], v[28:31], v[68:71]
  ds_read_b64_tr_b16 v[24:25], v112 offset:34816
  ds_read_b64_tr_b16 v[26:27], v112 offset:35072
  s_waitcnt lgkmcnt(8)
  v_mfma_f32_16x16x32_bf16 v[40:43], v[144:147], v[12:15], v[40:43]
  ds_read_b64_tr_b16 v[28:29], v112 offset:35840
  ds_read_b64_tr_b16 v[30:31], v112 offset:36096
  v_mfma_f32_16x16x32_bf16 v[44:47], v[148:151], v[12:15], v[44:47]
  s_cmp_lg_u32 s85, 1
  s_cbranch_scc1 GL9
  s_mov_b64 exec, s[86:87]
  buffer_load_dword v99, v98, s[68:71], 0 offen
  s_mov_b64 exec, -1
GL9:
  s_cmp_lg_u32 s85, 2
  s_cbranch_scc1 GL10
  s_mov_b64 exec, s[86:87]
  buffer_load_dword v99, v98, s[68:71], 0 offen
  s_mov_b64 exec, -1
GL10:
  s_waitcnt lgkmcnt(8)
  v_mfma_f32_16x16x32_bf16 v[56:59], v[144:147], v[16:19], v[56:59]
  ds_read_b64_tr_b16 v[12:13], v112 offset:36864
  ds_read_b64_tr_b16 v[14:15], v112 offset:37120
  v_mfma_f32_16x16x32_bf16 v[60:63], v[148:151], v[16:19], v[60:63]
  s_cmp_lg_u32 s85, 1
  s_cbranch_scc1 GL11
  s_mov_b64 exec, s[86:87]
  buffer_load_dword v103, v98, s[68:71], s88 offen
  s_mov_b64 exec, -1
GL11:
  s_cmp_lg_u32 s85, 2
  s_cbranch_scc1 GL12
  s_mov_b64 exec, s[86:87]
  buffer_load_dword v103, v98, s[68:71], s88 offen
  s_mov_b64 exec, -1
GL12:
  s_waitcnt lgkmcnt(8)
  v_mfma_f32_16x16x32_bf16 v[72:75], v[144:147], v[20:23], v[72:75]
  ds_read_b64_tr_b16 v[16:17], v113 offset:34816
  ds_read_b64_tr_b16 v[18:19], v113 offset:35072
  v_mfma_f32_16x16x32_bf16 v[76:79], v[148:151], v[20:23], v[76:79]
  s_cmp_lg_u32 s85, 1
  s_cbranch_scc1 GL13
  s_mov_b64 exec, s[86:87]
  buffer_load_dword v107, v98, s[68:71], s89 offen
  s_mov_b64 exec, -1
GL13:
  s_cmp_lg_u32 s85, 2
  s_cbranch_scc1 GL14
  s_mov_b64 exec, s[86:87]
  buffer_load_dword v107, v98, s[68:71], s89 offen
  s_mov_b64 exec, -1
GL14:
  s_waitcnt lgkmcnt(6)
  v_mfma_f32_16x16x32_bf16 v[32:35], v[152:155], v[24:27], v[32:35]
  ds_read_b64_tr_b16 v[20:21], v113 offset:35840
  ds_read_b64_tr_b16 v[22:23], v113 offset:36096
  v_mfma_f32_16x16x32_bf16 v[36:39], v[156:159], v[24:27], v[36:39]
  s_waitcnt lgkmcnt(6)
  v_mfma_f32_16x16x32_bf16 v[48:51], v[152:155], v[28:31], v[48:51]
  ds_read_b64_tr_b16 v[24:25], v113 offset:36864
  ds_read_b64_tr_b16 v[26:27], v113 offset:37120
  v_mfma_f32_16x16x32_bf16 v[52:55], v[156:159], v[28:31], v[52:55]
  s_waitcnt lgkmcnt(6)
  v_mfma_f32_16x16x32_bf16 v[64:67], v[152:155], v[12:15], v[64:67]
  s_barrier
  ds_read_b128 v[160:163], v3 offset:0
  ds_read_b128 v[164:167], v3 offset:2048
  v_mfma_f32_16x16x32_bf16 v[68:71], v[156:159], v[12:15], v[68:71]
  ds_read_b64_tr_b16 v[28:29], v114 offset:0
  ds_read_b64_tr_b16 v[30:31], v114 offset:256
  s_waitcnt lgkmcnt(8)
  v_mfma_f32_16x16x32_bf16 v[40:43], v[152:155], v[16:19], v[40:43]
  ds_read_b64_tr_b16 v[12:13], v114 offset:1024
  ds_read_b64_tr_b16 v[14:15], v114 offset:1280
  v_mfma_f32_16x16x32_bf16 v[44:47], v[156:159], v[16:19], v[44:47]
  s_waitcnt lgkmcnt(8)
  v_mfma_f32_16x16x32_bf16 v[56:59], v[152:155], v[20:23], v[56:59]
  ds_read_b64_tr_b16 v[16:17], v114 offset:2048
  ds_read_b64_tr_b16 v[18:19], v114 offset:2304
  v_mfma_f32_16x16x32_bf16 v[60:63], v[156:159], v[20:23], v[60:63]
  s_waitcnt lgkmcnt(8)
  v_mfma_f32_16x16x32_bf16 v[72:75], v[152:155], v[24:27], v[72:75]
  ds_read_b64_tr_b16 v[20:21], v115 offset:0
  ds_read_b64_tr_b16 v[22:23], v115 offset:256
  v_mfma_f32_16x16x32_bf16 v[76:79], v[156:159], v[24:27], v[76:79]
  s_waitcnt lgkmcnt(6)
  v_mfma_f32_16x16x32_bf16 v[32:35], v[160:163], v[28:31], v[32:35]
  ds_read_b64_tr_b16 v[24:25], v115 offset:1024
  ds_read_b64_tr_b16 v[26:27], v115 offset:1280
  v_mfma_f32_16x16x32_bf16 v[36:39], v[164:167], v[28:31], v[36:39]
  s_waitcnt lgkmcnt(6)
  v_mfma_f32_16x16x32_bf16 v[48:51], v[160:163], v[12:15], v[48:51]
  ds_read_b64_tr_b16 v[28:29], v115 offset:2048
  ds_read_b64_tr_b16 v[30:31], v115 offset:2304
  v_mfma_f32_16x16x32_bf16 v[52:55], v[164:167], v[12:15], v[52:55]
  s_waitcnt lgkmcnt(6)
  v_mfma_f32_16x16x32_bf16 v[64:67], v[160:163], v[16:19], v[64:67]
  ds_read_b128 v[168:171], v4 offset:0
  ds_read_b128 v[172:175], v4 offset:2048
  v_mfma_f32_16x16x32_bf16 v[68:71], v[164:167], v[16:19], v[68:71]
  ds_read_b64_tr_b16 v[12:13], v114 offset:6144
  ds_read_b64_tr_b16 v[14:15], v114 offset:6400
  s_waitcnt lgkmcnt(8)
  v_mfma_f32_16x16x32_bf16 v[40:43], v[160:163], v[20:23], v[40:43]
  ds_read_b64_tr_b16 v[16:17], v114 offset:7168
  ds_read_b64_tr_b16 v[18:19], v114 offset:7424
  v_mfma_f32_16x16x32_bf16 v[44:47], v[164:167], v[20:23], v[44:47]
  s_waitcnt lgkmcnt(8)
  v_mfma_f32_16x16x32_bf16 v[56:59], v[160:163], v[24:27], v[56:59]
  ds_read_b64_tr_b16 v[20:21], v114 offset:8192
  ds_read_b64_tr_b16 v[22:23], v114 offset:8448
  v_mfma_f32_16x16x32_bf16 v[60:63], v[164:167], v[24:27], v[60:63]
  s_waitcnt lgkmcnt(8)
  v_mfma_f32_16x16x32_bf16 v[72:75], v[160:163], v[28:31], v[72:75]
  ds_read_b64_tr_b16 v[24:25], v115 offset:6144
  ds_read_b64_tr_b16 v[26:27], v115 offset:6400
  v_mfma_f32_16x16x32_bf16 v[76:79], v[164:167], v[28:31], v[76:79]
  s_waitcnt lgkmcnt(6)
  v_mfma_f32_16x16x32_bf16 v[32:35], v[168:171], v[12:15], v[32:35]
  ds_read_b64_tr_b16 v[28:29], v115 offset:7168
  ds_read_b64_tr_b16 v[30:31], v115 offset:7424
  v_mfma_f32_16x16x32_bf16 v[36:39], v[172:175], v[12:15], v[36:39]
  s_waitcnt lgkmcnt(6)
  v_mfma_f32_16x16x32_bf16 v[48:51], v[168:171], v[16:19], v[48:51]
  ds_read_b64_tr_b16 v[12:13], v115 offset:8192
  ds_read_b64_tr_b16 v[14:15], v115 offset:8448
  v_mfma_f32_16x16x32_bf16 v[52:55], v[172:175], v[16:19], v[52:55]
  s_waitcnt lgkmcnt(6)
  v_mfma_f32_16x16x32_bf16 v[64:67], v[168:171], v[20:23], v[64:67]
  s_barrier
  ds_read_b128 v[176:179], v3 offset:28672
  ds_read_b128 v[180:183], v3 offset:30720
  v_mfma_f32_16x16x32_bf16 v[68:71], v[172:175], v[20:23], v[68:71]
  ds_read_b64_tr_b16 v[16:17], v114 offset:28672
  ds_read_b64_tr_b16 v[18:19], v114 offset:28928
  s_waitcnt lgkmcnt(8)
  v_mfma_f32_16x16x32_bf16 v[40:43], v[168:171], v[24:27], v[40:43]
  ds_read_b64_tr_b16 v[20:21], v114 offset:29696
  ds_read_b64_tr_b16 v[22:23], v114 offset:29952
  v_mfma_f32_16x16x32_bf16 v[44:47], v[172:175], v[24:27], v[44:47]
  s_waitcnt lgkmcnt(8)
  v_mfma_f32_16x16x32_bf16 v[56:59], v[168:171], v[28:31], v[56:59]
  ds_read_b64_tr_b16 v[24:25], v114 offset:30720
  ds_read_b64_tr_b16 v[26:27], v114 offset:30976
  v_mfma_f32_16x16x32_bf16 v[60:63], v[172:175], v[28:31], v[60:63]
  s_waitcnt lgkmcnt(8)
  v_mfma_f32_16x16x32_bf16 v[72:75], v[168:171], v[12:15], v[72:75]
  ds_read_b64_tr_b16 v[28:29], v115 offset:28672
  ds_read_b64_tr_b16 v[30:31], v115 offset:28928
  v_mfma_f32_16x16x32_bf16 v[76:79], v[172:175], v[12:15], v[76:79]
  s_waitcnt lgkmcnt(6)
  v_mfma_f32_16x16x32_bf16 v[32:35], v[176:179], v[16:19], v[32:35]
  ds_read_b64_tr_b16 v[12:13], v115 offset:29696
  ds_read_b64_tr_b16 v[14:15], v115 offset:29952
  v_mfma_f32_16x16x32_bf16 v[36:39], v[180:183], v[16:19], v[36:39]
  s_waitcnt lgkmcnt(6)
  v_mfma_f32_16x16x32_bf16 v[48:51], v[176:179], v[20:23], v[48:51]
  ds_read_b64_tr_b16 v[16:17], v115 offset:30720
  ds_read_b64_tr_b16 v[18:19], v115 offset:30976
  v_mfma_f32_16x16x32_bf16 v[52:55], v[180:183], v[20:23], v[52:55]
  s_waitcnt lgkmcnt(6)
  v_mfma_f32_16x16x32_bf16 v[64:67], v[176:179], v[24:27], v[64:67]
  ds_read_b128 v[184:187], v4 offset:28672
  ds_read_b128 v[188:191], v4 offset:30720
  v_mfma_f32_16x16x32_bf16 v[68:71], v[180:183], v[24:27], v[68:71]
  ds_read_b64_tr_b16 v[20:21], v114 offset:34816
  ds_read_b64_tr_b16 v[22:23], v114 offset:35072
  s_waitcnt lgkmcnt(8)
  v_mfma_f32_16x16x32_bf16 v[40:43], v[176:179], v[28:31], v[40:43]
  ds_read_b64_tr_b16 v[24:25], v114 offset:35840
  ds_read_b64_tr_b16 v[26:27], v114 offset:36096
  v_mfma_f32_16x16x32_bf16 v[44:47], v[180:183], v[28:31], v[44:47]
  s_waitcnt lgkmcnt(8)
  v_mfma_f32_16x16x32_bf16 v[56:59], v[176:179], v[12:15], v[56:59]
  ds_read_b64_tr_b16 v[28:29], v114 offset:36864
  ds_read_b64_tr_b16 v[30:31], v114 offset:37120
  v_mfma_f32_16x16x32_bf16 v[60:63], v[180:183], v[12:15], v[60:63]
  s_waitcnt lgkmcnt(8)
  v_mfma_f32_16x16x32_bf16 v[72:75], v[176:179], v[16:19], v[72:75]
  ds_read_b64_tr_b16 v[12:13], v115 offset:34816
  ds_read_b64_tr_b16 v[14:15], v115 offset:35072
  v_mfma_f32_16x16x32_bf16 v[76:79], v[180:183], v[16:19], v[76:79]
  s_waitcnt lgkmcnt(6)
  v_mfma_f32_16x16x32_bf16 v[32:35], v[184:187], v[20:23], v[32:35]
  ds_read_b64_tr_b16 v[16:17], v115 offset:35840
  ds_read_b64_tr_b16 v[18:19], v115 offset:36096
  v_mfma_f32_16x16x32_bf16 v[36:39], v[188:191], v[20:23], v[36:39]
  s_waitcnt lgkmcnt(6)
  v_mfma_f32_16x16x32_bf16 v[48:51], v[184:187], v[24:27], v[48:51]
  ds_read_b64_tr_b16 v[20:21], v115 offset:36864
  ds_read_b64_tr_b16 v[22:23], v115 offset:37120
  v_mfma_f32_16x16x32_bf16 v[52:55], v[188:191], v[24:27], v[52:55]
  s_waitcnt lgkmcnt(6)
  v_mfma_f32_16x16x32_bf16 v[64:67], v[184:187], v[28:31], v[64:67]
  s_barrier
  ds_read_b128 v[192:195], v1 offset:0
  ds_read_b128 v[196:199], v1 offset:2048
  v_mfma_f32_16x16x32_bf16 v[68:71], v[188:191], v[28:31], v[68:71]
  ds_read_b64_tr_b16 v[24:25], v112 offset:0
  ds_read_b64_tr_b16 v[26:27], v112 offset:256
  s_waitcnt lgkmcnt(8)
  v_mfma_f32_16x16x32_bf16 v[40:43], v[184:187], v[12:15], v[40:43]
  ds_read_b64_tr_b16 v[28:29], v112 offset:1024
  ds_read_b64_tr_b16 v[30:31], v112 offset:1280
  v_mfma_f32_16x16x32_bf16 v[44:47], v[188:191], v[12:15], v[44:47]
  s_waitcnt lgkmcnt(8)
  v_mfma_f32_16x16x32_bf16 v[56:59], v[184:187], v[16:19], v[56:59]
  ds_read_b64_tr_b16 v[12:13], v112 offset:2048
  ds_read_b64_tr_b16 v[14:15], v112 offset:2304
  v_mfma_f32_16x16x32_bf16 v[60:63], v[188:191], v[16:19], v[60:63]
  s_waitcnt lgkmcnt(8)
  v_mfma_f32_16x16x32_bf16 v[72:75], v[184:187], v[20:23], v[72:75]
  ds_read_b64_tr_b16 v[16:17], v113 offset:0
  ds_read_b64_tr_b16 v[18:19], v113 offset:256
  v_mfma_f32_16x16x32_bf16 v[76:79], v[188:191], v[20:23], v[76:79]
  s_waitcnt lgkmcnt(6)
  v_mfma_f32_16x16x32_bf16 v[32:35], v[192:195], v[24:27], v[32:35]
  ds_read_b64_tr_b16 v[20:21], v113 offset:1024
  ds_read_b64_tr_b16 v[22:23], v113 offset:1280
  v_mfma_f32_16x16x32_bf16 v[36:39], v[196:199], v[24:27], v[36:39]
  s_waitcnt lgkmcnt(6)
  v_mfma_f32_16x16x32_bf16 v[48:51], v[192:195], v[28:31], v[48:51]
  ds_read_b64_tr_b16 v[24:25], v113 offset:2048
  ds_read_b64_tr_b16 v[26:27], v113 offset:2304
  v_mfma_f32_16x16x32_bf16 v[52:55], v[196:199], v[28:31], v[52:55]
  s_waitcnt lgkmcnt(6)
  v_mfma_f32_16x16x32_bf16 v[64:67], v[192:195], v[12:15], v[64:67]
  ds_read_b128 v[200:203], v2 offset:0
  ds_read_b128 v[204:207], v2 offset:2048
  v_mfma_f32_16x16x32_bf16 v[68:71], v[196:199], v[12:15], v[68:71]
  ds_read_b64_tr_b16 v[28:29], v112 offset:6144
  ds_read_b64_tr_b16 v[30:31], v112 offset:6400
  s_waitcnt lgkmcnt(8)
  v_mfma_f32_16x16x32_bf16 v[40:43], v[192:195], v[16:19], v[40:43]
  ds_read_b64_tr_b16 v[12:13], v112 offset:7168
  ds_read_b64_tr_b16 v[14:15], v112 offset:7424
  v_mfma_f32_16x16x32_bf16 v[44:47], v[196:199], v[16:19], v[44:47]
  s_waitcnt lgkmcnt(8)
  v_mfma_f32_16x16x32_bf16 v[56:59], v[192:195], v[20:23], v[56:59]
  ds_read_b64_tr_b16 v[16:17], v112 offset:8192
  ds_read_b64_tr_b16 v[18:19], v112 offset:8448
  v_mfma_f32_16x16x32_bf16 v[60:63], v[196:199], v[20:23], v[60:63]
  s_waitcnt lgkmcnt(8)
  v_mfma_f32_16x16x32_bf16 v[72:75], v[192:195], v[24:27], v[72:75]
  ds_read_b64_tr_b16 v[20:21], v113 offset:6144
  ds_read_b64_tr_b16 v[22:23], v113 offset:6400
  v_mfma_f32_16x16x32_bf16 v[76:79], v[196:199], v[24:27], v[76:79]
  s_waitcnt lgkmcnt(6)
  v_mfma_f32_16x16x32_bf16 v[32:35], v[200:203], v[28:31], v[32:35]
  ds_read_b64_tr_b16 v[24:25], v113 offset:7168
  ds_read_b64_tr_b16 v[26:27], v113 offset:7424
  v_mfma_f32_16x16x32_bf16 v[36:39], v[204:207], v[28:31], v[36:39]
  s_waitcnt lgkmcnt(6)
  v_mfma_f32_16x16x32_bf16 v[48:51], v[200:203], v[12:15], v[48:51]
  ds_read_b64_tr_b16 v[28:29], v113 offset:8192
  ds_read_b64_tr_b16 v[30:31], v113 offset:8448
  v_mfma_f32_16x16x32_bf16 v[52:55], v[204:207], v[12:15], v[52:55]
  s_waitcnt lgkmcnt(6)
  v_mfma_f32_16x16x32_bf16 v[64:67], v[200:203], v[16:19], v[64:67]
  s_barrier
  ds_read_b128 v[208:211], v1 offset:28672
  ds_read_b128 v[212:215], v1 offset:30720
  v_mfma_f32_16x16x32_bf16 v[68:71], v[204:207], v[16:19], v[68:71]
  ds_read_b64_tr_b16 v[12:13], v112 offset:28672
  ds_read_b64_tr_b16 v[14:15], v112 offset:28928
  s_waitcnt lgkmcnt(8)
  v_mfma_f32_16x16x32_bf16 v[40:43], v[200:203], v[20:23], v[40:43]
  ds_read_b64_tr_b16 v[16:17], v112 offset:29696
  ds_read_b64_tr_b16 v[18:19], v112 offset:29952
  v_mfma_f32_16x16x32_bf16 v[44:47], v[204:207], v[20:23], v[44:47]
  s_waitcnt lgkmcnt(8)
  v_mfma_f32_16x16x32_bf16 v[56:59], v[200:203], v[24:27], v[56:59]
  ds_read_b64_tr_b16 v[20:21], v112 offset:30720
  ds_read_b64_tr_b16 v[22:23], v112 offset:30976
  v_mfma_f32_16x16x32_bf16 v[60:63], v[204:207], v[24:27], v[60:63]
  s_waitcnt lgkmcnt(8)
  v_mfma_f32_16x16x32_bf16 v[72:75], v[200:203], v[28:31], v[72:75]
  ds_read_b64_tr_b16 v[24:25], v113 offset:28672
  ds_read_b64_tr_b16 v[26:27], v113 offset:28928
  v_mfma_f32_16x16x32_bf16 v[76:79], v[204:207], v[28:31], v[76:79]
  s_waitcnt lgkmcnt(6)
  v_mfma_f32_16x16x32_bf16 v[32:35], v[208:211], v[12:15], v[32:35]
  ds_read_b64_tr_b16 v[28:29], v113 offset:29696
  ds_read_b64_tr_b16 v[30:31], v113 offset:29952
  v_mfma_f32_16x16x32_bf16 v[36:39], v[212:215], v[12:15], v[36:39]
  s_waitcnt lgkmcnt(6)
  v_mfma_f32_16x16x32_bf16 v[48:51], v[208:211], v[16:19], v[48:51]
  ds_read_b64_tr_b16 v[12:13], v113 offset:30720
  ds_read_b64_tr_b16 v[14:15], v113 offset:30976
  v_mfma_f32_16x16x32_bf16 v[52:55], v[212:215], v[16:19], v[52:55]
  s_waitcnt lgkmcnt(6)
  v_mfma_f32_16x16x32_bf16 v[64:67], v[208:211], v[20:23], v[64:67]
  ds_read_b128 v[216:219], v2 offset:28672
  ds_read_b128 v[220:223], v2 offset:30720
  v_mfma_f32_16x16x32_bf16 v[68:71], v[212:215], v[20:23], v[68:71]
  ds_read_b64_tr_b16 v[16:17], v112 offset:34816
  ds_read_b64_tr_b16 v[18:19], v112 offset:35072
  s_waitcnt lgkmcnt(8)
  v_mfma_f32_16x16x32_bf16 v[40:43], v[208:211], v[24:27], v[40:43]
  ds_read_b64_tr_b16 v[20:21], v112 offset:35840
  ds_read_b64_tr_b16 v[22:23], v112 offset:36096
  v_mfma_f32_16x16x32_bf16 v[44:47], v[212:215], v[24:27], v[44:47]
  s_waitcnt lgkmcnt(8)
  v_mfma_f32_16x16x32_bf16 v[56:59], v[208:211], v[28:31], v[56:59]
  ds_read_b64_tr_b16 v[24:25], v112 offset:36864
  ds_read_b64_tr_b16 v[26:27], v112 offset:37120
  v_mfma_f32_16x16x32_bf16 v[60:63], v[212:215], v[28:31], v[60:63]
  s_waitcnt lgkmcnt(8)
  v_mfma_f32_16x16x32_bf16 v[72:75], v[208:211], v[12:15], v[72:75]
  ds_read_b64_tr_b16 v[28:29], v113 offset:34816
  ds_read_b64_tr_b16 v[30:31], v113 offset:35072
  v_mfma_f32_16x16x32_bf16 v[76:79], v[212:215], v[12:15], v[76:79]
  s_waitcnt lgkmcnt(6)
  v_mfma_f32_16x16x32_bf16 v[32:35], v[216:219], v[16:19], v[32:35]
  ds_read_b64_tr_b16 v[12:13], v113 offset:35840
  ds_read_b64_tr_b16 v[14:15], v113 offset:36096
  v_mfma_f32_16x16x32_bf16 v[36:39], v[220:223], v[16:19], v[36:39]
  s_waitcnt lgkmcnt(6)
  v_mfma_f32_16x16x32_bf16 v[48:51], v[216:219], v[20:23], v[48:51]
  ds_read_b64_tr_b16 v[16:17], v113 offset:36864
  ds_read_b64_tr_b16 v[18:19], v113 offset:37120
  v_mfma_f32_16x16x32_bf16 v[52:55], v[220:223], v[20:23], v[52:55]
  s_waitcnt lgkmcnt(6)
  v_mfma_f32_16x16x32_bf16 v[64:67], v[216:219], v[24:27], v[64:67]
  s_barrier
  ds_read_b128 v[224:227], v3 offset:0
  ds_read_b128 v[228:231], v3 offset:2048
  v_mfma_f32_16x16x32_bf16 v[68:71], v[220:223], v[24:27], v[68:71]
  ds_read_b64_tr_b16 v[20:21], v114 offset:0
  ds_read_b64_tr_b16 v[22:23], v114 offset:256
  s_waitcnt lgkmcnt(8)
  v_mfma_f32_16x16x32_bf16 v[40:43], v[216:219], v[28:31], v[40:43]
  ds_read_b64_tr_b16 v[24:25], v114 offset:1024
  ds_read_b64_tr_b16 v[26:27], v114 offset:1280
  v_mfma_f32_16x16x32_bf16 v[44:47], v[220:223], v[28:31], v[44:47]
  s_waitcnt lgkmcnt(8)
  v_mfma_f32_16x16x32_bf16 v[56:59], v[216:219], v[12:15], v[56:59]
  ds_read_b64_tr_b16 v[28:29], v114 offset:2048
  ds_read_b64_tr_b16 v[30:31], v114 offset:2304
  v_mfma_f32_16x16x32_bf16 v[60:63], v[220:223], v[12:15], v[60:63]
  s_waitcnt lgkmcnt(8)
  v_mfma_f32_16x16x32_bf16 v[72:75], v[216:219], v[16:19], v[72:75]
  ds_read_b64_tr_b16 v[12:13], v115 offset:0
  ds_read_b64_tr_b16 v[14:15], v115 offset:256
  v_mfma_f32_16x16x32_bf16 v[76:79], v[220:223], v[16:19], v[76:79]
  s_waitcnt lgkmcnt(6)
  v_mfma_f32_16x16x32_bf16 v[32:35], v[224:227], v[20:23], v[32:35]
  ds_read_b64_tr_b16 v[16:17], v115 offset:1024
  ds_read_b64_tr_b16 v[18:19], v115 offset:1280
  v_mfma_f32_16x16x32_bf16 v[36:39], v[228:231], v[20:23], v[36:39]
  s_waitcnt lgkmcnt(6)
  v_mfma_f32_16x16x32_bf16 v[48:51], v[224:227], v[24:27], v[48:51]
  ds_read_b64_tr_b16 v[20:21], v115 offset:2048
  ds_read_b64_tr_b16 v[22:23], v115 offset:2304
  v_mfma_f32_16x16x32_bf16 v[52:55], v[228:231], v[24:27], v[52:55]
  s_waitcnt lgkmcnt(6)
  v_mfma_f32_16x16x32_bf16 v[64:67], v[224:227], v[28:31], v[64:67]
  ds_read_b128 v[232:235], v4 offset:0
  ds_read_b128 v[236:239], v4 offset:2048
  v_mfma_f32_16x16x32_bf16 v[68:71], v[228:231], v[28:31], v[68:71]
  ds_read_b64_tr_b16 v[24:25], v114 offset:6144
  ds_read_b64_tr_b16 v[26:27], v114 offset:6400
  s_waitcnt lgkmcnt(8)
  v_mfma_f32_16x16x32_bf16 v[40:43], v[224:227], v[12:15], v[40:43]
  ds_read_b64_tr_b16 v[28:29], v114 offset:7168
  ds_read_b64_tr_b16 v[30:31], v114 offset:7424
  v_mfma_f32_16x16x32_bf16 v[44:47], v[228:231], v[12:15], v[44:47]
  s_waitcnt lgkmcnt(8)
  v_mfma_f32_16x16x32_bf16 v[56:59], v[224:227], v[16:19], v[56:59]
  ds_read_b64_tr_b16 v[12:13], v114 offset:8192
  ds_read_b64_tr_b16 v[14:15], v114 offset:8448
  v_mfma_f32_16x16x32_bf16 v[60:63], v[228:231], v[16:19], v[60:63]
  s_waitcnt lgkmcnt(8)
  v_mfma_f32_16x16x32_bf16 v[72:75], v[224:227], v[20:23], v[72:75]
  ds_read_b64_tr_b16 v[16:17], v115 offset:6144
  ds_read_b64_tr_b16 v[18:19], v115 offset:6400
  v_mfma_f32_16x16x32_bf16 v[76:79], v[228:231], v[20:23], v[76:79]
  s_waitcnt lgkmcnt(6)
  v_mfma_f32_16x16x32_bf16 v[32:35], v[232:235], v[24:27], v[32:35]
  ds_read_b64_tr_b16 v[20:21], v115 offset:7168
  ds_read_b64_tr_b16 v[22:23], v115 offset:7424
  v_mfma_f32_16x16x32_bf16 v[36:39], v[236:239], v[24:27], v[36:39]
  s_waitcnt lgkmcnt(6)
  v_mfma_f32_16x16x32_bf16 v[48:51], v[232:235], v[28:31], v[48:51]
  ds_read_b64_tr_b16 v[24:25], v115 offset:8192
  ds_read_b64_tr_b16 v[26:27], v115 offset:8448
  v_mfma_f32_16x16x32_bf16 v[52:55], v[236:239], v[28:31], v[52:55]
  s_waitcnt lgkmcnt(6)
  v_mfma_f32_16x16x32_bf16 v[64:67], v[232:235], v[12:15], v[64:67]
  s_barrier
  ds_read_b128 v[240:243], v3 offset:28672
  ds_read_b128 v[244:247], v3 offset:30720
  v_mfma_f32_16x16x32_bf16 v[68:71], v[236:239], v[12:15], v[68:71]
  ds_read_b64_tr_b16 v[28:29], v114 offset:28672
  ds_read_b64_tr_b16 v[30:31], v114 offset:28928
  s_waitcnt lgkmcnt(8)
  v_mfma_f32_16x16x32_bf16 v[40:43], v[232:235], v[16:19], v[40:43]
  ds_read_b64_tr_b16 v[12:13], v114 offset:29696
  ds_read_b64_tr_b16 v[14:15], v114 offset:29952
  v_mfma_f32_16x16x32_bf16 v[44:47], v[236:239], v[16:19], v[44:47]
  s_waitcnt lgkmcnt(8)
  v_mfma_f32_16x16x32_bf16 v[56:59], v[232:235], v[20:23], v[56:59]
  ds_read_b64_tr_b16 v[16:17], v114 offset:30720
  ds_read_b64_tr_b16 v[18:19], v114 offset:30976
  v_mfma_f32_16x16x32_bf16 v[60:63], v[236:239], v[20:23], v[60:63]
  s_waitcnt lgkmcnt(8)
  v_mfma_f32_16x16x32_bf16 v[72:75], v[232:235], v[24:27], v[72:75]
  ds_read_b64_tr_b16 v[20:21], v115 offset:28672
  ds_read_b64_tr_b16 v[22:23], v115 offset:28928
  v_mfma_f32_16x16x32_bf16 v[76:79], v[236:239], v[24:27], v[76:79]
  s_waitcnt lgkmcnt(6)
  v_mfma_f32_16x16x32_bf16 v[32:35], v[240:243], v[28:31], v[32:35]
  ds_read_b64_tr_b16 v[24:25], v115 offset:29696
  ds_read_b64_tr_b16 v[26:27], v115 offset:29952
  v_mfma_f32_16x16x32_bf16 v[36:39], v[244:247], v[28:31], v[36:39]
  s_waitcnt lgkmcnt(6)
  v_mfma_f32_16x16x32_bf16 v[48:51], v[240:243], v[12:15], v[48:51]
  ds_read_b64_tr_b16 v[28:29], v115 offset:30720
  ds_read_b64_tr_b16 v[30:31], v115 offset:30976
  v_mfma_f32_16x16x32_bf16 v[52:55], v[244:247], v[12:15], v[52:55]
  s_waitcnt lgkmcnt(6)
  v_mfma_f32_16x16x32_bf16 v[64:67], v[240:243], v[16:19], v[64:67]
  ds_read_b128 v[248:251], v4 offset:28672
  ds_read_b128 v[252:255], v4 offset:30720
  v_mfma_f32_16x16x32_bf16 v[68:71], v[244:247], v[16:19], v[68:71]
  ds_read_b64_tr_b16 v[12:13], v114 offset:34816
  ds_read_b64_tr_b16 v[14:15], v114 offset:35072
  s_waitcnt lgkmcnt(8)
  v_mfma_f32_16x16x32_bf16 v[40:43], v[240:243], v[20:23], v[40:43]
  ds_read_b64_tr_b16 v[16:17], v114 offset:35840
  ds_read_b64_tr_b16 v[18:19], v114 offset:36096
  v_mfma_f32_16x16x32_bf16 v[44:47], v[244:247], v[20:23], v[44:47]
  s_waitcnt lgkmcnt(8)
  v_mfma_f32_16x16x32_bf16 v[56:59], v[240:243], v[24:27], v[56:59]
  ds_read_b64_tr_b16 v[20:21], v114 offset:36864
  ds_read_b64_tr_b16 v[22:23], v114 offset:37120
  v_mfma_f32_16x16x32_bf16 v[60:63], v[244:247], v[24:27], v[60:63]
  s_waitcnt lgkmcnt(8)
  v_mfma_f32_16x16x32_bf16 v[72:75], v[240:243], v[28:31], v[72:75]
  ds_read_b64_tr_b16 v[24:25], v115 offset:34816
  ds_read_b64_tr_b16 v[26:27], v115 offset:35072
  v_mfma_f32_16x16x32_bf16 v[76:79], v[244:247], v[28:31], v[76:79]
  s_waitcnt vmcnt(0)
  s_waitcnt lgkmcnt(6)
  v_mfma_f32_16x16x32_bf16 v[32:35], v[248:251], v[12:15], v[32:35]
  ds_read_b64_tr_b16 v[28:29], v115 offset:35840
  ds_read_b64_tr_b16 v[30:31], v115 offset:36096
  v_mfma_f32_16x16x32_bf16 v[36:39], v[252:255], v[12:15], v[36:39]
  s_waitcnt lgkmcnt(6)
  v_mfma_f32_16x16x32_bf16 v[48:51], v[248:251], v[16:19], v[48:51]
  ds_read_b64_tr_b16 v[12:13], v115 offset:36864
  ds_read_b64_tr_b16 v[14:15], v115 offset:37120
  v_mfma_f32_16x16x32_bf16 v[52:55], v[252:255], v[16:19], v[52:55]
  s_waitcnt lgkmcnt(6)
  v_mfma_f32_16x16x32_bf16 v[64:67], v[248:251], v[20:23], v[64:67]
  s_barrier
  ds_read_b64_tr_b16 v[16:17], v7 offset:0
  v_mfma_f32_16x16x32_bf16 v[68:71], v[252:255], v[20:23], v[68:71]
  ds_read_b64_tr_b16 v[18:19], v7 offset:256
  s_waitcnt lgkmcnt(6)
  v_mfma_f32_16x16x32_bf16 v[40:43], v[248:251], v[24:27], v[40:43]
  ds_read_b64_tr_b16 v[20:21], v8 offset:0
  ds_read_b64_tr_b16 v[22:23], v8 offset:256
  v_mfma_f32_16x16x32_bf16 v[44:47], v[252:255], v[24:27], v[44:47]
  s_waitcnt lgkmcnt(6)
  v_mfma_f32_16x16x32_bf16 v[56:59], v[248:251], v[28:31], v[56:59]
  ds_read_b64_tr_b16 v[24:25], v7 offset:1024
  ds_read_b64_tr_b16 v[26:27], v7 offset:1280
  v_mfma_f32_16x16x32_bf16 v[60:63], v[252:255], v[28:31], v[60:63]
  s_waitcnt lgkmcnt(6)
  v_mfma_f32_16x16x32_bf16 v[72:75], v[248:251], v[12:15], v[72:75]
  ds_read_b64_tr_b16 v[28:29], v7 offset:3072
  ds_read_b64_tr_b16 v[30:31], v7 offset:3328
  v_mfma_f32_16x16x32_bf16 v[76:79], v[252:255], v[12:15], v[76:79]
  s_branch G_P2
.p2align 12
.fill 2, 4, 0xBF800000
G_V0:
  v_and_b32_e64 v14, 63, v0
  s_load_dwordx2 s[4:5], s[0:1], 80
  s_load_dwordx2 s[40:41], s[0:1], 72
  s_load_dwordx2 s[16:17], s[0:1], 32
  s_load_dwordx2 s[20:21], s[0:1], 40
  s_load_dwordx2 s[24:25], s[0:1], 48
  s_load_dwordx2 s[28:29], s[0:1], 16
  s_load_dwordx2 s[32:33], s[0:1], 64
  s_bfe_u32 s46, s2, 0x10002
  s_lshl_b32 s46, s46, 3
  s_bfe_u32 s50, s2, 0x30003
  s_add_u32 s46, s46, s50
  s_and_b32 s47, s2, 3
  s_lshl_b32 s47, s47, 2
  s_lshr_b32 s50, s2, 6
  s_add_u32 s47, s47, s50
  s_add_u32 s49, s50, s46
  s_lshl_b32 s49, s49, 2
  s_lshr_b32 s50, s47, 2
  s_add_u32 s49, s49, s50
  s_lshr_b32 s50, s46, 3
  s_lshl_b32 s50, s50, 1
  s_add_u32 s49, s49, s50
  s_and_b32 s45, s44, 3
  s_mov_b32 s6, 0x1000000
  s_mov_b32 s7, 0x20000
  s_mov_b32 s42, 0x100
  s_mov_b32 s43, 0x20000
  s_mov_b32 s18, 0x158000
  s_mov_b32 s19, 0x20000
  s_mov_b32 s22, 0x158000
  s_mov_b32 s23, 0x20000
  s_mov_b32 s26, 0x158000
  s_mov_b32 s27, 0x20000
  s_mov_b32 s30, 0x80000
  s_mov_b32 s31, 0x20000
  s_mov_b32 s34, 0x200000
  s_mov_b32 s35, 0x20000
  s_movk_i32 s50, 0x4924
  s_bitcmp1_b32 s50, s47
  s_cselect_b32 s63, 0x40000000, 0
  s_bfm_b32 s3, s47, 0
  s_and_b32 s3, s3, s50
  s_bcnt1_i32_b32 s3, s3
  s_mul_i32 s48, s47, 3
  s_sub_u32 s48, s48, s3
  s_and_b32 s53, s2, 7
  s_lshl_b32 s53, s53, 2
  s_bfe_u32 s50, s2, 0x20003
  s_add_u32 s53, s53, s50
  s_lshr_b32 s54, s2, 5
  s_lshl_b32 s98, s45, 10
  s_lshl_b32 s99, s45, 14
  s_lshl_b32 s50, s54, 7
  s_add_u32 s99, s99, s50
  s_lshl_b32 s101, s53, 1
  s_add_u32 s101, s101, s54
  s_and_b32 s101, s101, 7
  s_mul_i32 s62, s101, 21
  s_lshr_b32 s62, s62, 3
  s_lshl_b32 s62, s62, 16
  s_lshl_b32 s101, s101, 16
  v_lshlrev_b32 v0, 4, v14
  v_and_b32 v12, 15, v14
  v_lshrrev_b32 v13, 4, v14
  v_bfe_u32 v1, v14, 1, 3
  v_xor_b32 v1, v1, v13
  v_lshlrev_b32 v1, 4, v1
  v_lshl_add_u32 v1, v12, 7, v1
  s_lshl_b32 s50, s45, 12
  v_add_u32 v1, s50, v1
  v_xor_b32_e64 v2, 64, v1
  v_add_u32 v3, 57344, v1
  v_add_u32 v4, 57344, v2
  v_bfe_u32 v12, v14, 2, 2
  v_lshlrev_b32 v12, 6, v12
  v_and_b32 v13, 3, v14
  v_lshl_add_u32 v12, v13, 3, v12
  v_bfe_u32 v13, v14, 4, 1
  v_cmp_ne_u32 s[64:65], 0, v13
  v_mul_u32_u24 v13, 544, v13
  v_add_u32 v12, v12, v13
  v_lshrrev_b32 v13, 5, v14
  v_mul_u32_u24 v13, 3072, v13
  v_add_u32_e64 v12, v12, v13
  v_add_u32 v112, 16384, v12
  v_add_u32 v7, v12, v13
  v_xor_b32 v113, 32, v112
  v_add_u32 v114, 57344, v112
  v_add_u32 v115, 57344, v113
  v_xor_b32_e64 v8, 32, v7
  v_add_u32 v9, 57344, v7
  v_add_u32 v10, 57344, v8
  s_waitcnt lgkmcnt(0)
  s_lshl_b32 s50, s47, 2
  s_add_u32 s72, s50, s45
  s_cmp_lg_u32 s72, 15
  s_cbranch_scc1 G_NOINIT0
  v_and_b32 v12, 15, v14
  s_lshl_b32 s50, s46, 4
  v_add_u32 v12, s50, v12
  v_lshlrev_b32 v13, 7, v12
  v_lshlrev_b32 v12, 4, v12
  v_add_u32 v12, 32768, v12
  v_cndmask_b32 v12, v13, v12, s[64:65]
  s_mov_b32 s50, 14680064
  s_mov_b32 exec_hi, 0
  buffer_store_dwordx4 v[16:19], v12, s[4:7], s50 offen sc1
  s_mov_b32 exec_hi, -1
G_NOINIT0:
  s_cmp_eq_u32 s45, 1
  s_cselect_b32 s68, s20, s16
  s_cselect_b32 s69, s21, s17
  s_cmp_eq_u32 s45, 2
  s_cselect_b32 s68, s24, s68
  s_cselect_b32 s69, s25, s69
  s_mov_b32 s70, 1409024
  s_cmp_eq_u32 s45, 3
  s_cselect_b32 s68, s28, s68
  s_cselect_b32 s69, s29, s69
  s_cselect_b32 s70, 524288, s70
  s_mov_b32 s71, 0x20000
  s_mov_b32 s50, s3
  s_lshr_b32 s85, s45, 1
  s_cmp_eq_u32 s63, 0
  s_cbranch_scc1 GH15
  s_mul_i32 s51, s46, 5
  s_add_u32 s50, s50, s51
  s_mul_i32 s50, s50, 3
  s_cmp_eq_u32 s45, 2
  s_cselect_b32 s88, 46, 46
  s_cmp_eq_u32 s45, 3
  s_cselect_b32 s88, 18, s88
  s_add_u32 s85, s85, 1
  s_cmp_eq_u32 s45, 3
  s_cselect_b32 s85, 0, s85
  s_mov_b32 s52, 0
  s_branch GH15J
GH15:
  s_sub_u32 s50, s47, s50
  s_mul_i32 s51, s46, 11
  s_add_u32 s50, s50, s51
  s_mul_i32 s85, s85, 3
  s_cmp_eq_u32 s45, 3
  s_cselect_b32 s88, 24, 1
  s_cselect_b32 s52, 0, 1413120
  s_cselect_b32 s85, s85, 0
GH15J:
  s_bfm_b64 s[86:87], s88, 0
  s_lshl_b32 s88, s88, 7
  s_lshl_b32 s89, s88, 1
  s_mul_i32 s50, s50, s88
  s_add_u32 s50, s50, s52
  v_lshl_add_u32 v98, v14, 7, s50
  s_cmp_lg_u32 s85, 3
  s_cbranch_scc1 GL16
  s_mov_b64 exec, s[86:87]
  buffer_load_dword v99, v98, s[68:71], 0 offen
  s_mov_b64 exec, -1
GL16:
  s_lshr_b32 s84, s2, 3
  s_and_b32 s84, s84, 7
  s_lshl_b32 s51, s46, 12
  s_add_u32 s51, s51, s98
  s_mul_i32 s76, s47, 393216
  s_add_u32 s76, s76, s51
  s_add_u32 s77, s76, 65536
  s_add_u32 s78, s76, 131072
  s_add_u32 s79, s76, 196608
  s_add_u32 s80, s76, 262144
  s_add_u32 s81, s76, 327680
  s_cmp_lt_u32 s76, 2097152
  s_cselect_b32 s90, 1, 0
  s_cmp_lt_u32 s78, 2097152
  s_cselect_b32 s91, 1, 0
  s_cmp_lt_u32 s80, 2097152
  s_cselect_b32 s92, 1, 0
  s_setprio 2
  s_barrier
  ds_read_b128 v[128:131], v1 offset:0
  ds_read_b128 v[132:135], v1 offset:2048
  ds_read_b64_tr_b16 v[12:13], v112 offset:0
  ds_read_b64_tr_b16 v[14:15], v112 offset:256
  ds_read_b64_tr_b16 v[16:17], v112 offset:1024
  ds_read_b64_tr_b16 v[18:19], v112 offset:1280
  ds_read_b64_tr_b16 v[20:21], v112 offset:2048
  ds_read_b64_tr_b16 v[22:23], v112 offset:2304
  ds_read_b64_tr_b16 v[24:25], v113 offset:0
  ds_read_b64_tr_b16 v[26:27], v113 offset:256
  s_waitcnt lgkmcnt(6)
  v_mfma_f32_16x16x32_bf16 v[32:35], v[12:15], v[128:131], 0
  ds_read_b64_tr_b16 v[28:29], v113 offset:1024
  ds_read_b64_tr_b16 v[30:31], v113 offset:1280
  v_mfma_f32_16x16x32_bf16 v[36:39], v[12:15], v[132:135], 0
  s_waitcnt lgkmcnt(6)
  v_mfma_f32_16x16x32_bf16 v[48:51], v[16:19], v[128:131], 0
  ds_read_b64_tr_b16 v[12:13], v113 offset:2048
  ds_read_b64_tr_b16 v[14:15], v113 offset:2304
  v_mfma_f32_16x16x32_bf16 v[52:55], v[16:19], v[132:135], 0
  s_waitcnt lgkmcnt(6)
  v_mfma_f32_16x16x32_bf16 v[64:67], v[20:23], v[128:131], 0
  ds_read_b128 v[136:139], v2 offset:0
  ds_read_b128 v[140:143], v2 offset:2048
  v_mfma_f32_16x16x32_bf16 v[68:71], v[20:23], v[132:135], 0
  ds_read_b64_tr_b16 v[16:17], v112 offset:6144
  ds_read_b64_tr_b16 v[18:19], v112 offset:6400
  s_waitcnt lgkmcnt(8)
  v_mfma_f32_16x16x32_bf16 v[40:43], v[24:27], v[128:131], 0
  ds_read_b64_tr_b16 v[20:21], v112 offset:7168
  ds_read_b64_tr_b16 v[22:23], v112 offset:7424
  v_mfma_f32_16x16x32_bf16 v[44:47], v[24:27], v[132:135], 0
  s_waitcnt lgkmcnt(8)
  v_mfma_f32_16x16x32_bf16 v[56:59], v[28:31], v[128:131], 0
  ds_read_b64_tr_b16 v[24:25], v112 offset:8192
  ds_read_b64_tr_b16 v[26:27], v112 offset:8448
  v_mfma_f32_16x16x32_bf16 v[60:63], v[28:31], v[132:135], 0
  s_waitcnt lgkmcnt(8)
  v_mfma_f32_16x16x32_bf16 v[72:75], v[12:15], v[128:131], 0
  ds_read_b64_tr_b16 v[28:29], v113 offset:6144
  ds_read_b64_tr_b16 v[30:31], v113 offset:6400
  v_mfma_f32_16x16x32_bf16 v[76:79], v[12:15], v[132:135], 0
  s_waitcnt lgkmcnt(6)
  v_mfma_f32_16x16x32_bf16 v[32:35], v[16:19], v[136:139], v[32:35]
  ds_read_b64_tr_b16 v[12:13], v113 offset:7168
  ds_read_b64_tr_b16 v[14:15], v113 offset:7424
  v_mfma_f32_16x16x32_bf16 v[36:39], v[16:19], v[140:143], v[36:39]
  s_waitcnt lgkmcnt(6)
  v_mfma_f32_16x16x32_bf16 v[48:51], v[20:23], v[136:139], v[48:51]
  ds_read_b64_tr_b16 v[16:17], v113 offset:8192
  ds_read_b64_tr_b16 v[18:19], v113 offset:8448
  v_mfma_f32_16x16x32_bf16 v[52:55], v[20:23], v[140:143], v[52:55]
  s_waitcnt lgkmcnt(6)
  v_mfma_f32_16x16x32_bf16 v[64:67], v[24:27], v[136:139], v[64:67]
  s_barrier
  ds_read_b128 v[144:147], v1 offset:28672
  ds_read_b128 v[148:151], v1 offset:30720
  v_mfma_f32_16x16x32_bf16 v[68:71], v[24:27], v[140:143], v[68:71]
  ds_read_b64_tr_b16 v[20:21], v112 offset:28672
  ds_read_b64_tr_b16 v[22:23], v112 offset:28928
  s_waitcnt lgkmcnt(8)
  v_mfma_f32_16x16x32_bf16 v[40:43], v[28:31], v[136:139], v[40:43]
  ds_read_b64_tr_b16 v[24:25], v112 offset:29696
  ds_read_b64_tr_b16 v[26:27], v112 offset:29952
  v_mfma_f32_16x16x32_bf16 v[44:47], v[28:31], v[140:143], v[44:47]
  s_waitcnt lgkmcnt(8)
  v_mfma_f32_16x16x32_bf16 v[56:59], v[12:15], v[136:139], v[56:59]
  ds_read_b64_tr_b16 v[28:29], v112 offset:30720
  ds_read_b64_tr_b16 v[30:31], v112 offset:30976
  v_mfma_f32_16x16x32_bf16 v[60:63], v[12:15], v[140:143], v[60:63]
  s_waitcnt lgkmcnt(8)
  v_mfma_f32_16x16x32_bf16 v[72:75], v[16:19], v[136:139], v[72:75]
  ds_read_b64_tr_b16 v[12:13], v113 offset:28672
  ds_read_b64_tr_b16 v[14:15], v113 offset:28928
  v_mfma_f32_16x16x32_bf16 v[76:79], v[16:19], v[140:143], v[76:79]
  s_cmp_lg_u32 s72, 15
  s_cbranch_scc1 G_NOPUB
  s_lshl_b32 s50, s46, 2
  v_mov_b32 v100, 1
  s_mov_b64 exec, 1
  s_waitcnt vmcnt(0)
  buffer_store_dword v100, off, s[40:43], s50 sc1
  s_mov_b64 exec, -1
G_NOPUB:
  s_waitcnt lgkmcnt(6)
  v_mfma_f32_16x16x32_bf16 v[32:35], v[20:23], v[144:147], v[32:35]
  ds_read_b64_tr_b16 v[16:17], v113 offset:29696
  ds_read_b64_tr_b16 v[18:19], v113 offset:29952
  v_mfma_f32_16x16x32_bf16 v[36:39], v[20:23], v[148:151], v[36:39]
  s_waitcnt lgkmcnt(6)
  v_mfma_f32_16x16x32_bf16 v[48:51], v[24:27], v[144:147], v[48:51]
  ds_read_b64_tr_b16 v[20:21], v113 offset:30720
  ds_read_b64_tr_b16 v[22:23], v113 offset:30976
  v_mfma_f32_16x16x32_bf16 v[52:55], v[24:27], v[148:151], v[52:55]
  s_waitcnt lgkmcnt(6)
  v_mfma_f32_16x16x32_bf16 v[64:67], v[28:31], v[144:147], v[64:67]
  ds_read_b128 v[152:155], v2 offset:28672
  ds_read_b128 v[156:159], v2 offset:30720
  v_mfma_f32_16x16x32_bf16 v[68:71], v[28:31], v[148:151], v[68:71]
  ds_read_b64_tr_b16 v[24:25], v112 offset:34816
  ds_read_b64_tr_b16 v[26:27], v112 offset:35072
  s_waitcnt lgkmcnt(8)
  v_mfma_f32_16x16x32_bf16 v[40:43], v[12:15], v[144:147], v[40:43]
  ds_read_b64_tr_b16 v[28:29], v112 offset:35840
  ds_read_b64_tr_b16 v[30:31], v112 offset:36096
  v_mfma_f32_16x16x32_bf16 v[44:47], v[12:15], v[148:151], v[44:47]
  s_cmp_lg_u32 s85, 1
  s_cbranch_scc1 GL17
  s_mov_b64 exec, s[86:87]
  buffer_load_dword v99, v98, s[68:71], 0 offen
  s_mov_b64 exec, -1
GL17:
  s_cmp_lg_u32 s85, 2
  s_cbranch_scc1 GL18
  s_mov_b64 exec, s[86:87]
  buffer_load_dword v99, v98, s[68:71], 0 offen
  s_mov_b64 exec, -1
GL18:
  s_waitcnt lgkmcnt(8)
  v_mfma_f32_16x16x32_bf16 v[56:59], v[16:19], v[144:147], v[56:59]
  ds_read_b64_tr_b16 v[12:13], v112 offset:36864
  ds_read_b64_tr_b16 v[14:15], v112 offset:37120
  v_mfma_f32_16x16x32_bf16 v[60:63], v[16:19], v[148:151], v[60:63]
  s_cmp_lg_u32 s85, 1
  s_cbranch_scc1 GL19
  s_mov_b64 exec, s[86:87]
  buffer_load_dword v103, v98, s[68:71], s88 offen
  s_mov_b64 exec, -1
GL19:
  s_cmp_lg_u32 s85, 2
  s_cbranch_scc1 GL20
  s_mov_b64 exec, s[86:87]
  buffer_load_dword v103, v98, s[68:71], s88 offen
  s_mov_b64 exec, -1
GL20:
  s_waitcnt lgkmcnt(8)
  v_mfma_f32_16x16x32_bf16 v[72:75], v[20:23], v[144:147], v[72:75]
  ds_read_b64_tr_b16 v[16:17], v113 offset:34816
  ds_read_b64_tr_b16 v[18:19], v113 offset:35072
  v_mfma_f32_16x16x32_bf16 v[76:79], v[20:23], v[148:151], v[76:79]
  s_cmp_lg_u32 s85, 1
  s_cbranch_scc1 GL21
  s_mov_b64 exec, s[86:87]
  buffer_load_dword v107, v98, s[68:71], s89 offen
  s_mov_b64 exec, -1
GL21:
  s_cmp_lg_u32 s85, 2
  s_cbranch_scc1 GL22
  s_mov_b64 exec, s[86:87]
  buffer_load_dword v107, v98, s[68:71], s89 offen
  s_mov_b64 exec, -1
GL22:
  s_waitcnt lgkmcnt(6)
  v_mfma_f32_16x16x32_bf16 v[32:35], v[24:27], v[152:155], v[32:35]
  ds_read_b64_tr_b16 v[20:21], v113 offset:35840
  ds_read_b64_tr_b16 v[22:23], v113 offset:36096
  v_mfma_f32_16x16x32_bf16 v[36:39], v[24:27], v[156:159], v[36:39]
  s_waitcnt lgkmcnt(6)
  v_mfma_f32_16x16x32_bf16 v[48:51], v[28:31], v[152:155], v[48:51]
  ds_read_b64_tr_b16 v[24:25], v113 offset:36864
  ds_read_b64_tr_b16 v[26:27], v113 offset:37120
  v_mfma_f32_16x16x32_bf16 v[52:55], v[28:31], v[156:159], v[52:55]
  s_waitcnt lgkmcnt(6)
  v_mfma_f32_16x16x32_bf16 v[64:67], v[12:15], v[152:155], v[64:67]
  s_barrier
  ds_read_b128 v[160:163], v3 offset:0
  ds_read_b128 v[164:167], v3 offset:2048
  v_mfma_f32_16x16x32_bf16 v[68:71], v[12:15], v[156:159], v[68:71]
  ds_read_b64_tr_b16 v[28:29], v114 offset:0
  ds_read_b64_tr_b16 v[30:31], v114 offset:256
  s_waitcnt lgkmcnt(8)
  v_mfma_f32_16x16x32_bf16 v[40:43], v[16:19], v[152:155], v[40:43]
  ds_read_b64_tr_b16 v[12:13], v114 offset:1024
  ds_read_b64_tr_b16 v[14:15], v114 offset:1280
  v_mfma_f32_16x16x32_bf16 v[44:47], v[16:19], v[156:159], v[44:47]
  s_waitcnt lgkmcnt(8)
  v_mfma_f32_16x16x32_bf16 v[56:59], v[20:23], v[152:155], v[56:59]
  ds_read_b64_tr_b16 v[16:17], v114 offset:2048
  ds_read_b64_tr_b16 v[18:19], v114 offset:2304
  v_mfma_f32_16x16x32_bf16 v[60:63], v[20:23], v[156:159], v[60:63]
  s_waitcnt lgkmcnt(8)
  v_mfma_f32_16x16x32_bf16 v[72:75], v[24:27], v[152:155], v[72:75]
  ds_read_b64_tr_b16 v[20:21], v115 offset:0
  ds_read_b64_tr_b16 v[22:23], v115 offset:256
  v_mfma_f32_16x16x32_bf16 v[76:79], v[24:27], v[156:159], v[76:79]
  s_waitcnt lgkmcnt(6)
  v_mfma_f32_16x16x32_bf16 v[32:35], v[28:31], v[160:163], v[32:35]
  ds_read_b64_tr_b16 v[24:25], v115 offset:1024
  ds_read_b64_tr_b16 v[26:27], v115 offset:1280
  v_mfma_f32_16x16x32_bf16 v[36:39], v[28:31], v[164:167], v[36:39]
  s_waitcnt lgkmcnt(6)
  v_mfma_f32_16x16x32_bf16 v[48:51], v[12:15], v[160:163], v[48:51]
  ds_read_b64_tr_b16 v[28:29], v115 offset:2048
  ds_read_b64_tr_b16 v[30:31], v115 offset:2304
  v_mfma_f32_16x16x32_bf16 v[52:55], v[12:15], v[164:167], v[52:55]
  s_waitcnt lgkmcnt(6)
  v_mfma_f32_16x16x32_bf16 v[64:67], v[16:19], v[160:163], v[64:67]
  ds_read_b128 v[168:171], v4 offset:0
  ds_read_b128 v[172:175], v4 offset:2048
  v_mfma_f32_16x16x32_bf16 v[68:71], v[16:19], v[164:167], v[68:71]
  ds_read_b64_tr_b16 v[12:13], v114 offset:6144
  ds_read_b64_tr_b16 v[14:15], v114 offset:6400
  s_waitcnt lgkmcnt(8)
  v_mfma_f32_16x16x32_bf16 v[40:43], v[20:23], v[160:163], v[40:43]
  ds_read_b64_tr_b16 v[16:17], v114 offset:7168
  ds_read_b64_tr_b16 v[18:19], v114 offset:7424
  v_mfma_f32_16x16x32_bf16 v[44:47], v[20:23], v[164:167], v[44:47]
  s_waitcnt lgkmcnt(8)
  v_mfma_f32_16x16x32_bf16 v[56:59], v[24:27], v[160:163], v[56:59]
  ds_read_b64_tr_b16 v[20:21], v114 offset:8192
  ds_read_b64_tr_b16 v[22:23], v114 offset:8448
  v_mfma_f32_16x16x32_bf16 v[60:63], v[24:27], v[164:167], v[60:63]
  s_waitcnt lgkmcnt(8)
  v_mfma_f32_16x16x32_bf16 v[72:75], v[28:31], v[160:163], v[72:75]
  ds_read_b64_tr_b16 v[24:25], v115 offset:6144
  ds_read_b64_tr_b16 v[26:27], v115 offset:6400
  v_mfma_f32_16x16x32_bf16 v[76:79], v[28:31], v[164:167], v[76:79]
  s_waitcnt lgkmcnt(6)
  v_mfma_f32_16x16x32_bf16 v[32:35], v[12:15], v[168:171], v[32:35]
  ds_read_b64_tr_b16 v[28:29], v115 offset:7168
  ds_read_b64_tr_b16 v[30:31], v115 offset:7424
  v_mfma_f32_16x16x32_bf16 v[36:39], v[12:15], v[172:175], v[36:39]
  s_waitcnt lgkmcnt(6)
  v_mfma_f32_16x16x32_bf16 v[48:51], v[16:19], v[168:171], v[48:51]
  ds_read_b64_tr_b16 v[12:13], v115 offset:8192
  ds_read_b64_tr_b16 v[14:15], v115 offset:8448
  v_mfma_f32_16x16x32_bf16 v[52:55], v[16:19], v[172:175], v[52:55]
  s_waitcnt lgkmcnt(6)
  v_mfma_f32_16x16x32_bf16 v[64:67], v[20:23], v[168:171], v[64:67]
  s_barrier
  ds_read_b128 v[176:179], v3 offset:28672
  ds_read_b128 v[180:183], v3 offset:30720
  v_mfma_f32_16x16x32_bf16 v[68:71], v[20:23], v[172:175], v[68:71]
  ds_read_b64_tr_b16 v[16:17], v114 offset:28672
  ds_read_b64_tr_b16 v[18:19], v114 offset:28928
  s_waitcnt lgkmcnt(8)
  v_mfma_f32_16x16x32_bf16 v[40:43], v[24:27], v[168:171], v[40:43]
  ds_read_b64_tr_b16 v[20:21], v114 offset:29696
  ds_read_b64_tr_b16 v[22:23], v114 offset:29952
  v_mfma_f32_16x16x32_bf16 v[44:47], v[24:27], v[172:175], v[44:47]
  s_waitcnt lgkmcnt(8)
  v_mfma_f32_16x16x32_bf16 v[56:59], v[28:31], v[168:171], v[56:59]
  ds_read_b64_tr_b16 v[24:25], v114 offset:30720
  ds_read_b64_tr_b16 v[26:27], v114 offset:30976
  v_mfma_f32_16x16x32_bf16 v[60:63], v[28:31], v[172:175], v[60:63]
  s_waitcnt lgkmcnt(8)
  v_mfma_f32_16x16x32_bf16 v[72:75], v[12:15], v[168:171], v[72:75]
  ds_read_b64_tr_b16 v[28:29], v115 offset:28672
  ds_read_b64_tr_b16 v[30:31], v115 offset:28928
  v_mfma_f32_16x16x32_bf16 v[76:79], v[12:15], v[172:175], v[76:79]
  s_waitcnt lgkmcnt(6)
  v_mfma_f32_16x16x32_bf16 v[32:35], v[16:19], v[176:179], v[32:35]
  ds_read_b64_tr_b16 v[12:13], v115 offset:29696
  ds_read_b64_tr_b16 v[14:15], v115 offset:29952
  v_mfma_f32_16x16x32_bf16 v[36:39], v[16:19], v[180:183], v[36:39]
  s_waitcnt lgkmcnt(6)
  v_mfma_f32_16x16x32_bf16 v[48:51], v[20:23], v[176:179], v[48:51]
  ds_read_b64_tr_b16 v[16:17], v115 offset:30720
  ds_read_b64_tr_b16 v[18:19], v115 offset:30976
  v_mfma_f32_16x16x32_bf16 v[52:55], v[20:23], v[180:183], v[52:55]
  s_waitcnt lgkmcnt(6)
  v_mfma_f32_16x16x32_bf16 v[64:67], v[24:27], v[176:179], v[64:67]
  ds_read_b128 v[184:187], v4 offset:28672
  ds_read_b128 v[188:191], v4 offset:30720
  v_mfma_f32_16x16x32_bf16 v[68:71], v[24:27], v[180:183], v[68:71]
  ds_read_b64_tr_b16 v[20:21], v114 offset:34816
  ds_read_b64_tr_b16 v[22:23], v114 offset:35072
  s_waitcnt lgkmcnt(8)
  v_mfma_f32_16x16x32_bf16 v[40:43], v[28:31], v[176:179], v[40:43]
  ds_read_b64_tr_b16 v[24:25], v114 offset:35840
  ds_read_b64_tr_b16 v[26:27], v114 offset:36096
  v_mfma_f32_16x16x32_bf16 v[44:47], v[28:31], v[180:183], v[44:47]
  s_waitcnt lgkmcnt(8)
  v_mfma_f32_16x16x32_bf16 v[56:59], v[12:15], v[176:179], v[56:59]
  ds_read_b64_tr_b16 v[28:29], v114 offset:36864
  ds_read_b64_tr_b16 v[30:31], v114 offset:37120
  v_mfma_f32_16x16x32_bf16 v[60:63], v[12:15], v[180:183], v[60:63]
  s_waitcnt lgkmcnt(8)
  v_mfma_f32_16x16x32_bf16 v[72:75], v[16:19], v[176:179], v[72:75]
  ds_read_b64_tr_b16 v[12:13], v115 offset:34816
  ds_read_b64_tr_b16 v[14:15], v115 offset:35072
  v_mfma_f32_16x16x32_bf16 v[76:79], v[16:19], v[180:183], v[76:79]
  s_waitcnt lgkmcnt(6)
  v_mfma_f32_16x16x32_bf16 v[32:35], v[20:23], v[184:187], v[32:35]
  ds_read_b64_tr_b16 v[16:17], v115 offset:35840
  ds_read_b64_tr_b16 v[18:19], v115 offset:36096
  v_mfma_f32_16x16x32_bf16 v[36:39], v[20:23], v[188:191], v[36:39]
  s_waitcnt lgkmcnt(6)
  v_mfma_f32_16x16x32_bf16 v[48:51], v[24:27], v[184:187], v[48:51]
  ds_read_b64_tr_b16 v[20:21], v115 offset:36864
  ds_read_b64_tr_b16 v[22:23], v115 offset:37120
  v_mfma_f32_16x16x32_bf16 v[52:55], v[24:27], v[188:191], v[52:55]
  s_waitcnt lgkmcnt(6)
  v_mfma_f32_16x16x32_bf16 v[64:67], v[28:31], v[184:187], v[64:67]
  s_barrier
  ds_read_b128 v[192:195], v1 offset:0
  ds_read_b128 v[196:199], v1 offset:2048
  v_mfma_f32_16x16x32_bf16 v[68:71], v[28:31], v[188:191], v[68:71]
  ds_read_b64_tr_b16 v[24:25], v112 offset:0
  ds_read_b64_tr_b16 v[26:27], v112 offset:256
  s_waitcnt lgkmcnt(8)
  v_mfma_f32_16x16x32_bf16 v[40:43], v[12:15], v[184:187], v[40:43]
  ds_read_b64_tr_b16 v[28:29], v112 offset:1024
  ds_read_b64_tr_b16 v[30:31], v112 offset:1280
  v_mfma_f32_16x16x32_bf16 v[44:47], v[12:15], v[188:191], v[44:47]
  s_waitcnt lgkmcnt(8)
  v_mfma_f32_16x16x32_bf16 v[56:59], v[16:19], v[184:187], v[56:59]
  ds_read_b64_tr_b16 v[12:13], v112 offset:2048
  ds_read_b64_tr_b16 v[14:15], v112 offset:2304
  v_mfma_f32_16x16x32_bf16 v[60:63], v[16:19], v[188:191], v[60:63]
  s_waitcnt lgkmcnt(8)
  v_mfma_f32_16x16x32_bf16 v[72:75], v[20:23], v[184:187], v[72:75]
  ds_read_b64_tr_b16 v[16:17], v113 offset:0
  ds_read_b64_tr_b16 v[18:19], v113 offset:256
  v_mfma_f32_16x16x32_bf16 v[76:79], v[20:23], v[188:191], v[76:79]
  s_waitcnt lgkmcnt(6)
  v_mfma_f32_16x16x32_bf16 v[32:35], v[24:27], v[192:195], v[32:35]
  ds_read_b64_tr_b16 v[20:21], v113 offset:1024
  ds_read_b64_tr_b16 v[22:23], v113 offset:1280
  v_mfma_f32_16x16x32_bf16 v[36:39], v[24:27], v[196:199], v[36:39]
  s_waitcnt lgkmcnt(6)
  v_mfma_f32_16x16x32_bf16 v[48:51], v[28:31], v[192:195], v[48:51]
  ds_read_b64_tr_b16 v[24:25], v113 offset:2048
  ds_read_b64_tr_b16 v[26:27], v113 offset:2304
  v_mfma_f32_16x16x32_bf16 v[52:55], v[28:31], v[196:199], v[52:55]
  s_waitcnt lgkmcnt(6)
  v_mfma_f32_16x16x32_bf16 v[64:67], v[12:15], v[192:195], v[64:67]
  ds_read_b128 v[200:203], v2 offset:0
  ds_read_b128 v[204:207], v2 offset:2048
  v_mfma_f32_16x16x32_bf16 v[68:71], v[12:15], v[196:199], v[68:71]
  ds_read_b64_tr_b16 v[28:29], v112 offset:6144
  ds_read_b64_tr_b16 v[30:31], v112 offset:6400
  s_waitcnt lgkmcnt(8)
  v_mfma_f32_16x16x32_bf16 v[40:43], v[16:19], v[192:195], v[40:43]
  ds_read_b64_tr_b16 v[12:13], v112 offset:7168
  ds_read_b64_tr_b16 v[14:15], v112 offset:7424
  v_mfma_f32_16x16x32_bf16 v[44:47], v[16:19], v[196:199], v[44:47]
  s_waitcnt lgkmcnt(8)
  v_mfma_f32_16x16x32_bf16 v[56:59], v[20:23], v[192:195], v[56:59]
  ds_read_b64_tr_b16 v[16:17], v112 offset:8192
  ds_read_b64_tr_b16 v[18:19], v112 offset:8448
  v_mfma_f32_16x16x32_bf16 v[60:63], v[20:23], v[196:199], v[60:63]
  s_waitcnt lgkmcnt(8)
  v_mfma_f32_16x16x32_bf16 v[72:75], v[24:27], v[192:195], v[72:75]
  ds_read_b64_tr_b16 v[20:21], v113 offset:6144
  ds_read_b64_tr_b16 v[22:23], v113 offset:6400
  v_mfma_f32_16x16x32_bf16 v[76:79], v[24:27], v[196:199], v[76:79]
  s_waitcnt lgkmcnt(6)
  v_mfma_f32_16x16x32_bf16 v[32:35], v[28:31], v[200:203], v[32:35]
  ds_read_b64_tr_b16 v[24:25], v113 offset:7168
  ds_read_b64_tr_b16 v[26:27], v113 offset:7424
  v_mfma_f32_16x16x32_bf16 v[36:39], v[28:31], v[204:207], v[36:39]
  s_waitcnt lgkmcnt(6)
  v_mfma_f32_16x16x32_bf16 v[48:51], v[12:15], v[200:203], v[48:51]
  ds_read_b64_tr_b16 v[28:29], v113 offset:8192
  ds_read_b64_tr_b16 v[30:31], v113 offset:8448
  v_mfma_f32_16x16x32_bf16 v[52:55], v[12:15], v[204:207], v[52:55]
  s_waitcnt lgkmcnt(6)
  v_mfma_f32_16x16x32_bf16 v[64:67], v[16:19], v[200:203], v[64:67]
  s_barrier
  ds_read_b128 v[208:211], v1 offset:28672
  ds_read_b128 v[212:215], v1 offset:30720
  v_mfma_f32_16x16x32_bf16 v[68:71], v[16:19], v[204:207], v[68:71]
  ds_read_b64_tr_b16 v[12:13], v112 offset:28672
  ds_read_b64_tr_b16 v[14:15], v112 offset:28928
  s_waitcnt lgkmcnt(8)
  v_mfma_f32_16x16x32_bf16 v[40:43], v[20:23], v[200:203], v[40:43]
  ds_read_b64_tr_b16 v[16:17], v112 offset:29696
  ds_read_b64_tr_b16 v[18:19], v112 offset:29952
  v_mfma_f32_16x16x32_bf16 v[44:47], v[20:23], v[204:207], v[44:47]
  s_waitcnt lgkmcnt(8)
  v_mfma_f32_16x16x32_bf16 v[56:59], v[24:27], v[200:203], v[56:59]
  ds_read_b64_tr_b16 v[20:21], v112 offset:30720
  ds_read_b64_tr_b16 v[22:23], v112 offset:30976
  v_mfma_f32_16x16x32_bf16 v[60:63], v[24:27], v[204:207], v[60:63]
  s_waitcnt lgkmcnt(8)
  v_mfma_f32_16x16x32_bf16 v[72:75], v[28:31], v[200:203], v[72:75]
  ds_read_b64_tr_b16 v[24:25], v113 offset:28672
  ds_read_b64_tr_b16 v[26:27], v113 offset:28928
  v_mfma_f32_16x16x32_bf16 v[76:79], v[28:31], v[204:207], v[76:79]
  s_waitcnt lgkmcnt(6)
  v_mfma_f32_16x16x32_bf16 v[32:35], v[12:15], v[208:211], v[32:35]
  ds_read_b64_tr_b16 v[28:29], v113 offset:29696
  ds_read_b64_tr_b16 v[30:31], v113 offset:29952
  v_mfma_f32_16x16x32_bf16 v[36:39], v[12:15], v[212:215], v[36:39]
  s_waitcnt lgkmcnt(6)
  v_mfma_f32_16x16x32_bf16 v[48:51], v[16:19], v[208:211], v[48:51]
  ds_read_b64_tr_b16 v[12:13], v113 offset:30720
  ds_read_b64_tr_b16 v[14:15], v113 offset:30976
  v_mfma_f32_16x16x32_bf16 v[52:55], v[16:19], v[212:215], v[52:55]
  s_waitcnt lgkmcnt(6)
  v_mfma_f32_16x16x32_bf16 v[64:67], v[20:23], v[208:211], v[64:67]
  ds_read_b128 v[216:219], v2 offset:28672
  ds_read_b128 v[220:223], v2 offset:30720
  v_mfma_f32_16x16x32_bf16 v[68:71], v[20:23], v[212:215], v[68:71]
  ds_read_b64_tr_b16 v[16:17], v112 offset:34816
  ds_read_b64_tr_b16 v[18:19], v112 offset:35072
  s_waitcnt lgkmcnt(8)
  v_mfma_f32_16x16x32_bf16 v[40:43], v[24:27], v[208:211], v[40:43]
  ds_read_b64_tr_b16 v[20:21], v112 offset:35840
  ds_read_b64_tr_b16 v[22:23], v112 offset:36096
  v_mfma_f32_16x16x32_bf16 v[44:47], v[24:27], v[212:215], v[44:47]
  s_waitcnt lgkmcnt(8)
  v_mfma_f32_16x16x32_bf16 v[56:59], v[28:31], v[208:211], v[56:59]
  ds_read_b64_tr_b16 v[24:25], v112 offset:36864
  ds_read_b64_tr_b16 v[26:27], v112 offset:37120
  v_mfma_f32_16x16x32_bf16 v[60:63], v[28:31], v[212:215], v[60:63]
  s_waitcnt lgkmcnt(8)
  v_mfma_f32_16x16x32_bf16 v[72:75], v[12:15], v[208:211], v[72:75]
  ds_read_b64_tr_b16 v[28:29], v113 offset:34816
  ds_read_b64_tr_b16 v[30:31], v113 offset:35072
  v_mfma_f32_16x16x32_bf16 v[76:79], v[12:15], v[212:215], v[76:79]
  s_waitcnt lgkmcnt(6)
  v_mfma_f32_16x16x32_bf16 v[32:35], v[16:19], v[216:219], v[32:35]
  ds_read_b64_tr_b16 v[12:13], v113 offset:35840
  ds_read_b64_tr_b16 v[14:15], v113 offset:36096
  v_mfma_f32_16x16x32_bf16 v[36:39], v[16:19], v[220:223], v[36:39]
  s_waitcnt lgkmcnt(6)
  v_mfma_f32_16x16x32_bf16 v[48:51], v[20:23], v[216:219], v[48:51]
  ds_read_b64_tr_b16 v[16:17], v113 offset:36864
  ds_read_b64_tr_b16 v[18:19], v113 offset:37120
  v_mfma_f32_16x16x32_bf16 v[52:55], v[20:23], v[220:223], v[52:55]
  s_waitcnt lgkmcnt(6)
  v_mfma_f32_16x16x32_bf16 v[64:67], v[24:27], v[216:219], v[64:67]
  s_barrier
  ds_read_b128 v[224:227], v3 offset:0
  ds_read_b128 v[228:231], v3 offset:2048
  v_mfma_f32_16x16x32_bf16 v[68:71], v[24:27], v[220:223], v[68:71]
  ds_read_b64_tr_b16 v[20:21], v114 offset:0
  ds_read_b64_tr_b16 v[22:23], v114 offset:256
  s_waitcnt lgkmcnt(8)
  v_mfma_f32_16x16x32_bf16 v[40:43], v[28:31], v[216:219], v[40:43]
  ds_read_b64_tr_b16 v[24:25], v114 offset:1024
  ds_read_b64_tr_b16 v[26:27], v114 offset:1280
  v_mfma_f32_16x16x32_bf16 v[44:47], v[28:31], v[220:223], v[44:47]
  s_waitcnt lgkmcnt(8)
  v_mfma_f32_16x16x32_bf16 v[56:59], v[12:15], v[216:219], v[56:59]
  ds_read_b64_tr_b16 v[28:29], v114 offset:2048
  ds_read_b64_tr_b16 v[30:31], v114 offset:2304
  v_mfma_f32_16x16x32_bf16 v[60:63], v[12:15], v[220:223], v[60:63]
  s_waitcnt lgkmcnt(8)
  v_mfma_f32_16x16x32_bf16 v[72:75], v[16:19], v[216:219], v[72:75]
  ds_read_b64_tr_b16 v[12:13], v115 offset:0
  ds_read_b64_tr_b16 v[14:15], v115 offset:256
  v_mfma_f32_16x16x32_bf16 v[76:79], v[16:19], v[220:223], v[76:79]
  s_waitcnt lgkmcnt(6)
  v_mfma_f32_16x16x32_bf16 v[32:35], v[20:23], v[224:227], v[32:35]
  ds_read_b64_tr_b16 v[16:17], v115 offset:1024
  ds_read_b64_tr_b16 v[18:19], v115 offset:1280
  v_mfma_f32_16x16x32_bf16 v[36:39], v[20:23], v[228:231], v[36:39]
  s_waitcnt lgkmcnt(6)
  v_mfma_f32_16x16x32_bf16 v[48:51], v[24:27], v[224:227], v[48:51]
  ds_read_b64_tr_b16 v[20:21], v115 offset:2048
  ds_read_b64_tr_b16 v[22:23], v115 offset:2304
  v_mfma_f32_16x16x32_bf16 v[52:55], v[24:27], v[228:231], v[52:55]
  s_waitcnt lgkmcnt(6)
  v_mfma_f32_16x16x32_bf16 v[64:67], v[28:31], v[224:227], v[64:67]
  ds_read_b128 v[232:235], v4 offset:0
  ds_read_b128 v[236:239], v4 offset:2048
  v_mfma_f32_16x16x32_bf16 v[68:71], v[28:31], v[228:231], v[68:71]
  ds_read_b64_tr_b16 v[24:25], v114 offset:6144
  ds_read_b64_tr_b16 v[26:27], v114 offset:6400
  s_waitcnt lgkmcnt(8)
  v_mfma_f32_16x16x32_bf16 v[40:43], v[12:15], v[224:227], v[40:43]
  ds_read_b64_tr_b16 v[28:29], v114 offset:7168
  ds_read_b64_tr_b16 v[30:31], v114 offset:7424
  v_mfma_f32_16x16x32_bf16 v[44:47], v[12:15], v[228:231], v[44:47]
  s_waitcnt lgkmcnt(8)
  v_mfma_f32_16x16x32_bf16 v[56:59], v[16:19], v[224:227], v[56:59]
  ds_read_b64_tr_b16 v[12:13], v114 offset:8192
  ds_read_b64_tr_b16 v[14:15], v114 offset:8448
  v_mfma_f32_16x16x32_bf16 v[60:63], v[16:19], v[228:231], v[60:63]
  s_waitcnt lgkmcnt(8)
  v_mfma_f32_16x16x32_bf16 v[72:75], v[20:23], v[224:227], v[72:75]
  ds_read_b64_tr_b16 v[16:17], v115 offset:6144
  ds_read_b64_tr_b16 v[18:19], v115 offset:6400
  v_mfma_f32_16x16x32_bf16 v[76:79], v[20:23], v[228:231], v[76:79]
  s_waitcnt lgkmcnt(6)
  v_mfma_f32_16x16x32_bf16 v[32:35], v[24:27], v[232:235], v[32:35]
  ds_read_b64_tr_b16 v[20:21], v115 offset:7168
  ds_read_b64_tr_b16 v[22:23], v115 offset:7424
  v_mfma_f32_16x16x32_bf16 v[36:39], v[24:27], v[236:239], v[36:39]
  s_waitcnt lgkmcnt(6)
  v_mfma_f32_16x16x32_bf16 v[48:51], v[28:31], v[232:235], v[48:51]
  ds_read_b64_tr_b16 v[24:25], v115 offset:8192
  ds_read_b64_tr_b16 v[26:27], v115 offset:8448
  v_mfma_f32_16x16x32_bf16 v[52:55], v[28:31], v[236:239], v[52:55]
  s_waitcnt lgkmcnt(6)
  v_mfma_f32_16x16x32_bf16 v[64:67], v[12:15], v[232:235], v[64:67]
  s_barrier
  ds_read_b128 v[240:243], v3 offset:28672
  ds_read_b128 v[244:247], v3 offset:30720
  v_mfma_f32_16x16x32_bf16 v[68:71], v[12:15], v[236:239], v[68:71]
  ds_read_b64_tr_b16 v[28:29], v114 offset:28672
  ds_read_b64_tr_b16 v[30:31], v114 offset:28928
  s_waitcnt lgkmcnt(8)
  v_mfma_f32_16x16x32_bf16 v[40:43], v[16:19], v[232:235], v[40:43]
  ds_read_b64_tr_b16 v[12:13], v114 offset:29696
  ds_read_b64_tr_b16 v[14:15], v114 offset:29952
  v_mfma_f32_16x16x32_bf16 v[44:47], v[16:19], v[236:239], v[44:47]
  s_waitcnt lgkmcnt(8)
  v_mfma_f32_16x16x32_bf16 v[56:59], v[20:23], v[232:235], v[56:59]
  ds_read_b64_tr_b16 v[16:17], v114 offset:30720
  ds_read_b64_tr_b16 v[18:19], v114 offset:30976
  v_mfma_f32_16x16x32_bf16 v[60:63], v[20:23], v[236:239], v[60:63]
  s_waitcnt lgkmcnt(8)
  v_mfma_f32_16x16x32_bf16 v[72:75], v[24:27], v[232:235], v[72:75]
  ds_read_b64_tr_b16 v[20:21], v115 offset:28672
  ds_read_b64_tr_b16 v[22:23], v115 offset:28928
  v_mfma_f32_16x16x32_bf16 v[76:79], v[24:27], v[236:239], v[76:79]
  s_waitcnt lgkmcnt(6)
  v_mfma_f32_16x16x32_bf16 v[32:35], v[28:31], v[240:243], v[32:35]
  ds_read_b64_tr_b16 v[24:25], v115 offset:29696
  ds_read_b64_tr_b16 v[26:27], v115 offset:29952
  v_mfma_f32_16x16x32_bf16 v[36:39], v[28:31], v[244:247], v[36:39]
  s_waitcnt lgkmcnt(6)
  v_mfma_f32_16x16x32_bf16 v[48:51], v[12:15], v[240:243], v[48:51]
  ds_read_b64_tr_b16 v[28:29], v115 offset:30720
  ds_read_b64_tr_b16 v[30:31], v115 offset:30976
  v_mfma_f32_16x16x32_bf16 v[52:55], v[12:15], v[244:247], v[52:55]
  s_waitcnt lgkmcnt(6)
  v_mfma_f32_16x16x32_bf16 v[64:67], v[16:19], v[240:243], v[64:67]
  ds_read_b128 v[248:251], v4 offset:28672
  ds_read_b128 v[252:255], v4 offset:30720
  v_mfma_f32_16x16x32_bf16 v[68:71], v[16:19], v[244:247], v[68:71]
  ds_read_b64_tr_b16 v[12:13], v114 offset:34816
  ds_read_b64_tr_b16 v[14:15], v114 offset:35072
  s_waitcnt lgkmcnt(8)
  v_mfma_f32_16x16x32_bf16 v[40:43], v[20:23], v[240:243], v[40:43]
  ds_read_b64_tr_b16 v[16:17], v114 offset:35840
  ds_read_b64_tr_b16 v[18:19], v114 offset:36096
  v_mfma_f32_16x16x32_bf16 v[44:47], v[20:23], v[244:247], v[44:47]
  s_waitcnt lgkmcnt(8)
  v_mfma_f32_16x16x32_bf16 v[56:59], v[24:27], v[240:243], v[56:59]
  ds_read_b64_tr_b16 v[20:21], v114 offset:36864
  ds_read_b64_tr_b16 v[22:23], v114 offset:37120
  v_mfma_f32_16x16x32_bf16 v[60:63], v[24:27], v[244:247], v[60:63]
  s_waitcnt lgkmcnt(8)
  v_mfma_f32_16x16x32_bf16 v[72:75], v[28:31], v[240:243], v[72:75]
  ds_read_b64_tr_b16 v[24:25], v115 offset:34816
  ds_read_b64_tr_b16 v[26:27], v115 offset:35072
  v_mfma_f32_16x16x32_bf16 v[76:79], v[28:31], v[244:247], v[76:79]
  s_waitcnt vmcnt(0)
  s_waitcnt lgkmcnt(6)
  v_mfma_f32_16x16x32_bf16 v[32:35], v[12:15], v[248:251], v[32:35]
  ds_read_b64_tr_b16 v[28:29], v115 offset:35840
  ds_read_b64_tr_b16 v[30:31], v115 offset:36096
  v_mfma_f32_16x16x32_bf16 v[36:39], v[12:15], v[252:255], v[36:39]
  s_waitcnt lgkmcnt(6)
  v_mfma_f32_16x16x32_bf16 v[48:51], v[16:19], v[248:251], v[48:51]
  ds_read_b64_tr_b16 v[12:13], v115 offset:36864
  ds_read_b64_tr_b16 v[14:15], v115 offset:37120
  v_mfma_f32_16x16x32_bf16 v[52:55], v[16:19], v[252:255], v[52:55]
  s_waitcnt lgkmcnt(6)
  v_mfma_f32_16x16x32_bf16 v[64:67], v[20:23], v[248:251], v[64:67]
  s_barrier
  ds_read_b64_tr_b16 v[16:17], v7 offset:0
  v_mfma_f32_16x16x32_bf16 v[68:71], v[20:23], v[252:255], v[68:71]
  ds_read_b64_tr_b16 v[18:19], v7 offset:256
  s_waitcnt lgkmcnt(6)
  v_mfma_f32_16x16x32_bf16 v[40:43], v[24:27], v[248:251], v[40:43]
  ds_read_b64_tr_b16 v[20:21], v8 offset:0
  ds_read_b64_tr_b16 v[22:23], v8 offset:256
  v_mfma_f32_16x16x32_bf16 v[44:47], v[24:27], v[252:255], v[44:47]
  s_waitcnt lgkmcnt(6)
  v_mfma_f32_16x16x32_bf16 v[56:59], v[28:31], v[248:251], v[56:59]
  ds_read_b64_tr_b16 v[24:25], v7 offset:1024
  ds_read_b64_tr_b16 v[26:27], v7 offset:1280
  v_mfma_f32_16x16x32_bf16 v[60:63], v[28:31], v[252:255], v[60:63]
  s_waitcnt lgkmcnt(6)
  v_mfma_f32_16x16x32_bf16 v[72:75], v[12:15], v[248:251], v[72:75]
  ds_read_b64_tr_b16 v[28:29], v7 offset:3072
  ds_read_b64_tr_b16 v[30:31], v7 offset:3328
  v_mfma_f32_16x16x32_bf16 v[76:79], v[12:15], v[252:255], v[76:79]
G_P2:
  s_waitcnt lgkmcnt(4)
  v_mfma_f32_16x16x32_bf16 v[80:83], v[16:19], v[128:131], 0
  ds_read_b64_tr_b16 v[12:13], v8 offset:3072
  ds_read_b64_tr_b16 v[14:15], v8 offset:3328
  v_mfma_f32_16x16x32_bf16 v[84:87], v[16:19], v[132:135], 0
  v_cvt_pk_bf16_f32 v32, v32, v33
  v_cvt_pk_bf16_f32 v33, v34, v35
  v_mfma_f32_16x16x32_bf16 v[96:99], v[20:23], v[128:131], 0
  ds_read_b64_tr_b16 v[16:17], v7 offset:4096
  ds_read_b64_tr_b16 v[18:19], v7 offset:4352
  v_mfma_f32_16x16x32_bf16 v[100:103], v[20:23], v[132:135], 0
  v_cvt_pk_bf16_f32 v34, v36, v37
  v_cvt_pk_bf16_f32 v35, v38, v39
  s_waitcnt lgkmcnt(4)
  v_mfma_f32_16x16x32_bf16 v[112:115], v[24:27], v[128:131], 0
  ds_read_b64_tr_b16 v[20:21], v7 offset:12288
  ds_read_b64_tr_b16 v[22:23], v7 offset:12544
  v_mfma_f32_16x16x32_bf16 v[116:119], v[24:27], v[132:135], 0
  v_permlane16_swap_b32 v32, v34
  v_permlane16_swap_b32 v33, v35
  v_mfma_f32_16x16x32_bf16 v[88:91], v[28:31], v[128:131], 0
  ds_read_b64_tr_b16 v[24:25], v8 offset:12288
  ds_read_b64_tr_b16 v[26:27], v8 offset:12544
  v_mfma_f32_16x16x32_bf16 v[92:95], v[28:31], v[132:135], 0
  v_or_b32 v32, s90, v32
  buffer_store_dwordx4 v[32:35], v0, s[4:7], s76 offen sc1
  s_waitcnt lgkmcnt(4)
  v_mfma_f32_16x16x32_bf16 v[104:107], v[12:15], v[128:131], 0
  ds_read_b64_tr_b16 v[28:29], v7 offset:13312
  ds_read_b64_tr_b16 v[30:31], v7 offset:13568
  v_mfma_f32_16x16x32_bf16 v[108:111], v[12:15], v[132:135], 0
  v_cvt_pk_bf16_f32 v40, v40, v41
  v_cvt_pk_bf16_f32 v41, v42, v43
  v_mfma_f32_16x16x32_bf16 v[120:123], v[16:19], v[128:131], 0
  ds_read_b64_tr_b16 v[12:13], v7 offset:15360
  ds_read_b64_tr_b16 v[14:15], v7 offset:15616
  v_mfma_f32_16x16x32_bf16 v[124:127], v[16:19], v[132:135], 0
  v_cvt_pk_bf16_f32 v42, v44, v45
  v_cvt_pk_bf16_f32 v43, v46, v47
  s_waitcnt lgkmcnt(4)
  v_mfma_f32_16x16x32_bf16 v[80:83], v[20:23], v[136:139], v[80:83]
  ds_read_b64_tr_b16 v[16:17], v8 offset:15360
  ds_read_b64_tr_b16 v[18:19], v8 offset:15616
  v_mfma_f32_16x16x32_bf16 v[84:87], v[20:23], v[140:143], v[84:87]
  v_permlane16_swap_b32 v40, v42
  v_permlane16_swap_b32 v41, v43
  v_mfma_f32_16x16x32_bf16 v[96:99], v[24:27], v[136:139], v[96:99]
  ds_read_b64_tr_b16 v[20:21], v7 offset:16384
  ds_read_b64_tr_b16 v[22:23], v7 offset:16640
  v_mfma_f32_16x16x32_bf16 v[100:103], v[24:27], v[140:143], v[100:103]
  v_or_b32_e64 v40, s90, v40
  buffer_store_dwordx4 v[40:43], v0, s[4:7], s77 offen sc1
  s_waitcnt lgkmcnt(4)
  v_mfma_f32_16x16x32_bf16 v[112:115], v[28:31], v[136:139], v[112:115]
  ds_read_b64_tr_b16 v[24:25], v8 offset:1024
  ds_read_b64_tr_b16 v[26:27], v8 offset:1280
  v_mfma_f32_16x16x32_bf16 v[116:119], v[28:31], v[140:143], v[116:119]
  v_cvt_pk_bf16_f32 v48, v48, v49
  v_cvt_pk_bf16_f32 v49, v50, v51
  v_cvt_pk_bf16_f32 v50, v52, v53
  v_mfma_f32_16x16x32_bf16 v[88:91], v[12:15], v[136:139], v[88:91]
  ds_read_b64_tr_b16 v[28:29], v8 offset:4096
  ds_read_b64_tr_b16 v[30:31], v8 offset:4352
  v_cvt_pk_bf16_f32 v51, v54, v55
  v_mfma_f32_16x16x32_bf16 v[92:95], v[12:15], v[140:143], v[92:95]
  v_permlane16_swap_b32 v48, v50
  v_permlane16_swap_b32 v49, v51
  s_waitcnt lgkmcnt(4)
  v_mfma_f32_16x16x32_bf16 v[104:107], v[16:19], v[136:139], v[104:107]
  ds_read_b64_tr_b16 v[12:13], v8 offset:13312
  ds_read_b64_tr_b16 v[14:15], v8 offset:13568
  v_mfma_f32_16x16x32_bf16 v[108:111], v[16:19], v[140:143], v[108:111]
  v_or_b32_e64 v48, s91, v48
  buffer_store_dwordx4 v[48:51], v0, s[4:7], s78 offen sc1
  v_mfma_f32_16x16x32_bf16 v[120:123], v[20:23], v[136:139], v[120:123]
  ds_read_b64_tr_b16 v[16:17], v8 offset:16384
  ds_read_b64_tr_b16 v[18:19], v8 offset:16640
  v_mfma_f32_16x16x32_bf16 v[124:127], v[20:23], v[140:143], v[124:127]
  v_cvt_pk_bf16_f32 v56, v56, v57
  v_cvt_pk_bf16_f32 v57, v58, v59
  s_cmp_lg_u32 s63, 0
  s_cbranch_scc1 G_L4
  s_waitcnt lgkmcnt(4)
  v_mfma_f32_16x16x32_bf16 v[32:35], v[24:27], v[128:131], 0
  ds_read_b64_tr_b16 v[20:21], v7 offset:2048
  ds_read_b64_tr_b16 v[22:23], v7 offset:2304
  v_mfma_f32_16x16x32_bf16 v[36:39], v[24:27], v[132:135], 0
  v_cvt_pk_bf16_f32 v58, v60, v61
  v_cvt_pk_bf16_f32 v59, v62, v63
  v_mfma_f32_16x16x32_bf16 v[40:43], v[28:31], v[128:131], 0
  ds_read_b64_tr_b16 v[24:25], v7 offset:5120
  ds_read_b64_tr_b16 v[26:27], v7 offset:5376
  v_mfma_f32_16x16x32_bf16 v[44:47], v[28:31], v[132:135], 0
  v_permlane16_swap_b32 v56, v58
  v_permlane16_swap_b32 v57, v59
  s_waitcnt lgkmcnt(4)
  v_mfma_f32_16x16x32_bf16 v[32:35], v[12:15], v[136:139], v[32:35]
  ds_read_b64_tr_b16 v[28:29], v7 offset:14336
  ds_read_b64_tr_b16 v[30:31], v7 offset:14592
  v_mfma_f32_16x16x32_bf16 v[36:39], v[12:15], v[140:143], v[36:39]
  v_or_b32_e64 v56, s91, v56
  buffer_store_dwordx4 v[56:59], v0, s[4:7], s79 offen sc1
  v_mfma_f32_16x16x32_bf16 v[40:43], v[16:19], v[136:139], v[40:43]
  ds_read_b64_tr_b16 v[12:13], v7 offset:17408
  ds_read_b64_tr_b16 v[14:15], v7 offset:17664
  v_cvt_pk_bf16_f32 v64, v64, v65
  v_mfma_f32_16x16x32_bf16 v[44:47], v[16:19], v[140:143], v[44:47]
  v_cvt_pk_bf16_f32 v65, v66, v67
  v_cvt_pk_bf16_f32 v66, v68, v69
  v_cvt_pk_bf16_f32 v67, v70, v71
  s_waitcnt lgkmcnt(4)
  v_mfma_f32_16x16x32_bf16 v[48:51], v[20:23], v[128:131], 0
  ds_read_b64_tr_b16 v[16:17], v8 offset:2048
  ds_read_b64_tr_b16 v[18:19], v8 offset:2304
  v_permlane16_swap_b32 v64, v66
  v_mfma_f32_16x16x32_bf16 v[52:55], v[20:23], v[132:135], 0
  v_permlane16_swap_b32 v65, v67
  v_or_b32 v64, s92, v64
  buffer_store_dwordx4 v[64:67], v0, s[4:7], s80 offen sc1
  v_mfma_f32_16x16x32_bf16 v[56:59], v[24:27], v[128:131], 0
  ds_read_b64_tr_b16 v[20:21], v8 offset:5120
  ds_read_b64_tr_b16 v[22:23], v8 offset:5376
  v_cvt_pk_bf16_f32 v72, v72, v73
  v_mfma_f32_16x16x32_bf16 v[60:63], v[24:27], v[132:135], 0
  v_cvt_pk_bf16_f32 v73, v74, v75
  v_cvt_pk_bf16_f32 v74, v76, v77
  s_waitcnt lgkmcnt(4)
  v_mfma_f32_16x16x32_bf16 v[48:51], v[28:31], v[136:139], v[48:51]
  ds_read_b64_tr_b16 v[24:25], v8 offset:14336
  ds_read_b64_tr_b16 v[26:27], v8 offset:14592
  v_mfma_f32_16x16x32_bf16 v[52:55], v[28:31], v[140:143], v[52:55]
  v_cvt_pk_bf16_f32 v75, v78, v79
  v_permlane16_swap_b32 v72, v74
  s_nop 0
  v_permlane16_swap_b32 v73, v75
  v_mfma_f32_16x16x32_bf16 v[56:59], v[12:15], v[136:139], v[56:59]
  ds_read_b64_tr_b16 v[28:29], v8 offset:17408
  ds_read_b64_tr_b16 v[30:31], v8 offset:17664
  v_mfma_f32_16x16x32_bf16 v[60:63], v[12:15], v[140:143], v[60:63]
  v_or_b32_e64 v72, s92, v72
  buffer_store_dwordx4 v[72:75], v0, s[4:7], s81 offen sc1
  s_waitcnt lgkmcnt(4)
  v_mfma_f32_16x16x32_bf16 v[64:67], v[16:19], v[128:131], 0
  s_barrier
  ds_read_b64_tr_b16 v[12:13], v7 offset:28672
  v_mfma_f32_16x16x32_bf16 v[68:71], v[16:19], v[132:135], 0
  ds_read_b64_tr_b16 v[14:15], v7 offset:28928
  v_mfma_f32_16x16x32_bf16 v[72:75], v[20:23], v[128:131], 0
  ds_read_b64_tr_b16 v[16:17], v8 offset:28672
  ds_read_b64_tr_b16 v[18:19], v8 offset:28928
  v_mfma_f32_16x16x32_bf16 v[76:79], v[20:23], v[132:135], 0
  s_waitcnt lgkmcnt(4)
  v_mfma_f32_16x16x32_bf16 v[64:67], v[24:27], v[136:139], v[64:67]
  ds_read_b64_tr_b16 v[20:21], v7 offset:29696
  ds_read_b64_tr_b16 v[22:23], v7 offset:29952
  v_mfma_f32_16x16x32_bf16 v[68:71], v[24:27], v[140:143], v[68:71]
  v_mov_b32 v6, 162304
  v_mfma_f32_16x16x32_bf16 v[72:75], v[28:31], v[136:139], v[72:75]
  ds_read_b64_tr_b16 v[24:25], v8 offset:29696
  ds_read_b64_tr_b16 v[26:27], v8 offset:29952
  v_mfma_f32_16x16x32_bf16 v[76:79], v[28:31], v[140:143], v[76:79]
  s_and_b32 s50, s46, 1
  s_waitcnt lgkmcnt(4)
  v_mfma_f32_16x16x32_bf16 v[80:83], v[12:15], v[144:147], v[80:83]
  ds_read_b64_tr_b16 v[28:29], v7 offset:30720
  ds_read_b64_tr_b16 v[30:31], v7 offset:30976
  v_mfma_f32_16x16x32_bf16 v[84:87], v[12:15], v[148:151], v[84:87]
  v_mfma_f32_16x16x32_bf16 v[96:99], v[16:19], v[144:147], v[96:99]
  ds_read_b64_tr_b16 v[12:13], v8 offset:30720
  ds_read_b64_tr_b16 v[14:15], v8 offset:30976
  v_mfma_f32_16x16x32_bf16 v[100:103], v[16:19], v[148:151], v[100:103]
  s_lshl_b32 s50, s50, 2
  s_waitcnt lgkmcnt(4)
  v_mfma_f32_16x16x32_bf16 v[112:115], v[20:23], v[144:147], v[112:115]
  ds_read_b64_tr_b16 v[16:17], v7 offset:31744
  ds_read_b64_tr_b16 v[18:19], v7 offset:32000
  v_mfma_f32_16x16x32_bf16 v[116:119], v[20:23], v[148:151], v[116:119]
  v_mfma_f32_16x16x32_bf16 v[32:35], v[24:27], v[144:147], v[32:35]
  ds_read_b64_tr_b16 v[20:21], v8 offset:31744
  ds_read_b64_tr_b16 v[22:23], v8 offset:32000
  v_mfma_f32_16x16x32_bf16 v[36:39], v[24:27], v[148:151], v[36:39]
  s_add_u32 s50, s50, s45
  s_waitcnt lgkmcnt(4)
  v_mfma_f32_16x16x32_bf16 v[48:51], v[28:31], v[144:147], v[48:51]
  ds_read_b64_tr_b16 v[24:25], v7 offset:32768
  ds_read_b64_tr_b16 v[26:27], v7 offset:33024
  v_mfma_f32_16x16x32_bf16 v[52:55], v[28:31], v[148:151], v[52:55]
  v_mfma_f32_16x16x32_bf16 v[64:67], v[12:15], v[144:147], v[64:67]
  ds_read_b64_tr_b16 v[28:29], v8 offset:32768
  ds_read_b64_tr_b16 v[30:31], v8 offset:33024
  v_mfma_f32_16x16x32_bf16 v[68:71], v[12:15], v[148:151], v[68:71]
  s_lshl_b32 s50, s50, 7
  s_waitcnt lgkmcnt(4)
  v_mfma_f32_16x16x32_bf16 v[88:91], v[16:19], v[144:147], v[88:91]
  ds_read_b64_tr_b16 v[12:13], v7 offset:33792
  ds_read_b64_tr_b16 v[14:15], v7 offset:34048
  v_mfma_f32_16x16x32_bf16 v[92:95], v[16:19], v[148:151], v[92:95]
  s_add_u32 s50, s50, 160768
  v_mfma_f32_16x16x32_bf16 v[104:107], v[20:23], v[144:147], v[104:107]
  ds_read_b64_tr_b16 v[16:17], v8 offset:33792
  ds_read_b64_tr_b16 v[18:19], v8 offset:34048
  v_mfma_f32_16x16x32_bf16 v[108:111], v[20:23], v[148:151], v[108:111]
  s_waitcnt lgkmcnt(4)
  v_mfma_f32_16x16x32_bf16 v[120:123], v[24:27], v[144:147], v[120:123]
  ds_read_b64_tr_b16 v[20:21], v7 offset:40960
  ds_read_b64_tr_b16 v[22:23], v7 offset:41216
  v_mfma_f32_16x16x32_bf16 v[124:127], v[24:27], v[148:151], v[124:127]
  v_bfe_u32 v3, v0, 4, 4
  v_mfma_f32_16x16x32_bf16 v[40:43], v[28:31], v[144:147], v[40:43]
  ds_read_b64_tr_b16 v[24:25], v8 offset:40960
  ds_read_b64_tr_b16 v[26:27], v8 offset:41216
  v_mfma_f32_16x16x32_bf16 v[44:47], v[28:31], v[148:151], v[44:47]
  s_waitcnt lgkmcnt(4)
  v_mfma_f32_16x16x32_bf16 v[56:59], v[12:15], v[144:147], v[56:59]
  ds_read_b64_tr_b16 v[28:29], v7 offset:41984
  ds_read_b64_tr_b16 v[30:31], v7 offset:42240
  v_mfma_f32_16x16x32_bf16 v[60:63], v[12:15], v[148:151], v[60:63]
  v_lshl_add_u32 v3, v3, 2, s50
  v_mfma_f32_16x16x32_bf16 v[72:75], v[16:19], v[144:147], v[72:75]
  ds_read_b64_tr_b16 v[12:13], v8 offset:41984
  ds_read_b64_tr_b16 v[14:15], v8 offset:42240
  v_mfma_f32_16x16x32_bf16 v[76:79], v[16:19], v[148:151], v[76:79]
  s_waitcnt lgkmcnt(4)
  v_mfma_f32_16x16x32_bf16 v[80:83], v[20:23], v[152:155], v[80:83]
  ds_read_b64_tr_b16 v[16:17], v7 offset:43008
  ds_read_b64_tr_b16 v[18:19], v7 offset:43264
  v_mfma_f32_16x16x32_bf16 v[84:87], v[20:23], v[156:159], v[84:87]
  v_mfma_f32_16x16x32_bf16 v[96:99], v[24:27], v[152:155], v[96:99]
  ds_read_b64_tr_b16 v[20:21], v8 offset:43008
  ds_read_b64_tr_b16 v[22:23], v8 offset:43264
  v_mfma_f32_16x16x32_bf16 v[100:103], v[24:27], v[156:159], v[100:103]
  s_waitcnt lgkmcnt(4)
  v_mfma_f32_16x16x32_bf16 v[112:115], v[28:31], v[152:155], v[112:115]
  ds_read_b64_tr_b16 v[24:25], v7 offset:44032
  ds_read_b64_tr_b16 v[26:27], v7 offset:44288
  v_mfma_f32_16x16x32_bf16 v[116:119], v[28:31], v[156:159], v[116:119]
  v_mfma_f32_16x16x32_bf16 v[32:35], v[12:15], v[152:155], v[32:35]
  ds_read_b64_tr_b16 v[28:29], v8 offset:44032
  ds_read_b64_tr_b16 v[30:31], v8 offset:44288
  v_mfma_f32_16x16x32_bf16 v[36:39], v[12:15], v[156:159], v[36:39]
  s_waitcnt lgkmcnt(4)
  v_mfma_f32_16x16x32_bf16 v[48:51], v[16:19], v[152:155], v[48:51]
  ds_read_b64_tr_b16 v[12:13], v7 offset:45056
  ds_read_b64_tr_b16 v[14:15], v7 offset:45312
  v_mfma_f32_16x16x32_bf16 v[52:55], v[16:19], v[156:159], v[52:55]
  v_mfma_f32_16x16x32_bf16 v[64:67], v[20:23], v[152:155], v[64:67]
  ds_read_b64_tr_b16 v[16:17], v8 offset:45056
  ds_read_b64_tr_b16 v[18:19], v8 offset:45312
  v_mfma_f32_16x16x32_bf16 v[68:71], v[20:23], v[156:159], v[68:71]
  s_waitcnt lgkmcnt(4)
  v_mfma_f32_16x16x32_bf16 v[88:91], v[24:27], v[152:155], v[88:91]
  ds_read_b64_tr_b16 v[20:21], v7 offset:46080
  ds_read_b64_tr_b16 v[22:23], v7 offset:46336
  v_mfma_f32_16x16x32_bf16 v[92:95], v[24:27], v[156:159], v[92:95]
  v_mfma_f32_16x16x32_bf16 v[104:107], v[28:31], v[152:155], v[104:107]
  ds_read_b64_tr_b16 v[24:25], v8 offset:46080
  ds_read_b64_tr_b16 v[26:27], v8 offset:46336
  v_mfma_f32_16x16x32_bf16 v[108:111], v[28:31], v[156:159], v[108:111]
  s_waitcnt lgkmcnt(4)
  v_mfma_f32_16x16x32_bf16 v[120:123], v[12:15], v[152:155], v[120:123]
  s_barrier
  ds_read_b64_tr_b16 v[28:29], v9 offset:0
  v_mfma_f32_16x16x32_bf16 v[124:127], v[12:15], v[156:159], v[124:127]
  ds_read_b64_tr_b16 v[30:31], v9 offset:256
  v_mfma_f32_16x16x32_bf16 v[40:43], v[16:19], v[152:155], v[40:43]
  ds_read_b64_tr_b16 v[12:13], v10 offset:0
  ds_read_b64_tr_b16 v[14:15], v10 offset:256
  v_mfma_f32_16x16x32_bf16 v[44:47], v[16:19], v[156:159], v[44:47]
  s_waitcnt lgkmcnt(4)
  v_mfma_f32_16x16x32_bf16 v[56:59], v[20:23], v[152:155], v[56:59]
  ds_read_b64_tr_b16 v[16:17], v9 offset:1024
  ds_read_b64_tr_b16 v[18:19], v9 offset:1280
  v_mfma_f32_16x16x32_bf16 v[60:63], v[20:23], v[156:159], v[60:63]
  v_mfma_f32_16x16x32_bf16 v[72:75], v[24:27], v[152:155], v[72:75]
  ds_read_b64_tr_b16 v[20:21], v10 offset:1024
  ds_read_b64_tr_b16 v[22:23], v10 offset:1280
  v_mfma_f32_16x16x32_bf16 v[76:79], v[24:27], v[156:159], v[76:79]
  s_waitcnt lgkmcnt(4)
  v_mfma_f32_16x16x32_bf16 v[80:83], v[28:31], v[160:163], v[80:83]
  ds_read_b64_tr_b16 v[24:25], v9 offset:2048
  ds_read_b64_tr_b16 v[26:27], v9 offset:2304
  s_lshl_b32 s50, s46, 4
  s_add_u32 s50, s50, s47
  s_lshl_b32 s50, s50, 5
  s_add_u32 s50, s50, s45
  v_mfma_f32_16x16x32_bf16 v[84:87], v[28:31], v[164:167], v[84:87]
  s_lshl_b32 s50, s50, 2
  s_add_u32 s50, s50, 14680064
  v_mov_b32_e64 v5, 1
  s_mov_b64 exec, 1
  s_waitcnt vmcnt(0)
  buffer_store_dword v5, off, s[4:7], s50 sc1
  s_mov_b64 exec, -1
  v_mfma_f32_16x16x32_bf16 v[96:99], v[12:15], v[160:163], v[96:99]
  ds_read_b64_tr_b16 v[28:29], v10 offset:2048
  ds_read_b64_tr_b16 v[30:31], v10 offset:2304
  v_mfma_f32_16x16x32_bf16 v[100:103], v[12:15], v[164:167], v[100:103]
  s_waitcnt lgkmcnt(4)
  v_mfma_f32_16x16x32_bf16 v[112:115], v[16:19], v[160:163], v[112:115]
  ds_read_b64_tr_b16 v[12:13], v9 offset:3072
  ds_read_b64_tr_b16 v[14:15], v9 offset:3328
  v_mfma_f32_16x16x32_bf16 v[116:119], v[16:19], v[164:167], v[116:119]
  v_mfma_f32_16x16x32_bf16 v[32:35], v[20:23], v[160:163], v[32:35]
  ds_read_b64_tr_b16 v[16:17], v10 offset:3072
  ds_read_b64_tr_b16 v[18:19], v10 offset:3328
  v_mfma_f32_16x16x32_bf16 v[36:39], v[20:23], v[164:167], v[36:39]
  s_waitcnt lgkmcnt(4)
  v_mfma_f32_16x16x32_bf16 v[48:51], v[24:27], v[160:163], v[48:51]
  ds_read_b64_tr_b16 v[20:21], v9 offset:4096
  ds_read_b64_tr_b16 v[22:23], v9 offset:4352
  v_mfma_f32_16x16x32_bf16 v[52:55], v[24:27], v[164:167], v[52:55]
  v_mfma_f32_16x16x32_bf16 v[64:67], v[28:31], v[160:163], v[64:67]
  ds_read_b64_tr_b16 v[24:25], v10 offset:4096
  ds_read_b64_tr_b16 v[26:27], v10 offset:4352
  v_mfma_f32_16x16x32_bf16 v[68:71], v[28:31], v[164:167], v[68:71]
  s_waitcnt lgkmcnt(4)
  v_mfma_f32_16x16x32_bf16 v[88:91], v[12:15], v[160:163], v[88:91]
  ds_read_b64_tr_b16 v[28:29], v9 offset:5120
  ds_read_b64_tr_b16 v[30:31], v9 offset:5376
  v_mfma_f32_16x16x32_bf16 v[92:95], v[12:15], v[164:167], v[92:95]
  v_mfma_f32_16x16x32_bf16 v[104:107], v[16:19], v[160:163], v[104:107]
  ds_read_b64_tr_b16 v[12:13], v10 offset:5120
  ds_read_b64_tr_b16 v[14:15], v10 offset:5376
  v_mfma_f32_16x16x32_bf16 v[108:111], v[16:19], v[164:167], v[108:111]
  s_waitcnt lgkmcnt(4)
  v_mfma_f32_16x16x32_bf16 v[120:123], v[20:23], v[160:163], v[120:123]
  ds_read_b64_tr_b16 v[16:17], v9 offset:12288
  ds_read_b64_tr_b16 v[18:19], v9 offset:12544
  v_mfma_f32_16x16x32_bf16 v[124:127], v[20:23], v[164:167], v[124:127]
  v_mfma_f32_16x16x32_bf16 v[40:43], v[24:27], v[160:163], v[40:43]
  ds_read_b64_tr_b16 v[20:21], v10 offset:12288
  ds_read_b64_tr_b16 v[22:23], v10 offset:12544
  v_mfma_f32_16x16x32_bf16 v[44:47], v[24:27], v[164:167], v[44:47]
  s_waitcnt lgkmcnt(4)
  v_mfma_f32_16x16x32_bf16 v[56:59], v[28:31], v[160:163], v[56:59]
  ds_read_b64_tr_b16 v[24:25], v9 offset:13312
  ds_read_b64_tr_b16 v[26:27], v9 offset:13568
  v_mfma_f32_16x16x32_bf16 v[60:63], v[28:31], v[164:167], v[60:63]
  v_mfma_f32_16x16x32_bf16 v[72:75], v[12:15], v[160:163], v[72:75]
  ds_read_b64_tr_b16 v[28:29], v10 offset:13312
  ds_read_b64_tr_b16 v[30:31], v10 offset:13568
  v_mfma_f32_16x16x32_bf16 v[76:79], v[12:15], v[164:167], v[76:79]
  s_waitcnt lgkmcnt(4)
  v_mfma_f32_16x16x32_bf16 v[80:83], v[16:19], v[168:171], v[80:83]
  ds_read_b64_tr_b16 v[12:13], v9 offset:14336
  ds_read_b64_tr_b16 v[14:15], v9 offset:14592
  v_mfma_f32_16x16x32_bf16 v[84:87], v[16:19], v[172:175], v[84:87]
  v_mfma_f32_16x16x32_bf16 v[96:99], v[20:23], v[168:171], v[96:99]
  ds_read_b64_tr_b16 v[16:17], v10 offset:14336
  ds_read_b64_tr_b16 v[18:19], v10 offset:14592
  v_mfma_f32_16x16x32_bf16 v[100:103], v[20:23], v[172:175], v[100:103]
  s_waitcnt lgkmcnt(4)
  v_mfma_f32_16x16x32_bf16 v[112:115], v[24:27], v[168:171], v[112:115]
  ds_read_b64_tr_b16 v[20:21], v9 offset:15360
  ds_read_b64_tr_b16 v[22:23], v9 offset:15616
  v_mfma_f32_16x16x32_bf16 v[116:119], v[24:27], v[172:175], v[116:119]
  v_mfma_f32_16x16x32_bf16 v[32:35], v[28:31], v[168:171], v[32:35]
  ds_read_b64_tr_b16 v[24:25], v10 offset:15360
  ds_read_b64_tr_b16 v[26:27], v10 offset:15616
  v_mfma_f32_16x16x32_bf16 v[36:39], v[28:31], v[172:175], v[36:39]
  s_waitcnt lgkmcnt(4)
  v_mfma_f32_16x16x32_bf16 v[48:51], v[12:15], v[168:171], v[48:51]
  ds_read_b64_tr_b16 v[28:29], v9 offset:16384
  ds_read_b64_tr_b16 v[30:31], v9 offset:16640
  v_mfma_f32_16x16x32_bf16 v[52:55], v[12:15], v[172:175], v[52:55]
  v_mfma_f32_16x16x32_bf16 v[64:67], v[16:19], v[168:171], v[64:67]
  ds_read_b64_tr_b16 v[12:13], v10 offset:16384
  ds_read_b64_tr_b16 v[14:15], v10 offset:16640
  v_mfma_f32_16x16x32_bf16 v[68:71], v[16:19], v[172:175], v[68:71]
  s_waitcnt lgkmcnt(4)
  v_mfma_f32_16x16x32_bf16 v[88:91], v[20:23], v[168:171], v[88:91]
  ds_read_b64_tr_b16 v[16:17], v9 offset:17408
  ds_read_b64_tr_b16 v[18:19], v9 offset:17664
  v_mfma_f32_16x16x32_bf16 v[92:95], v[20:23], v[172:175], v[92:95]
  v_mfma_f32_16x16x32_bf16 v[104:107], v[24:27], v[168:171], v[104:107]
  ds_read_b64_tr_b16 v[20:21], v10 offset:17408
  ds_read_b64_tr_b16 v[22:23], v10 offset:17664
  v_mfma_f32_16x16x32_bf16 v[108:111], v[24:27], v[172:175], v[108:111]
  s_waitcnt lgkmcnt(4)
  v_mfma_f32_16x16x32_bf16 v[120:123], v[28:31], v[168:171], v[120:123]
  s_barrier
  ds_read_b64_tr_b16 v[24:25], v9 offset:28672
  v_mfma_f32_16x16x32_bf16 v[124:127], v[28:31], v[172:175], v[124:127]
  ds_read_b64_tr_b16 v[26:27], v9 offset:28928
  v_mfma_f32_16x16x32_bf16 v[40:43], v[12:15], v[168:171], v[40:43]
  ds_read_b64_tr_b16 v[28:29], v10 offset:28672
  ds_read_b64_tr_b16 v[30:31], v10 offset:28928
  v_mfma_f32_16x16x32_bf16 v[44:47], v[12:15], v[172:175], v[44:47]
  s_waitcnt lgkmcnt(4)
  v_mfma_f32_16x16x32_bf16 v[56:59], v[16:19], v[168:171], v[56:59]
  ds_read_b64_tr_b16 v[12:13], v9 offset:29696
  ds_read_b64_tr_b16 v[14:15], v9 offset:29952
  v_mfma_f32_16x16x32_bf16 v[60:63], v[16:19], v[172:175], v[60:63]
  v_mfma_f32_16x16x32_bf16 v[72:75], v[20:23], v[168:171], v[72:75]
  ds_read_b64_tr_b16 v[16:17], v10 offset:29696
  ds_read_b64_tr_b16 v[18:19], v10 offset:29952
  v_mfma_f32_16x16x32_bf16 v[76:79], v[20:23], v[172:175], v[76:79]
  s_waitcnt lgkmcnt(4)
  v_mfma_f32_16x16x32_bf16 v[80:83], v[24:27], v[176:179], v[80:83]
  ds_read_b64_tr_b16 v[20:21], v9 offset:30720
  ds_read_b64_tr_b16 v[22:23], v9 offset:30976
  v_mfma_f32_16x16x32_bf16 v[84:87], v[24:27], v[180:183], v[84:87]
  v_mfma_f32_16x16x32_bf16 v[96:99], v[28:31], v[176:179], v[96:99]
  ds_read_b64_tr_b16 v[24:25], v10 offset:30720
  ds_read_b64_tr_b16 v[26:27], v10 offset:30976
  v_mfma_f32_16x16x32_bf16 v[100:103], v[28:31], v[180:183], v[100:103]
  s_waitcnt lgkmcnt(4)
  v_mfma_f32_16x16x32_bf16 v[112:115], v[12:15], v[176:179], v[112:115]
  ds_read_b64_tr_b16 v[28:29], v9 offset:31744
  ds_read_b64_tr_b16 v[30:31], v9 offset:32000
  v_mfma_f32_16x16x32_bf16 v[116:119], v[12:15], v[180:183], v[116:119]
  v_lshrrev_b32 v147, 4, v0
  v_mfma_f32_16x16x32_bf16 v[32:35], v[16:19], v[176:179], v[32:35]
  ds_read_b64_tr_b16 v[12:13], v10 offset:31744
  ds_read_b64_tr_b16 v[14:15], v10 offset:32000
  v_mfma_f32_16x16x32_bf16 v[36:39], v[16:19], v[180:183], v[36:39]
  v_bfe_u32 v162, v147, 4, 1
  s_waitcnt lgkmcnt(4)
  v_mfma_f32_16x16x32_bf16 v[48:51], v[20:23], v[176:179], v[48:51]
  ds_read_b64_tr_b16 v[16:17], v9 offset:32768
  ds_read_b64_tr_b16 v[18:19], v9 offset:33024
  v_mfma_f32_16x16x32_bf16 v[52:55], v[20:23], v[180:183], v[52:55]
  v_lshlrev_b32 v162, 2, v162
  v_mfma_f32_16x16x32_bf16 v[64:67], v[24:27], v[176:179], v[64:67]
  ds_read_b64_tr_b16 v[20:21], v10 offset:32768
  ds_read_b64_tr_b16 v[22:23], v10 offset:33024
  v_mfma_f32_16x16x32_bf16 v[68:71], v[24:27], v[180:183], v[68:71]
  v_and_b32 v163, 7, v147
  s_waitcnt lgkmcnt(4)
  v_mfma_f32_16x16x32_bf16 v[88:91], v[28:31], v[176:179], v[88:91]
  ds_read_b64_tr_b16 v[24:25], v9 offset:33792
  ds_read_b64_tr_b16 v[26:27], v9 offset:34048
  v_mfma_f32_16x16x32_bf16 v[92:95], v[28:31], v[180:183], v[92:95]
  v_xor_b32_e64 v162, v162, v163
  v_mfma_f32_16x16x32_bf16 v[104:107], v[12:15], v[176:179], v[104:107]
  ds_read_b64_tr_b16 v[28:29], v10 offset:33792
  ds_read_b64_tr_b16 v[30:31], v10 offset:34048
  v_mfma_f32_16x16x32_bf16 v[108:111], v[12:15], v[180:183], v[108:111]
  v_lshlrev_b32 v162, 4, v162
  s_waitcnt lgkmcnt(4)
  v_mfma_f32_16x16x32_bf16 v[120:123], v[16:19], v[176:179], v[120:123]
  ds_read_b64_tr_b16 v[12:13], v9 offset:40960
  ds_read_b64_tr_b16 v[14:15], v9 offset:41216
  v_mfma_f32_16x16x32_bf16 v[124:127], v[16:19], v[180:183], v[124:127]
  v_lshrrev_b32_e64 v163, 3, v147
  v_mfma_f32_16x16x32_bf16 v[40:43], v[20:23], v[176:179], v[40:43]
  ds_read_b64_tr_b16 v[16:17], v10 offset:40960
  ds_read_b64_tr_b16 v[18:19], v10 offset:41216
  v_mfma_f32_16x16x32_bf16 v[44:47], v[20:23], v[180:183], v[44:47]
  v_lshl_add_u32 v148, v163, 10, v162
  s_waitcnt lgkmcnt(4)
  v_mfma_f32_16x16x32_bf16 v[56:59], v[24:27], v[176:179], v[56:59]
  ds_read_b64_tr_b16 v[20:21], v9 offset:41984
  ds_read_b64_tr_b16 v[22:23], v9 offset:42240
  v_mfma_f32_16x16x32_bf16 v[60:63], v[24:27], v[180:183], v[60:63]
  v_mfma_f32_16x16x32_bf16 v[72:75], v[28:31], v[176:179], v[72:75]
  ds_read_b64_tr_b16 v[24:25], v10 offset:41984
  ds_read_b64_tr_b16 v[26:27], v10 offset:42240
  v_mfma_f32_16x16x32_bf16 v[76:79], v[28:31], v[180:183], v[76:79]
  v_add_u32_e64 v148, s99, v148
  s_waitcnt lgkmcnt(4)
  v_mfma_f32_16x16x32_bf16 v[80:83], v[12:15], v[184:187], v[80:83]
  ds_read_b64_tr_b16 v[28:29], v9 offset:43008
  ds_read_b64_tr_b16 v[30:31], v9 offset:43264
  v_mfma_f32_16x16x32_bf16 v[84:87], v[12:15], v[188:191], v[84:87]
  v_add_u32 v149, 8192, v148
  v_mfma_f32_16x16x32_bf16 v[96:99], v[16:19], v[184:187], v[96:99]
  ds_read_b64_tr_b16 v[12:13], v10 offset:43008
  ds_read_b64_tr_b16 v[14:15], v10 offset:43264
  v_mfma_f32_16x16x32_bf16 v[100:103], v[16:19], v[188:191], v[100:103]
  v_lshrrev_b32 v163, 5, v147
  s_waitcnt lgkmcnt(4)
  v_mfma_f32_16x16x32_bf16 v[112:115], v[20:23], v[184:187], v[112:115]
  ds_read_b64_tr_b16 v[16:17], v9 offset:44032
  ds_read_b64_tr_b16 v[18:19], v9 offset:44288
  v_mfma_f32_16x16x32_bf16 v[116:119], v[20:23], v[188:191], v[116:119]
  v_lshl_add_u32 v158, v163, 12, v148
  v_mfma_f32_16x16x32_bf16 v[32:35], v[24:27], v[184:187], v[32:35]
  ds_read_b64_tr_b16 v[20:21], v10 offset:44032
  ds_read_b64_tr_b16 v[22:23], v10 offset:44288
  v_mfma_f32_16x16x32_bf16 v[36:39], v[24:27], v[188:191], v[36:39]
  v_add_u32 v159, 4096, v158
  s_waitcnt lgkmcnt(4)
  v_mfma_f32_16x16x32_bf16 v[48:51], v[28:31], v[184:187], v[48:51]
  ds_read_b64_tr_b16 v[24:25], v9 offset:45056
  ds_read_b64_tr_b16 v[26:27], v9 offset:45312
  v_mfma_f32_16x16x32_bf16 v[52:55], v[28:31], v[188:191], v[52:55]
  v_lshrrev_b32 v162, 5, v147
  v_mfma_f32_16x16x32_bf16 v[64:67], v[12:15], v[184:187], v[64:67]
  ds_read_b64_tr_b16 v[28:29], v10 offset:45056
  ds_read_b64_tr_b16 v[30:31], v10 offset:45312
  v_mfma_f32_16x16x32_bf16 v[68:71], v[12:15], v[188:191], v[68:71]
  v_bfe_u32 v163, v147, 2, 2
  s_waitcnt lgkmcnt(4)
  v_mfma_f32_16x16x32_bf16 v[88:91], v[16:19], v[184:187], v[88:91]
  ds_read_b64_tr_b16 v[12:13], v9 offset:46080
  ds_read_b64_tr_b16 v[14:15], v9 offset:46336
  v_mfma_f32_16x16x32_bf16 v[92:95], v[16:19], v[188:191], v[92:95]
  v_mfma_f32_16x16x32_bf16 v[104:107], v[20:23], v[184:187], v[104:107]
  ds_read_b64_tr_b16 v[16:17], v10 offset:46080
  ds_read_b64_tr_b16 v[18:19], v10 offset:46336
  v_mfma_f32_16x16x32_bf16 v[108:111], v[20:23], v[188:191], v[108:111]
  v_lshl_add_u32 v162, v162, 2, v163
  s_waitcnt lgkmcnt(4)
  v_mfma_f32_16x16x32_bf16 v[120:123], v[24:27], v[184:187], v[120:123]
  s_barrier
  ds_read_b64_tr_b16 v[20:21], v7 offset:0
  v_mfma_f32_16x16x32_bf16 v[124:127], v[24:27], v[188:191], v[124:127]
  ds_read_b64_tr_b16 v[22:23], v7 offset:256
  v_lshlrev_b32 v150, 7, v162
  v_mfma_f32_16x16x32_bf16 v[40:43], v[28:31], v[184:187], v[40:43]
  ds_read_b64_tr_b16 v[24:25], v8 offset:0
  ds_read_b64_tr_b16 v[26:27], v8 offset:256
  v_mfma_f32_16x16x32_bf16 v[44:47], v[28:31], v[188:191], v[44:47]
  v_bfe_u32 v162, v147, 3, 1
  s_waitcnt lgkmcnt(4)
  v_mfma_f32_16x16x32_bf16 v[56:59], v[12:15], v[184:187], v[56:59]
  ds_read_b64_tr_b16 v[28:29], v7 offset:1024
  ds_read_b64_tr_b16 v[30:31], v7 offset:1280
  v_mfma_f32_16x16x32_bf16 v[60:63], v[12:15], v[188:191], v[60:63]
  v_lshl_add_u32 v150, v162, 6, v150
  v_mfma_f32_16x16x32_bf16 v[72:75], v[16:19], v[184:187], v[72:75]
  ds_read_b64_tr_b16 v[12:13], v8 offset:1024
  ds_read_b64_tr_b16 v[14:15], v8 offset:1280
  v_mfma_f32_16x16x32_bf16 v[76:79], v[16:19], v[188:191], v[76:79]
  v_bfe_u32 v162, v147, 4, 1
  s_waitcnt lgkmcnt(4)
  v_mfma_f32_16x16x32_bf16 v[80:83], v[20:23], v[192:195], v[80:83]
  ds_read_b64_tr_b16 v[16:17], v7 offset:2048
  ds_read_b64_tr_b16 v[18:19], v7 offset:2304
  v_mfma_f32_16x16x32_bf16 v[84:87], v[20:23], v[196:199], v[84:87]
  v_lshl_add_u32 v150, v162, 5, v150
  v_mfma_f32_16x16x32_bf16 v[96:99], v[24:27], v[192:195], v[96:99]
  ds_read_b64_tr_b16 v[20:21], v8 offset:2048
  ds_read_b64_tr_b16 v[22:23], v8 offset:2304
  v_mfma_f32_16x16x32_bf16 v[100:103], v[24:27], v[196:199], v[100:103]
  v_and_b32 v162, 3, v147
  s_waitcnt lgkmcnt(4)
  v_mfma_f32_16x16x32_bf16 v[112:115], v[28:31], v[192:195], v[112:115]
  ds_read_b64_tr_b16 v[24:25], v7 offset:3072
  ds_read_b64_tr_b16 v[26:27], v7 offset:3328
  v_mfma_f32_16x16x32_bf16 v[116:119], v[28:31], v[196:199], v[116:119]
  v_mfma_f32_16x16x32_bf16 v[32:35], v[12:15], v[192:195], v[32:35]
  ds_read_b64_tr_b16 v[28:29], v8 offset:3072
  ds_read_b64_tr_b16 v[30:31], v8 offset:3328
  v_mfma_f32_16x16x32_bf16 v[36:39], v[12:15], v[196:199], v[36:39]
  v_lshl_add_u32 v150, v162, 3, v150
  s_waitcnt lgkmcnt(4)
  v_mfma_f32_16x16x32_bf16 v[48:51], v[16:19], v[192:195], v[48:51]
  ds_read_b64_tr_b16 v[12:13], v7 offset:4096
  ds_read_b64_tr_b16 v[14:15], v7 offset:4352
  v_mfma_f32_16x16x32_bf16 v[52:55], v[16:19], v[196:199], v[52:55]
  v_add_u32 v150, s98, v150
  v_mfma_f32_16x16x32_bf16 v[64:67], v[20:23], v[192:195], v[64:67]
  ds_read_b64_tr_b16 v[16:17], v8 offset:4096
  ds_read_b64_tr_b16 v[18:19], v8 offset:4352
  v_mfma_f32_16x16x32_bf16 v[68:71], v[20:23], v[196:199], v[68:71]
  v_add_u32 v152, 65536, v150
  s_waitcnt lgkmcnt(4)
  v_mfma_f32_16x16x32_bf16 v[88:91], v[24:27], v[192:195], v[88:91]
  ds_read_b64_tr_b16 v[20:21], v7 offset:5120
  ds_read_b64_tr_b16 v[22:23], v7 offset:5376
  v_mfma_f32_16x16x32_bf16 v[92:95], v[24:27], v[196:199], v[92:95]
  v_add_u32 v154, 131072, v150
  v_mfma_f32_16x16x32_bf16 v[104:107], v[28:31], v[192:195], v[104:107]
  ds_read_b64_tr_b16 v[24:25], v8 offset:5120
  ds_read_b64_tr_b16 v[26:27], v8 offset:5376
  v_mfma_f32_16x16x32_bf16 v[108:111], v[28:31], v[196:199], v[108:111]
  v_xor_b32_e64 v151, 64, v150
  s_waitcnt lgkmcnt(4)
  v_mfma_f32_16x16x32_bf16 v[120:123], v[12:15], v[192:195], v[120:123]
  ds_read_b64_tr_b16 v[28:29], v7 offset:12288
  ds_read_b64_tr_b16 v[30:31], v7 offset:12544
  v_mfma_f32_16x16x32_bf16 v[124:127], v[12:15], v[196:199], v[124:127]
  v_xor_b32_e64 v153, 64, v152
  v_mfma_f32_16x16x32_bf16 v[40:43], v[16:19], v[192:195], v[40:43]
  ds_read_b64_tr_b16 v[12:13], v8 offset:12288
  ds_read_b64_tr_b16 v[14:15], v8 offset:12544
  v_mfma_f32_16x16x32_bf16 v[44:47], v[16:19], v[196:199], v[44:47]
  v_xor_b32 v155, 64, v154
  s_waitcnt lgkmcnt(4)
  v_mfma_f32_16x16x32_bf16 v[56:59], v[20:23], v[192:195], v[56:59]
  ds_read_b64_tr_b16 v[16:17], v7 offset:13312
  ds_read_b64_tr_b16 v[18:19], v7 offset:13568
  v_mfma_f32_16x16x32_bf16 v[60:63], v[20:23], v[196:199], v[60:63]
  s_mul_i32 s50, s53, 176128
  v_mfma_f32_16x16x32_bf16 v[72:75], v[24:27], v[192:195], v[72:75]
  ds_read_b64_tr_b16 v[20:21], v8 offset:13312
  ds_read_b64_tr_b16 v[22:23], v8 offset:13568
  v_mfma_f32_16x16x32_bf16 v[76:79], v[24:27], v[196:199], v[76:79]
  s_waitcnt lgkmcnt(4)
  v_mfma_f32_16x16x32_bf16 v[80:83], v[28:31], v[200:203], v[80:83]
  ds_read_b64_tr_b16 v[24:25], v7 offset:14336
  ds_read_b64_tr_b16 v[26:27], v7 offset:14592
  v_mfma_f32_16x16x32_bf16 v[84:87], v[28:31], v[204:207], v[84:87]
  s_add_u32 s50, s50, s98
  v_mfma_f32_16x16x32_bf16 v[96:99], v[12:15], v[200:203], v[96:99]
  ds_read_b64_tr_b16 v[28:29], v8 offset:14336
  ds_read_b64_tr_b16 v[30:31], v8 offset:14592
  v_mfma_f32_16x16x32_bf16 v[100:103], v[12:15], v[204:207], v[100:103]
  s_add_u32 s50, s50, 6291456
  s_waitcnt lgkmcnt(4)
  v_mfma_f32_16x16x32_bf16 v[112:115], v[16:19], v[200:203], v[112:115]
  ds_read_b64_tr_b16 v[12:13], v7 offset:15360
  ds_read_b64_tr_b16 v[14:15], v7 offset:15616
  v_mfma_f32_16x16x32_bf16 v[116:119], v[16:19], v[204:207], v[116:119]
  v_add_u32 v156, s50, v0
  v_mfma_f32_16x16x32_bf16 v[32:35], v[20:23], v[200:203], v[32:35]
  ds_read_b64_tr_b16 v[16:17], v8 offset:15360
  ds_read_b64_tr_b16 v[18:19], v8 offset:15616
  v_mfma_f32_16x16x32_bf16 v[36:39], v[20:23], v[204:207], v[36:39]
  v_add_u32 v157, 88064, v156
  s_waitcnt lgkmcnt(4)
  v_mfma_f32_16x16x32_bf16 v[48:51], v[24:27], v[200:203], v[48:51]
  ds_read_b64_tr_b16 v[20:21], v7 offset:16384
  ds_read_b64_tr_b16 v[22:23], v7 offset:16640
  v_mfma_f32_16x16x32_bf16 v[52:55], v[24:27], v[204:207], v[52:55]
  s_lshl_b32 s50, s46, 2
  v_mfma_f32_16x16x32_bf16 v[64:67], v[28:31], v[200:203], v[64:67]
  ds_read_b64_tr_b16 v[24:25], v8 offset:16384
  ds_read_b64_tr_b16 v[26:27], v8 offset:16640
  v_mfma_f32_16x16x32_bf16 v[68:71], v[28:31], v[204:207], v[68:71]
  s_add_u32 s50, s50, s45
  s_waitcnt lgkmcnt(4)
  v_mfma_f32_16x16x32_bf16 v[88:91], v[12:15], v[200:203], v[88:91]
  ds_read_b64_tr_b16 v[28:29], v7 offset:17408
  ds_read_b64_tr_b16 v[30:31], v7 offset:17664
  v_mfma_f32_16x16x32_bf16 v[92:95], v[12:15], v[204:207], v[92:95]
  s_mul_i32 s56, s50, 88064
  v_mfma_f32_16x16x32_bf16 v[104:107], v[16:19], v[200:203], v[104:107]
  ds_read_b64_tr_b16 v[12:13], v8 offset:17408
  ds_read_b64_tr_b16 v[14:15], v8 offset:17664
  v_mfma_f32_16x16x32_bf16 v[108:111], v[16:19], v[204:207], v[108:111]
  s_waitcnt lgkmcnt(4)
  v_mfma_f32_16x16x32_bf16 v[120:123], v[20:23], v[200:203], v[120:123]
  s_barrier
  ds_read_b64_tr_b16 v[16:17], v7 offset:28672
  v_mfma_f32_16x16x32_bf16 v[124:127], v[20:23], v[204:207], v[124:127]
  ds_read_b64_tr_b16 v[18:19], v7 offset:28928
  s_lshl_b32 s50, s48, 11
  v_mfma_f32_16x16x32_bf16 v[40:43], v[24:27], v[200:203], v[40:43]
  ds_read_b64_tr_b16 v[20:21], v8 offset:28672
  ds_read_b64_tr_b16 v[22:23], v8 offset:28928
  v_mfma_f32_16x16x32_bf16 v[44:47], v[24:27], v[204:207], v[44:47]
  s_add_u32 s56, s56, s50
  s_waitcnt lgkmcnt(4)
  v_mfma_f32_16x16x32_bf16 v[56:59], v[28:31], v[200:203], v[56:59]
  ds_read_b64_tr_b16 v[24:25], v7 offset:29696
  ds_read_b64_tr_b16 v[26:27], v7 offset:29952
  v_mfma_f32_16x16x32_bf16 v[60:63], v[28:31], v[204:207], v[60:63]
  s_add_u32 s56, s56, 6291456
  v_mfma_f32_16x16x32_bf16 v[72:75], v[12:15], v[200:203], v[72:75]
  ds_read_b64_tr_b16 v[28:29], v8 offset:29696
  ds_read_b64_tr_b16 v[30:31], v8 offset:29952
  v_mfma_f32_16x16x32_bf16 v[76:79], v[12:15], v[204:207], v[76:79]
  s_add_u32 s58, s56, 4096
  s_waitcnt lgkmcnt(4)
  v_mfma_f32_16x16x32_bf16 v[80:83], v[16:19], v[208:211], v[80:83]
  ds_read_b64_tr_b16 v[12:13], v7 offset:30720
  ds_read_b64_tr_b16 v[14:15], v7 offset:30976
  v_mfma_f32_16x16x32_bf16 v[84:87], v[16:19], v[212:215], v[84:87]
  s_mov_b32 s55, 0xbfb8aa3b
  v_mfma_f32_16x16x32_bf16 v[96:99], v[20:23], v[208:211], v[96:99]
  ds_read_b64_tr_b16 v[16:17], v8 offset:30720
  ds_read_b64_tr_b16 v[18:19], v8 offset:30976
  v_mfma_f32_16x16x32_bf16 v[100:103], v[20:23], v[212:215], v[100:103]
  s_lshl_b32 s50, s45, 5
  s_waitcnt lgkmcnt(4)
  v_mfma_f32_16x16x32_bf16 v[112:115], v[24:27], v[208:211], v[112:115]
  ds_read_b64_tr_b16 v[20:21], v7 offset:31744
  ds_read_b64_tr_b16 v[22:23], v7 offset:32000
  v_mfma_f32_16x16x32_bf16 v[116:119], v[24:27], v[212:215], v[116:119]
  s_add_u32 s50, s50, s53
  v_mfma_f32_16x16x32_bf16 v[32:35], v[28:31], v[208:211], v[32:35]
  ds_read_b64_tr_b16 v[24:25], v8 offset:31744
  ds_read_b64_tr_b16 v[26:27], v8 offset:32000
  v_mfma_f32_16x16x32_bf16 v[36:39], v[28:31], v[212:215], v[36:39]
  s_waitcnt lgkmcnt(4)
  v_mfma_f32_16x16x32_bf16 v[48:51], v[12:15], v[208:211], v[48:51]
  ds_read_b64_tr_b16 v[28:29], v7 offset:32768
  ds_read_b64_tr_b16 v[30:31], v7 offset:33024
  v_mfma_f32_16x16x32_bf16 v[52:55], v[12:15], v[212:215], v[52:55]
  s_lshl_b32 s50, s50, 11
  v_mfma_f32_16x16x32_bf16 v[64:67], v[16:19], v[208:211], v[64:67]
  ds_read_b64_tr_b16 v[12:13], v8 offset:32768
  ds_read_b64_tr_b16 v[14:15], v8 offset:33024
  v_mfma_f32_16x16x32_bf16 v[68:71], v[16:19], v[212:215], v[68:71]
  v_add_u32_e64 v160, s50, v0
  s_waitcnt lgkmcnt(4)
  v_mfma_f32_16x16x32_bf16 v[88:91], v[20:23], v[208:211], v[88:91]
  ds_read_b64_tr_b16 v[16:17], v7 offset:33792
  ds_read_b64_tr_b16 v[18:19], v7 offset:34048
  v_mfma_f32_16x16x32_bf16 v[92:95], v[20:23], v[212:215], v[92:95]
  v_mov_b32_e64 v1, 1
  v_mfma_f32_16x16x32_bf16 v[104:107], v[24:27], v[208:211], v[104:107]
  ds_read_b64_tr_b16 v[20:21], v8 offset:33792
  ds_read_b64_tr_b16 v[22:23], v8 offset:34048
  v_mfma_f32_16x16x32_bf16 v[108:111], v[24:27], v[212:215], v[108:111]
  v_and_b32 v162, 31, v147
  s_waitcnt lgkmcnt(4)
  v_mfma_f32_16x16x32_bf16 v[120:123], v[28:31], v[208:211], v[120:123]
  ds_read_b64_tr_b16 v[24:25], v7 offset:40960
  ds_read_b64_tr_b16 v[26:27], v7 offset:41216
  v_mfma_f32_16x16x32_bf16 v[124:127], v[28:31], v[212:215], v[124:127]
  v_lshlrev_b32_e64 v146, 2, v162
  v_mfma_f32_16x16x32_bf16 v[40:43], v[12:15], v[208:211], v[40:43]
  ds_read_b64_tr_b16 v[28:29], v8 offset:40960
  ds_read_b64_tr_b16 v[30:31], v8 offset:41216
  v_mfma_f32_16x16x32_bf16 v[44:47], v[12:15], v[212:215], v[44:47]
  s_lshl_b32 s61, s53, 7
  s_waitcnt lgkmcnt(4)
  v_mfma_f32_16x16x32_bf16 v[56:59], v[16:19], v[208:211], v[56:59]
  ds_read_b64_tr_b16 v[12:13], v7 offset:41984
  ds_read_b64_tr_b16 v[14:15], v7 offset:42240
  v_mfma_f32_16x16x32_bf16 v[60:63], v[16:19], v[212:215], v[60:63]
  s_add_u32 s61, s61, 14712832
  v_mfma_f32_16x16x32_bf16 v[72:75], v[20:23], v[208:211], v[72:75]
  ds_read_b64_tr_b16 v[16:17], v8 offset:41984
  ds_read_b64_tr_b16 v[18:19], v8 offset:42240
  v_mfma_f32_16x16x32_bf16 v[76:79], v[20:23], v[212:215], v[76:79]
  s_waitcnt lgkmcnt(4)
  v_mfma_f32_16x16x32_bf16 v[80:83], v[24:27], v[216:219], v[80:83]
  ds_read_b64_tr_b16 v[20:21], v7 offset:43008
  ds_read_b64_tr_b16 v[22:23], v7 offset:43264
  v_mfma_f32_16x16x32_bf16 v[84:87], v[24:27], v[220:223], v[84:87]
  v_mfma_f32_16x16x32_bf16 v[96:99], v[28:31], v[216:219], v[96:99]
  ds_read_b64_tr_b16 v[24:25], v8 offset:43008
  ds_read_b64_tr_b16 v[26:27], v8 offset:43264
  v_mfma_f32_16x16x32_bf16 v[100:103], v[28:31], v[220:223], v[100:103]
  s_waitcnt lgkmcnt(4)
  v_mfma_f32_16x16x32_bf16 v[112:115], v[12:15], v[216:219], v[112:115]
  ds_read_b64_tr_b16 v[28:29], v7 offset:44032
  ds_read_b64_tr_b16 v[30:31], v7 offset:44288
  v_mfma_f32_16x16x32_bf16 v[116:119], v[12:15], v[220:223], v[116:119]
  v_mfma_f32_16x16x32_bf16 v[32:35], v[16:19], v[216:219], v[32:35]
  ds_read_b64_tr_b16 v[12:13], v8 offset:44032
  ds_read_b64_tr_b16 v[14:15], v8 offset:44288
  v_mfma_f32_16x16x32_bf16 v[36:39], v[16:19], v[220:223], v[36:39]
  s_waitcnt lgkmcnt(4)
  v_mfma_f32_16x16x32_bf16 v[48:51], v[20:23], v[216:219], v[48:51]
  ds_read_b64_tr_b16 v[16:17], v7 offset:45056
  ds_read_b64_tr_b16 v[18:19], v7 offset:45312
  v_mfma_f32_16x16x32_bf16 v[52:55], v[20:23], v[220:223], v[52:55]
  v_mfma_f32_16x16x32_bf16 v[64:67], v[24:27], v[216:219], v[64:67]
  ds_read_b32 v2, v6 offset:4
  ds_read_b64_tr_b16 v[20:21], v8 offset:45056
  v_mfma_f32_16x16x32_bf16 v[68:71], v[24:27], v[220:223], v[68:71]
  ds_read_b64_tr_b16 v[22:23], v8 offset:45312
  s_waitcnt lgkmcnt(5)
  v_mfma_f32_16x16x32_bf16 v[88:91], v[28:31], v[216:219], v[88:91]
  ds_read_b64_tr_b16 v[24:25], v7 offset:46080
  ds_read_b64_tr_b16 v[26:27], v7 offset:46336
  v_mfma_f32_16x16x32_bf16 v[92:95], v[28:31], v[220:223], v[92:95]
  v_mfma_f32_16x16x32_bf16 v[104:107], v[12:15], v[216:219], v[104:107]
  ds_read_b64_tr_b16 v[28:29], v8 offset:46080
  ds_read_b64_tr_b16 v[30:31], v8 offset:46336
  v_mfma_f32_16x16x32_bf16 v[108:111], v[12:15], v[220:223], v[108:111]
  s_waitcnt lgkmcnt(4)
  v_mfma_f32_16x16x32_bf16 v[120:123], v[16:19], v[216:219], v[120:123]
  v_cmp_ne_u32 vcc, 4, v2
  v_mfma_f32_16x16x32_bf16 v[124:127], v[16:19], v[220:223], v[124:127]
  s_cbranch_vccnz G_W14
G_R14:
  ds_read_b64_tr_b16 v[12:13], v9 offset:0
  ds_read_b64_tr_b16 v[14:15], v9 offset:256
  v_mfma_f32_16x16x32_bf16 v[40:43], v[20:23], v[216:219], v[40:43]
  ds_read_b64_tr_b16 v[16:17], v10 offset:0
  ds_read_b64_tr_b16 v[18:19], v10 offset:256
  v_mfma_f32_16x16x32_bf16 v[44:47], v[20:23], v[220:223], v[44:47]
  s_waitcnt lgkmcnt(4)
  v_mfma_f32_16x16x32_bf16 v[56:59], v[24:27], v[216:219], v[56:59]
  ds_read_b64_tr_b16 v[20:21], v9 offset:1024
  ds_read_b64_tr_b16 v[22:23], v9 offset:1280
  v_mfma_f32_16x16x32_bf16 v[60:63], v[24:27], v[220:223], v[60:63]
  v_mfma_f32_16x16x32_bf16 v[72:75], v[28:31], v[216:219], v[72:75]
  ds_read_b64_tr_b16 v[24:25], v10 offset:1024
  ds_read_b64_tr_b16 v[26:27], v10 offset:1280
  v_mfma_f32_16x16x32_bf16 v[76:79], v[28:31], v[220:223], v[76:79]
  s_waitcnt lgkmcnt(4)
  v_mfma_f32_16x16x32_bf16 v[80:83], v[12:15], v[224:227], v[80:83]
  ds_read_b64_tr_b16 v[28:29], v9 offset:2048
  ds_read_b64_tr_b16 v[30:31], v9 offset:2304
  v_mfma_f32_16x16x32_bf16 v[84:87], v[12:15], v[228:231], v[84:87]
  ds_read_b64_tr_b16 v[164:165], v152 offset:49152
  ds_read_b64_tr_b16 v[166:167], v152 offset:53248
  v_mfma_f32_16x16x32_bf16 v[96:99], v[16:19], v[224:227], v[96:99]
  ds_read_b64_tr_b16 v[12:13], v10 offset:2048
  ds_read_b64_tr_b16 v[14:15], v10 offset:2304
  v_mfma_f32_16x16x32_bf16 v[100:103], v[16:19], v[228:231], v[100:103]
  ds_read_b64_tr_b16 v[168:169], v153 offset:49152
  ds_read_b64_tr_b16 v[170:171], v153 offset:53248
  s_waitcnt lgkmcnt(8)
  v_mfma_f32_16x16x32_bf16 v[112:115], v[20:23], v[224:227], v[112:115]
  ds_read_b64_tr_b16 v[16:17], v9 offset:3072
  ds_read_b64_tr_b16 v[18:19], v9 offset:3328
  v_mfma_f32_16x16x32_bf16 v[116:119], v[20:23], v[228:231], v[116:119]
  ds_read_b64_tr_b16 v[172:173], v152 offset:57344
  ds_read_b64_tr_b16 v[174:175], v152 offset:61440
  v_mfma_f32_16x16x32_bf16 v[32:35], v[24:27], v[224:227], v[32:35]
  ds_read_b64_tr_b16 v[20:21], v10 offset:3072
  ds_read_b64_tr_b16 v[22:23], v10 offset:3328
  v_mfma_f32_16x16x32_bf16 v[36:39], v[24:27], v[228:231], v[36:39]
  ds_read_b64_tr_b16 v[176:177], v153 offset:57344
  ds_read_b64_tr_b16 v[178:179], v153 offset:61440
  s_waitcnt lgkmcnt(10)
  v_mfma_f32_16x16x32_bf16 v[48:51], v[28:31], v[224:227], v[48:51]
  ds_read_b64_tr_b16 v[24:25], v9 offset:4096
  ds_read_b64_tr_b16 v[26:27], v9 offset:4352
  v_mfma_f32_16x16x32_bf16 v[52:55], v[28:31], v[228:231], v[52:55]
  ds_read_b64_tr_b16 v[180:181], v154 offset:0
  ds_read_b64_tr_b16 v[182:183], v154 offset:4096
  v_mfma_f32_16x16x32_bf16 v[64:67], v[12:15], v[224:227], v[64:67]
  ds_read_b64_tr_b16 v[28:29], v10 offset:4096
  ds_read_b64_tr_b16 v[30:31], v10 offset:4352
  v_mfma_f32_16x16x32_bf16 v[68:71], v[12:15], v[228:231], v[68:71]
  ds_read_b64_tr_b16 v[184:185], v155 offset:0
  ds_read_b64_tr_b16 v[186:187], v155 offset:4096
  s_waitcnt lgkmcnt(10)
  v_mfma_f32_16x16x32_bf16 v[88:91], v[16:19], v[224:227], v[88:91]
  ds_read_b64_tr_b16 v[12:13], v9 offset:5120
  ds_read_b64_tr_b16 v[14:15], v9 offset:5376
  v_mfma_f32_16x16x32_bf16 v[92:95], v[16:19], v[228:231], v[92:95]
  ds_read_b64_tr_b16 v[188:189], v154 offset:8192
  ds_read_b64_tr_b16 v[190:191], v154 offset:12288
  v_mfma_f32_16x16x32_bf16 v[104:107], v[20:23], v[224:227], v[104:107]
  ds_read_b64_tr_b16 v[16:17], v10 offset:5120
  ds_read_b64_tr_b16 v[18:19], v10 offset:5376
  v_mfma_f32_16x16x32_bf16 v[108:111], v[20:23], v[228:231], v[108:111]
  ds_read_b64_tr_b16 v[192:193], v155 offset:8192
  ds_read_b64_tr_b16 v[194:195], v155 offset:12288
  s_waitcnt lgkmcnt(10)
  v_mfma_f32_16x16x32_bf16 v[120:123], v[24:27], v[224:227], v[120:123]
  ds_read_b64_tr_b16 v[20:21], v9 offset:12288
  ds_read_b64_tr_b16 v[22:23], v9 offset:12544
  v_mfma_f32_16x16x32_bf16 v[124:127], v[24:27], v[228:231], v[124:127]
  ds_read_b64_tr_b16 v[196:197], v154 offset:16384
  ds_read_b64_tr_b16 v[198:199], v154 offset:20480
  v_mfma_f32_16x16x32_bf16 v[40:43], v[28:31], v[224:227], v[40:43]
  ds_read_b64_tr_b16 v[24:25], v10 offset:12288
  ds_read_b64_tr_b16 v[26:27], v10 offset:12544
  v_mfma_f32_16x16x32_bf16 v[44:47], v[28:31], v[228:231], v[44:47]
  ds_read_b64_tr_b16 v[200:201], v155 offset:16384
  ds_read_b64_tr_b16 v[202:203], v155 offset:20480
  s_waitcnt lgkmcnt(10)
  v_mfma_f32_16x16x32_bf16 v[56:59], v[12:15], v[224:227], v[56:59]
  ds_read_b64_tr_b16 v[28:29], v9 offset:13312
  ds_read_b64_tr_b16 v[30:31], v9 offset:13568
  v_mfma_f32_16x16x32_bf16 v[60:63], v[12:15], v[228:231], v[60:63]
  s_mov_b64 exec, 1
  ds_add_u32 v6, v1 offset:8
  s_mov_b64 exec, -1
  v_mfma_f32_16x16x32_bf16 v[72:75], v[16:19], v[224:227], v[72:75]
  ds_read_b64_tr_b16 v[12:13], v10 offset:13312
  ds_read_b64_tr_b16 v[14:15], v10 offset:13568
  v_mfma_f32_16x16x32_bf16 v[76:79], v[16:19], v[228:231], v[76:79]
  s_waitcnt lgkmcnt(7)
  v_mfma_f32_16x16x32_bf16 v[80:83], v[20:23], v[232:235], v[80:83]
  ds_read_b64_tr_b16 v[16:17], v9 offset:14336
  ds_read_b64_tr_b16 v[18:19], v9 offset:14592
  v_mfma_f32_16x16x32_bf16 v[84:87], v[20:23], v[236:239], v[84:87]
  v_mfma_f32_16x16x32_bf16 v[96:99], v[24:27], v[232:235], v[96:99]
  ds_read_b64_tr_b16 v[20:21], v10 offset:14336
  ds_read_b64_tr_b16 v[22:23], v10 offset:14592
  v_mfma_f32_16x16x32_bf16 v[100:103], v[24:27], v[236:239], v[100:103]
  s_waitcnt lgkmcnt(4)
  v_mfma_f32_16x16x32_bf16 v[112:115], v[28:31], v[232:235], v[112:115]
  ds_read_b64_tr_b16 v[24:25], v9 offset:15360
  ds_read_b64_tr_b16 v[26:27], v9 offset:15616
  v_mfma_f32_16x16x32_bf16 v[116:119], v[28:31], v[236:239], v[116:119]
  v_mfma_f32_16x16x32_bf16 v[32:35], v[12:15], v[232:235], v[32:35]
  ds_read_b64_tr_b16 v[28:29], v10 offset:15360
  ds_read_b64_tr_b16 v[30:31], v10 offset:15616
  v_mfma_f32_16x16x32_bf16 v[36:39], v[12:15], v[236:239], v[36:39]
  s_waitcnt lgkmcnt(4)
  v_mfma_f32_16x16x32_bf16 v[48:51], v[16:19], v[232:235], v[48:51]
  ds_read_b64_tr_b16 v[12:13], v9 offset:16384
  ds_read_b64_tr_b16 v[14:15], v9 offset:16640
  v_mfma_f32_16x16x32_bf16 v[52:55], v[16:19], v[236:239], v[52:55]
  v_mfma_f32_16x16x32_bf16 v[64:67], v[20:23], v[232:235], v[64:67]
  ds_read_b32 v2, v6 offset:36
  ds_read_b64_tr_b16 v[16:17], v10 offset:16384
  v_mfma_f32_16x16x32_bf16 v[68:71], v[20:23], v[236:239], v[68:71]
  ds_read_b64_tr_b16 v[18:19], v10 offset:16640
  s_waitcnt lgkmcnt(5)
  v_mfma_f32_16x16x32_bf16 v[88:91], v[24:27], v[232:235], v[88:91]
  ds_read_b64_tr_b16 v[20:21], v9 offset:17408
  ds_read_b64_tr_b16 v[22:23], v9 offset:17664
  v_mfma_f32_16x16x32_bf16 v[92:95], v[24:27], v[236:239], v[92:95]
  v_mfma_f32_16x16x32_bf16 v[104:107], v[28:31], v[232:235], v[104:107]
  ds_read_b64_tr_b16 v[24:25], v10 offset:17408
  ds_read_b64_tr_b16 v[26:27], v10 offset:17664
  v_mfma_f32_16x16x32_bf16 v[108:111], v[28:31], v[236:239], v[108:111]
  s_waitcnt lgkmcnt(4)
  v_mfma_f32_16x16x32_bf16 v[120:123], v[12:15], v[232:235], v[120:123]
  v_cmp_ne_u32 vcc, 4, v2
  v_mfma_f32_16x16x32_bf16 v[124:127], v[12:15], v[236:239], v[124:127]
  s_cbranch_vccnz G_W15
G_R15:
  ds_read_b64_tr_b16 v[28:29], v9 offset:28672
  ds_read_b64_tr_b16 v[30:31], v9 offset:28928
  v_mfma_f32_16x16x32_bf16 v[40:43], v[16:19], v[232:235], v[40:43]
  ds_read_b64_tr_b16 v[12:13], v10 offset:28672
  ds_read_b64_tr_b16 v[14:15], v10 offset:28928
  v_mfma_f32_16x16x32_bf16 v[44:47], v[16:19], v[236:239], v[44:47]
  s_waitcnt lgkmcnt(4)
  v_mfma_f32_16x16x32_bf16 v[56:59], v[20:23], v[232:235], v[56:59]
  ds_read_b64_tr_b16 v[16:17], v9 offset:29696
  ds_read_b64_tr_b16 v[18:19], v9 offset:29952
  v_mfma_f32_16x16x32_bf16 v[60:63], v[20:23], v[236:239], v[60:63]
  v_mfma_f32_16x16x32_bf16 v[72:75], v[24:27], v[232:235], v[72:75]
  ds_read_b64_tr_b16 v[20:21], v10 offset:29696
  ds_read_b64_tr_b16 v[22:23], v10 offset:29952
  v_mfma_f32_16x16x32_bf16 v[76:79], v[24:27], v[236:239], v[76:79]
  s_waitcnt lgkmcnt(4)
  v_mfma_f32_16x16x32_bf16 v[80:83], v[28:31], v[240:243], v[80:83]
  ds_read_b64_tr_b16 v[24:25], v9 offset:30720
  ds_read_b64_tr_b16 v[26:27], v9 offset:30976
  v_mfma_f32_16x16x32_bf16 v[84:87], v[28:31], v[244:247], v[84:87]
  v_mfma_f32_16x16x32_bf16 v[96:99], v[12:15], v[240:243], v[96:99]
  ds_read_b64_tr_b16 v[28:29], v10 offset:30720
  ds_read_b64_tr_b16 v[30:31], v10 offset:30976
  v_mfma_f32_16x16x32_bf16 v[100:103], v[12:15], v[244:247], v[100:103]
  s_waitcnt lgkmcnt(4)
  v_mfma_f32_16x16x32_bf16 v[112:115], v[16:19], v[240:243], v[112:115]
  ds_read_b64_tr_b16 v[12:13], v9 offset:31744
  ds_read_b64_tr_b16 v[14:15], v9 offset:32000
  v_mfma_f32_16x16x32_bf16 v[116:119], v[16:19], v[244:247], v[116:119]
  v_mfma_f32_16x16x32_bf16 v[32:35], v[20:23], v[240:243], v[32:35]
  ds_read_b64_tr_b16 v[16:17], v10 offset:31744
  ds_read_b64_tr_b16 v[18:19], v10 offset:32000
  v_mfma_f32_16x16x32_bf16 v[36:39], v[20:23], v[244:247], v[36:39]
  s_waitcnt lgkmcnt(4)
  v_mfma_f32_16x16x32_bf16 v[48:51], v[24:27], v[240:243], v[48:51]
  ds_read_b64_tr_b16 v[20:21], v9 offset:32768
  ds_read_b64_tr_b16 v[22:23], v9 offset:33024
  v_mfma_f32_16x16x32_bf16 v[52:55], v[24:27], v[244:247], v[52:55]
  v_mfma_f32_16x16x32_bf16 v[64:67], v[28:31], v[240:243], v[64:67]
  ds_read_b64_tr_b16 v[24:25], v10 offset:32768
  ds_read_b64_tr_b16 v[26:27], v10 offset:33024
  v_mfma_f32_16x16x32_bf16 v[68:71], v[28:31], v[244:247], v[68:71]
  s_waitcnt lgkmcnt(4)
  v_mfma_f32_16x16x32_bf16 v[88:91], v[12:15], v[240:243], v[88:91]
  ds_read_b64_tr_b16 v[28:29], v9 offset:33792
  ds_read_b64_tr_b16 v[30:31], v9 offset:34048
  v_mfma_f32_16x16x32_bf16 v[92:95], v[12:15], v[244:247], v[92:95]
  v_mfma_f32_16x16x32_bf16 v[104:107], v[16:19], v[240:243], v[104:107]
  ds_read_b64_tr_b16 v[12:13], v10 offset:33792
  ds_read_b64_tr_b16 v[14:15], v10 offset:34048
  v_mfma_f32_16x16x32_bf16 v[108:111], v[16:19], v[244:247], v[108:111]
  s_waitcnt lgkmcnt(4)
  v_mfma_f32_16x16x32_bf16 v[120:123], v[20:23], v[240:243], v[120:123]
  ds_read_b64_tr_b16 v[16:17], v9 offset:40960
  ds_read_b64_tr_b16 v[18:19], v9 offset:41216
  v_mfma_f32_16x16x32_bf16 v[124:127], v[20:23], v[244:247], v[124:127]
  v_mfma_f32_16x16x32_bf16 v[40:43], v[24:27], v[240:243], v[40:43]
  ds_read_b64_tr_b16 v[20:21], v10 offset:40960
  ds_read_b64_tr_b16 v[22:23], v10 offset:41216
  v_mfma_f32_16x16x32_bf16 v[44:47], v[24:27], v[244:247], v[44:47]
  s_waitcnt lgkmcnt(4)
  v_mfma_f32_16x16x32_bf16 v[56:59], v[28:31], v[240:243], v[56:59]
  ds_read_b64_tr_b16 v[24:25], v9 offset:41984
  ds_read_b64_tr_b16 v[26:27], v9 offset:42240
  v_mfma_f32_16x16x32_bf16 v[60:63], v[28:31], v[244:247], v[60:63]
  v_mfma_f32_16x16x32_bf16 v[72:75], v[12:15], v[240:243], v[72:75]
  ds_read_b64_tr_b16 v[28:29], v10 offset:41984
  ds_read_b64_tr_b16 v[30:31], v10 offset:42240
  v_mfma_f32_16x16x32_bf16 v[76:79], v[12:15], v[244:247], v[76:79]
  s_waitcnt lgkmcnt(4)
  v_mfma_f32_16x16x32_bf16 v[80:83], v[16:19], v[248:251], v[80:83]
  ds_read_b64_tr_b16 v[12:13], v9 offset:43008
  ds_read_b64_tr_b16 v[14:15], v9 offset:43264
  v_mfma_f32_16x16x32_bf16 v[84:87], v[16:19], v[252:255], v[84:87]
  v_mfma_f32_16x16x32_bf16 v[96:99], v[20:23], v[248:251], v[96:99]
  ds_read_b64_tr_b16 v[16:17], v10 offset:43008
  ds_read_b64_tr_b16 v[18:19], v10 offset:43264
  v_mfma_f32_16x16x32_bf16 v[100:103], v[20:23], v[252:255], v[100:103]
  s_waitcnt lgkmcnt(4)
  v_mfma_f32_16x16x32_bf16 v[112:115], v[24:27], v[248:251], v[112:115]
  ds_read_b64_tr_b16 v[20:21], v9 offset:44032
  ds_read_b64_tr_b16 v[22:23], v9 offset:44288
  v_mfma_f32_16x16x32_bf16 v[116:119], v[24:27], v[252:255], v[116:119]
  v_mfma_f32_16x16x32_bf16 v[32:35], v[28:31], v[248:251], v[32:35]
  ds_read_b64_tr_b16 v[24:25], v10 offset:44032
  ds_read_b64_tr_b16 v[26:27], v10 offset:44288
  v_mfma_f32_16x16x32_bf16 v[36:39], v[28:31], v[252:255], v[36:39]
  s_waitcnt lgkmcnt(4)
  v_mfma_f32_16x16x32_bf16 v[48:51], v[12:15], v[248:251], v[48:51]
  ds_read_b64_tr_b16 v[28:29], v9 offset:45056
  ds_read_b64_tr_b16 v[30:31], v9 offset:45312
  v_mfma_f32_16x16x32_bf16 v[52:55], v[12:15], v[252:255], v[52:55]
  v_mfma_f32_16x16x32_bf16 v[64:67], v[16:19], v[248:251], v[64:67]
  ds_read_b64_tr_b16 v[12:13], v10 offset:45056
  ds_read_b64_tr_b16 v[14:15], v10 offset:45312
  v_mfma_f32_16x16x32_bf16 v[68:71], v[16:19], v[252:255], v[68:71]
  s_waitcnt lgkmcnt(4)
  v_mfma_f32_16x16x32_bf16 v[88:91], v[20:23], v[248:251], v[88:91]
  ds_read_b64_tr_b16 v[16:17], v9 offset:46080
  ds_read_b64_tr_b16 v[18:19], v9 offset:46336
  v_mfma_f32_16x16x32_bf16 v[92:95], v[20:23], v[252:255], v[92:95]
  v_mfma_f32_16x16x32_bf16 v[104:107], v[24:27], v[248:251], v[104:107]
  ds_read_b64_tr_b16 v[20:21], v10 offset:46080
  ds_read_b64_tr_b16 v[22:23], v10 offset:46336
  v_mfma_f32_16x16x32_bf16 v[108:111], v[24:27], v[252:255], v[108:111]
  s_waitcnt lgkmcnt(4)
  v_mfma_f32_16x16x32_bf16 v[120:123], v[28:31], v[248:251], v[120:123]
  v_mfma_f32_16x16x32_bf16 v[124:127], v[28:31], v[252:255], v[124:127]
  s_mov_b64 exec, 1
  ds_add_u32 v6, v1 offset:0
  s_mov_b64 exec, -1
  v_mfma_f32_16x16x32_bf16 v[40:43], v[12:15], v[248:251], v[40:43]
  v_mfma_f32_16x16x32_bf16 v[44:47], v[12:15], v[252:255], v[44:47]
  s_waitcnt lgkmcnt(1)
  v_mfma_f32_16x16x32_bf16 v[56:59], v[16:19], v[248:251], v[56:59]
  v_mfma_f32_16x16x32_bf16 v[60:63], v[16:19], v[252:255], v[60:63]
  v_mfma_f32_16x16x32_bf16 v[72:75], v[20:23], v[248:251], v[72:75]
  v_mfma_f32_16x16x32_bf16 v[76:79], v[20:23], v[252:255], v[76:79]
  v_mov_b32 v132, s55
  v_mov_b32 v133, s55
  ds_read_b32 v2, v6 offset:48
  ds_read2_b32 v[134:135], v3 offset0:0 offset1:16
  v_pk_mul_f32 v[88:89], v[80:81], v[88:89]
  v_pk_mul_f32 v[90:91], v[82:83], v[90:91]
  v_pk_mul_f32 v[92:93], v[84:85], v[92:93]
  v_pk_mul_f32 v[94:95], v[86:87], v[94:95]
  v_pk_mul_f32 v[80:81], v[80:81], v[132:133]
  v_pk_mul_f32 v[82:83], v[82:83], v[132:133]
  v_pk_mul_f32 v[84:85], v[84:85], v[132:133]
  v_pk_mul_f32 v[86:87], v[86:87], v[132:133]
  v_exp_f32 v80, v80
  v_exp_f32 v81, v81
  v_exp_f32 v82, v82
  v_exp_f32 v83, v83
  v_exp_f32 v84, v84
  v_exp_f32 v85, v85
  v_exp_f32 v86, v86
  v_exp_f32 v87, v87
  s_waitcnt lgkmcnt(0)
  v_cmp_ne_u32 vcc, 4, v2
  s_cbranch_vccnz G_WG
G_RG:
  v_exp_f32 v134, v134
  v_exp_f32 v135, v135
  v_add_f32 v134, 1.0, v134
  v_add_f32_e64 v135, 1.0, v135
  v_min_f32 v128, 0x7e967699, v134
  v_min_f32 v129, 0x7e967699, v134
  v_min_f32 v130, 0x7e967699, v135
  v_min_f32 v131, 0x7e967699, v135
  v_pk_fma_f32 v[80:81], v[80:81], v[128:129], v[128:129]
  v_pk_fma_f32 v[82:83], v[82:83], v[128:129], v[128:129]
  v_pk_fma_f32 v[84:85], v[84:85], v[130:131], v[130:131]
  v_pk_fma_f32 v[86:87], v[86:87], v[130:131], v[130:131]
  v_rcp_f32 v80, v80
  v_rcp_f32 v81, v81
  v_rcp_f32 v82, v82
  v_rcp_f32 v83, v83
  v_rcp_f32 v84, v84
  v_rcp_f32 v85, v85
  v_rcp_f32 v86, v86
  v_rcp_f32 v87, v87
  v_pk_mul_f32 v[104:105], v[96:97], v[104:105]
  v_pk_mul_f32 v[106:107], v[98:99], v[106:107]
  v_pk_mul_f32 v[108:109], v[100:101], v[108:109]
  v_pk_mul_f32 v[110:111], v[102:103], v[110:111]
  v_pk_mul_f32 v[96:97], v[96:97], v[132:133]
  v_pk_mul_f32 v[98:99], v[98:99], v[132:133]
  v_pk_mul_f32 v[100:101], v[100:101], v[132:133]
  v_pk_mul_f32 v[102:103], v[102:103], v[132:133]
  v_exp_f32 v96, v96
  v_exp_f32 v97, v97
  v_exp_f32 v98, v98
  v_exp_f32 v99, v99
  v_exp_f32 v100, v100
  v_exp_f32 v101, v101
  v_exp_f32 v102, v102
  v_exp_f32 v103, v103
  v_pk_fma_f32 v[96:97], v[96:97], v[128:129], v[128:129]
  v_pk_fma_f32 v[98:99], v[98:99], v[128:129], v[128:129]
  v_pk_fma_f32 v[100:101], v[100:101], v[130:131], v[130:131]
  v_pk_fma_f32 v[102:103], v[102:103], v[130:131], v[130:131]
  v_rcp_f32 v96, v96
  v_rcp_f32 v97, v97
  v_rcp_f32 v98, v98
  v_rcp_f32 v99, v99
  v_rcp_f32 v100, v100
  v_rcp_f32 v101, v101
  v_rcp_f32 v102, v102
  v_rcp_f32 v103, v103
  v_pk_mul_f32 v[80:81], v[80:81], v[88:89]
  v_pk_mul_f32 v[82:83], v[82:83], v[90:91]
  v_pk_mul_f32 v[84:85], v[84:85], v[92:93]
  v_pk_mul_f32 v[86:87], v[86:87], v[94:95]
  v_cvt_pk_bf16_f32 v88, v80, v81
  v_cvt_pk_bf16_f32 v90, v84, v85
  v_cvt_pk_bf16_f32 v89, v82, v83
  v_cvt_pk_bf16_f32 v91, v86, v87
  v_permlane16_swap_b32 v88, v90
  s_nop 0
  v_permlane16_swap_b32 v89, v91
  buffer_store_dwordx4 v[88:91], v0, s[4:7], s56 offen offset:0 sc1
  v_pk_mul_f32 v[120:121], v[112:113], v[120:121]
  v_pk_mul_f32 v[122:123], v[114:115], v[122:123]
  v_pk_mul_f32 v[124:125], v[116:117], v[124:125]
  v_pk_mul_f32 v[126:127], v[118:119], v[126:127]
  v_pk_mul_f32 v[112:113], v[112:113], v[132:133]
  v_pk_mul_f32 v[114:115], v[114:115], v[132:133]
  v_pk_mul_f32 v[116:117], v[116:117], v[132:133]
  v_pk_mul_f32 v[118:119], v[118:119], v[132:133]
  v_exp_f32 v112, v112
  v_exp_f32 v113, v113
  v_exp_f32 v114, v114
  v_exp_f32 v115, v115
  v_exp_f32 v116, v116
  v_exp_f32 v117, v117
  v_exp_f32 v118, v118
  v_exp_f32_e64 v119, v119
  v_pk_fma_f32 v[112:113], v[112:113], v[128:129], v[128:129]
  v_pk_fma_f32 v[114:115], v[114:115], v[128:129], v[128:129]
  v_pk_fma_f32 v[116:117], v[116:117], v[130:131], v[130:131]
  v_pk_fma_f32 v[118:119], v[118:119], v[130:131], v[130:131]
  v_rcp_f32 v112, v112
  v_rcp_f32 v113, v113
  v_rcp_f32 v114, v114
  v_rcp_f32 v115, v115
  v_rcp_f32 v116, v116
  v_rcp_f32 v117, v117
  v_rcp_f32 v118, v118
  v_rcp_f32 v119, v119
  v_pk_mul_f32 v[96:97], v[96:97], v[104:105]
  v_pk_mul_f32 v[98:99], v[98:99], v[106:107]
  v_pk_mul_f32 v[100:101], v[100:101], v[108:109]
  v_pk_mul_f32 v[102:103], v[102:103], v[110:111]
  v_cvt_pk_bf16_f32 v104, v96, v97
  v_cvt_pk_bf16_f32 v106, v100, v101
  v_cvt_pk_bf16_f32 v105, v98, v99
  v_cvt_pk_bf16_f32 v107, v102, v103
  v_permlane16_swap_b32 v104, v106
  s_nop 0
  v_permlane16_swap_b32 v105, v107
  buffer_store_dwordx4 v[104:107], v0, s[4:7], s56 offen offset:1024 sc1
  v_pk_mul_f32 v[40:41], v[32:33], v[40:41]
  v_pk_mul_f32 v[42:43], v[34:35], v[42:43]
  v_pk_mul_f32 v[44:45], v[36:37], v[44:45]
  v_pk_mul_f32 v[46:47], v[38:39], v[46:47]
  v_pk_mul_f32 v[32:33], v[32:33], v[132:133]
  v_pk_mul_f32 v[34:35], v[34:35], v[132:133]
  v_pk_mul_f32 v[36:37], v[36:37], v[132:133]
  v_pk_mul_f32 v[38:39], v[38:39], v[132:133]
  v_exp_f32 v32, v32
  v_exp_f32 v33, v33
  v_exp_f32 v34, v34
  v_exp_f32 v35, v35
  v_exp_f32 v36, v36
  v_exp_f32 v37, v37
  v_exp_f32 v38, v38
  v_exp_f32_e64 v39, v39
  v_pk_fma_f32 v[32:33], v[32:33], v[128:129], v[128:129]
  v_pk_fma_f32 v[34:35], v[34:35], v[128:129], v[128:129]
  v_pk_fma_f32 v[36:37], v[36:37], v[130:131], v[130:131]
  v_pk_fma_f32 v[38:39], v[38:39], v[130:131], v[130:131]
  v_rcp_f32 v32, v32
  v_rcp_f32 v33, v33
  v_rcp_f32 v34, v34
  v_rcp_f32 v35, v35
  v_rcp_f32 v36, v36
  v_rcp_f32 v37, v37
  v_rcp_f32 v38, v38
  v_rcp_f32 v39, v39
  v_pk_mul_f32 v[112:113], v[112:113], v[120:121]
  v_pk_mul_f32 v[114:115], v[114:115], v[122:123]
  v_pk_mul_f32 v[116:117], v[116:117], v[124:125]
  v_pk_mul_f32 v[118:119], v[118:119], v[126:127]
  v_cvt_pk_bf16_f32 v120, v112, v113
  v_cvt_pk_bf16_f32 v122, v116, v117
  v_cvt_pk_bf16_f32 v121, v114, v115
  v_cvt_pk_bf16_f32 v123, v118, v119
  v_permlane16_swap_b32 v120, v122
  s_nop 0
  v_permlane16_swap_b32 v121, v123
  buffer_store_dwordx4 v[120:123], v0, s[4:7], s56 offen offset:2048 sc1
  v_pk_mul_f32 v[56:57], v[48:49], v[56:57]
  v_pk_mul_f32 v[58:59], v[50:51], v[58:59]
  v_pk_mul_f32 v[60:61], v[52:53], v[60:61]
  v_pk_mul_f32 v[62:63], v[54:55], v[62:63]
  v_pk_mul_f32 v[48:49], v[48:49], v[132:133]
  v_pk_mul_f32 v[50:51], v[50:51], v[132:133]
  v_pk_mul_f32 v[52:53], v[52:53], v[132:133]
  v_pk_mul_f32 v[54:55], v[54:55], v[132:133]
  v_exp_f32 v48, v48
  v_exp_f32 v49, v49
  v_exp_f32 v50, v50
  v_exp_f32 v51, v51
  v_exp_f32 v52, v52
  v_exp_f32 v53, v53
  v_exp_f32 v54, v54
  v_exp_f32_e64 v55, v55
  v_pk_fma_f32 v[48:49], v[48:49], v[128:129], v[128:129]
  v_pk_fma_f32 v[50:51], v[50:51], v[128:129], v[128:129]
  v_pk_fma_f32 v[52:53], v[52:53], v[130:131], v[130:131]
  v_pk_fma_f32 v[54:55], v[54:55], v[130:131], v[130:131]
  v_rcp_f32 v48, v48
  v_rcp_f32 v49, v49
  v_rcp_f32 v50, v50
  v_rcp_f32 v51, v51
  v_rcp_f32 v52, v52
  v_rcp_f32 v53, v53
  v_rcp_f32 v54, v54
  v_rcp_f32 v55, v55
  v_pk_mul_f32 v[32:33], v[32:33], v[40:41]
  v_pk_mul_f32 v[34:35], v[34:35], v[42:43]
  v_pk_mul_f32 v[36:37], v[36:37], v[44:45]
  v_pk_mul_f32 v[38:39], v[38:39], v[46:47]
  v_cvt_pk_bf16_f32 v40, v32, v33
  v_cvt_pk_bf16_f32 v42, v36, v37
  v_cvt_pk_bf16_f32 v41, v34, v35
  v_cvt_pk_bf16_f32 v43, v38, v39
  v_permlane16_swap_b32 v40, v42
  s_nop 0
  v_permlane16_swap_b32 v41, v43
  buffer_store_dwordx4 v[40:43], v0, s[4:7], s56 offen offset:3072 sc1
  v_pk_mul_f32 v[72:73], v[64:65], v[72:73]
  v_pk_mul_f32 v[74:75], v[66:67], v[74:75]
  v_pk_mul_f32 v[76:77], v[68:69], v[76:77]
  v_pk_mul_f32 v[78:79], v[70:71], v[78:79]
  v_pk_mul_f32 v[64:65], v[64:65], v[132:133]
  v_pk_mul_f32 v[66:67], v[66:67], v[132:133]
  v_pk_mul_f32 v[68:69], v[68:69], v[132:133]
  v_pk_mul_f32 v[70:71], v[70:71], v[132:133]
  v_exp_f32 v64, v64
  v_exp_f32 v65, v65
  v_exp_f32 v66, v66
  v_exp_f32 v67, v67
  v_exp_f32 v68, v68
  v_exp_f32 v69, v69
  v_exp_f32 v70, v70
  v_exp_f32_e64 v71, v71
  v_pk_mul_f32 v[48:49], v[48:49], v[56:57]
  v_pk_mul_f32 v[50:51], v[50:51], v[58:59]
  v_pk_mul_f32 v[52:53], v[52:53], v[60:61]
  v_pk_mul_f32 v[54:55], v[54:55], v[62:63]
  v_cvt_pk_bf16_f32 v56, v48, v49
  v_cvt_pk_bf16_f32 v58, v52, v53
  v_cvt_pk_bf16_f32 v57, v50, v51
  v_cvt_pk_bf16_f32 v59, v54, v55
  v_permlane16_swap_b32 v56, v58
  s_nop 0
  v_permlane16_swap_b32 v57, v59
  buffer_store_dwordx4 v[56:59], v0, s[4:7], s58 offen offset:0 sc1
  v_pk_fma_f32 v[64:65], v[64:65], v[128:129], v[128:129]
  v_pk_fma_f32 v[66:67], v[66:67], v[128:129], v[128:129]
  v_pk_fma_f32 v[68:69], v[68:69], v[130:131], v[130:131]
  v_pk_fma_f32 v[70:71], v[70:71], v[130:131], v[130:131]
  v_rcp_f32 v64, v64
  v_rcp_f32 v65, v65
  v_rcp_f32 v66, v66
  v_rcp_f32 v67, v67
  v_rcp_f32 v68, v68
  v_rcp_f32 v69, v69
  v_rcp_f32 v70, v70
  v_rcp_f32_e64 v71, v71
  v_pk_mul_f32 v[64:65], v[64:65], v[72:73]
  v_pk_mul_f32 v[66:67], v[66:67], v[74:75]
  v_pk_mul_f32 v[68:69], v[68:69], v[76:77]
  v_pk_mul_f32 v[70:71], v[70:71], v[78:79]
  v_cvt_pk_bf16_f32 v72, v64, v65
  v_cvt_pk_bf16_f32 v74, v68, v69
  v_cvt_pk_bf16_f32 v73, v66, v67
  v_cvt_pk_bf16_f32 v75, v70, v71
  v_permlane16_swap_b32 v72, v74
  s_nop 0
  v_permlane16_swap_b32 v73, v75
  buffer_store_dwordx4 v[72:75], v0, s[4:7], s58 offen offset:1024 sc1
G_PT:
  s_cmp_lt_u32 s45, 2
  s_cselect_b64 s[0:1], -1, 0
  s_mov_b32 s52, 3200000
LP23:
  ds_read_b32 v163, v6 offset:12
  s_waitcnt lgkmcnt(0)
  v_cmp_ne_u32 vcc, 4, v163
  s_cbranch_vccz LP23_D
  s_sleep 1
  s_sub_u32 s52, s52, 1
  s_cmp_lg_u32 s52, 0
  s_cbranch_scc1 LP23
LP23_D:
  ds_read_b64_tr_b16 v[204:205], v154 offset:24576
  ds_read_b64_tr_b16 v[206:207], v150 offset:24576
  ds_read_b64_tr_b16 v[208:209], v155 offset:24576
  ds_read_b64_tr_b16 v[210:211], v151 offset:24576
  ds_read_b64_tr_b16 v[212:213], v150 offset:53248
  ds_read_b64_tr_b16 v[214:215], v152 offset:16384
  ds_read_b64_tr_b16 v[216:217], v151 offset:53248
  ds_read_b64_tr_b16 v[218:219], v153 offset:16384
  s_mov_b32 s52, 3200000
LP24:
  ds_read_b32 v163, v6 offset:0
  s_waitcnt lgkmcnt(0)
  v_cmp_ne_u32 vcc, 4, v163
  s_cbranch_vccz LP24_D
  s_sleep 1
  s_sub_u32 s52, s52, 1
  s_cmp_lg_u32 s52, 0
  s_cbranch_scc1 LP24
LP24_D:
  s_add_u32 m0, s98, 57344
  s_add_u32 s51, s62, 327680
  s_add_u32 s52, s62, 0xfff00000
  s_min_u32 s51, s51, s52
  buffer_load_dwordx4 v158, s[24:27], s51 offen lds
  s_add_u32 m0, s98, 61440
  s_nop 0
  buffer_load_dwordx4 v159, s[24:27], s51 offen lds
  s_add_u32 m0, s98, 65536
  s_add_u32 s51, s62, 393216
  s_add_u32 s52, s62, 0xfff10000
  s_min_u32 s51, s51, s52
  buffer_load_dwordx4 v158, s[24:27], s51 offen lds
  s_add_u32 m0, s98, 69632
  s_nop 0
  buffer_load_dwordx4 v159, s[24:27], s51 offen lds
  s_lshl_b32 s50, s46, 1
  s_lshr_b32 s51, s45, 1
  s_add_u32 s50, s50, s51
  s_lshl_b32 s50, s50, 4
  s_add_u32 s50, s50, s47
  s_lshl_b32 s50, s50, 1
  s_and_b32 s51, s45, 1
  s_add_u32 s50, s50, s51
  s_lshl_b32 s50, s50, 2
  s_add_u32 s50, s50, 14712832
  v_mov_b32_e64 v162, 1
  s_mov_b64 exec, 1
  s_waitcnt vmcnt(4)
  buffer_store_dword v162, off, s[4:7], s50 sc1
  s_mov_b64 exec, -1
  s_add_u32 m0, s98, 73728
  s_add_u32 s51, s62, 458752
  s_add_u32 s52, s62, 0xfff20000
  s_min_u32 s51, s51, s52
  buffer_load_dwordx4 v158, s[24:27], s51 offen lds
  s_add_u32 m0, s98, 77824
  s_nop 0
  buffer_load_dwordx4 v159, s[24:27], s51 offen lds
  s_waitcnt vmcnt(6)
  s_add_u32 m0, s98, 86016
  s_add_u32 s51, s62, 524288
  s_add_u32 s52, s62, 0xfff30000
  s_min_u32 s51, s51, s52
  buffer_load_dwordx4 v158, s[24:27], s51 offen lds
  s_add_u32 m0, s98, 90112
  s_nop 0
  buffer_load_dwordx4 v159, s[24:27], s51 offen lds
  s_waitcnt vmcnt(6)
  s_add_u32 m0, s98, 94208
  s_add_u32 s51, s62, 589824
  s_add_u32 s52, s62, 0xfff40000
  s_min_u32 s51, s51, s52
  buffer_load_dwordx4 v158, s[24:27], s51 offen lds
  s_add_u32 m0, s98, 98304
  s_nop 0
  buffer_load_dwordx4 v159, s[24:27], s51 offen lds
  s_waitcnt vmcnt(6)
  s_add_u32 m0, s98, 102400
  s_add_u32 s51, s62, 655360
  s_add_u32 s52, s62, 0xfff50000
  s_min_u32 s51, s51, s52
  buffer_load_dwordx4 v158, s[24:27], s51 offen lds
  s_add_u32 m0, s98, 106496
  s_nop 0
  buffer_load_dwordx4 v159, s[24:27], s51 offen lds
  s_waitcnt vmcnt(6)
  s_add_u32 m0, s98, 155648
  s_add_u32 s51, s101, 131072
  s_and_b32 s51, s51, 458752
  buffer_load_dwordx4 v148, s[28:31], s51 offen lds
  s_add_u32 m0, s98, 24576
  s_nop 0
  buffer_load_dwordx4 v149, s[28:31], s51 offen lds
  s_waitcnt vmcnt(6)
  s_add_u32 m0, s98, 53248
  s_add_u32 s51, s101, 196608
  s_and_b32 s51, s51, 458752
  buffer_load_dwordx4 v148, s[28:31], s51 offen lds
  s_add_u32 m0, s98, 81920
  s_nop 0
  buffer_load_dwordx4 v149, s[28:31], s51 offen lds
  s_waitcnt vmcnt(6)
  s_mov_b32 s52, 3200000
LP25:
  ds_read_b32 v163, v6 offset:44
  s_waitcnt lgkmcnt(0)
  v_cmp_ne_u32 vcc, 4, v163
  s_cbranch_vccz LP25_D
  s_sleep 1
  s_sub_u32 s52, s52, 1
  s_cmp_lg_u32 s52, 0
  s_cbranch_scc1 LP25
LP25_D:
  s_add_u32 m0, s98, 0
  s_add_u32 s51, s62, 851968
  s_add_u32 s52, s62, 0xfff80000
  s_min_u32 s51, s51, s52
  buffer_load_dwordx4 v158, s[24:27], s51 offen lds
  s_add_u32 m0, s98, 4096
  s_nop 0
  buffer_load_dwordx4 v159, s[24:27], s51 offen lds
  s_waitcnt vmcnt(6)
  s_add_u32 m0, s98, 8192
  s_add_u32 s51, s62, 917504
  s_add_u32 s52, s62, 0xfff90000
  s_min_u32 s51, s51, s52
  buffer_load_dwordx4 v158, s[24:27], s51 offen lds
  s_add_u32 m0, s98, 12288
  s_nop 0
  buffer_load_dwordx4 v159, s[24:27], s51 offen lds
  s_waitcnt vmcnt(6)
  s_add_u32 m0, s98, 28672
  s_add_u32 s51, s62, 983040
  s_add_u32 s52, s62, 0xfffa0000
  s_min_u32 s51, s51, s52
  buffer_load_dwordx4 v158, s[24:27], s51 offen lds
  s_add_u32 m0, s98, 32768
  s_nop 0
  buffer_load_dwordx4 v159, s[24:27], s51 offen lds
  s_waitcnt vmcnt(6)
  s_add_u32 m0, s98, 36864
  s_add_u32 s51, s62, 1048576
  s_add_u32 s52, s62, 0xfffb0000
  s_min_u32 s51, s51, s52
  buffer_load_dwordx4 v158, s[24:27], s51 offen lds
  s_add_u32 m0, s98, 40960
  s_nop 0
  buffer_load_dwordx4 v159, s[24:27], s51 offen lds
  s_waitcnt vmcnt(6)
  s_lshl_b32 s50, s45, 2
  v_add_u32_e64 v162, s50, v6
  s_mov_b32 s52, 3200000
LP26:
  ds_read_b32 v163, v162 offset:16
  s_waitcnt lgkmcnt(0)
  v_cmp_ne_u32 vcc, 1, v163
  s_cbranch_vccz LP26_D
  s_sleep 1
  s_sub_u32 s52, s52, 1
  s_cmp_lg_u32 s52, 0
  s_cbranch_scc1 LP26
LP26_D:
  ds_read_b64_tr_b16 v[220:221], v150 offset:57344
  ds_read_b64_tr_b16 v[222:223], v150 offset:61440
  ds_read_b64_tr_b16 v[224:225], v151 offset:57344
  ds_read_b64_tr_b16 v[226:227], v151 offset:61440
  ds_read_b64_tr_b16 v[228:229], v152 offset:0
  ds_read_b64_tr_b16 v[230:231], v152 offset:4096
  ds_read_b64_tr_b16 v[232:233], v153 offset:0
  ds_read_b64_tr_b16 v[234:235], v153 offset:4096
  ds_read_b64_tr_b16 v[236:237], v152 offset:8192
  ds_read_b64_tr_b16 v[238:239], v152 offset:12288
  ds_read_b64_tr_b16 v[240:241], v153 offset:8192
  ds_read_b64_tr_b16 v[242:243], v153 offset:12288
  ds_read_b64_tr_b16 v[244:245], v152 offset:20480
  ds_read_b64_tr_b16 v[246:247], v152 offset:24576
  ds_read_b64_tr_b16 v[248:249], v153 offset:20480
  ds_read_b64_tr_b16 v[250:251], v153 offset:24576
  s_waitcnt lgkmcnt(0)
  s_add_u32 m0, s98, 57344
  s_add_u32 s51, s101, 262144
  s_and_b32 s51, s51, 458752
  buffer_load_dwordx4 v148, s[28:31], s51 offen lds
  s_add_u32 m0, s98, 61440
  s_nop 0
  buffer_load_dwordx4 v149, s[28:31], s51 offen lds
  s_waitcnt vmcnt(6)
  buffer_load_dword v145, v146, s[4:7], s61 offen sc1
  s_add_u32 m0, s98, 65536
  s_add_u32 s51, s101, 327680
  s_and_b32 s51, s51, 458752
  buffer_load_dwordx4 v148, s[28:31], s51 offen lds
  s_add_u32 m0, s98, 69632
  s_nop 0
  buffer_load_dwordx4 v149, s[28:31], s51 offen lds
  s_waitcnt vmcnt(6)
  s_add_u32 m0, s98, 73728
  s_add_u32 s51, s101, 393216
  s_and_b32 s51, s51, 458752
  buffer_load_dwordx4 v148, s[28:31], s51 offen lds
  s_add_u32 m0, s98, 77824
  s_nop 0
  buffer_load_dwordx4 v149, s[28:31], s51 offen lds
  s_waitcnt vmcnt(6)
  s_add_u32 m0, s98, 86016
  s_add_u32 s51, s101, 458752
  s_and_b32 s51, s51, 458752
  buffer_load_dwordx4 v148, s[28:31], s51 offen lds
  s_add_u32 m0, s98, 90112
  s_nop 0
  buffer_load_dwordx4 v149, s[28:31], s51 offen lds
  s_waitcnt vmcnt(6)
  v_cmp_ne_u32 vcc, 1, v145
  s_cbranch_vccz PL27_D
  s_mov_b32 s52, 200000
PL27:
  buffer_load_dword v145, v146, s[4:7], s61 offen sc1
  s_waitcnt vmcnt(0)
  v_cmp_ne_u32 vcc, 1, v145
  s_cbranch_vccz PL27_D
  s_sleep 2
  s_sub_u32 s52, s52, 1
  s_cmp_lg_u32 s52, 0
  s_cbranch_scc1 PL27
PL27_D:
  s_add_u32 s51, s62, 0
  s_add_u32 s52, s62, 0xffeb0000
  s_min_u32 s51, s51, s52
  s_lshr_b32 s51, s51, 4
  buffer_load_dwordx4 v[96:99], v156, s[4:7], s51 offen sc1
  buffer_load_dwordx4 v[100:103], v157, s[4:7], s51 offen sc1
  s_add_u32 s51, s62, 65536
  s_add_u32 s52, s62, 0xffec0000
  s_min_u32 s51, s51, s52
  s_lshr_b32 s51, s51, 4
  buffer_load_dwordx4 v[104:107], v156, s[4:7], s51 offen sc1
  buffer_load_dwordx4 v[108:111], v157, s[4:7], s51 offen sc1
  s_add_u32 s51, s62, 131072
  s_add_u32 s52, s62, 0xffed0000
  s_min_u32 s51, s51, s52
  s_lshr_b32 s51, s51, 4
  buffer_load_dwordx4 v[112:115], v156, s[4:7], s51 offen sc1
  buffer_load_dwordx4 v[116:119], v157, s[4:7], s51 offen sc1
  s_add_u32 s51, s62, 196608
  s_add_u32 s52, s62, 0xffee0000
  s_min_u32 s51, s51, s52
  s_lshr_b32 s51, s51, 4
  buffer_load_dwordx4 v[120:123], v156, s[4:7], s51 offen sc1
  buffer_load_dwordx4 v[124:127], v157, s[4:7], s51 offen sc1
  v_mbcnt_lo_u32_b32 v1, -1, 0
  v_mbcnt_hi_u32_b32 v1, -1, v1
  v_lshrrev_b32_e64 v4, 4, v1
  v_bfe_u32 v5, v1, 3, 1
  v_lshl_add_u32 v3, v5, 2, v4
  v_lshlrev_b32_e64 v2, 8, v4
  v_lshl_add_u32 v2, v5, 7, v2
  v_and_b32_e64 v5, 3, v1
  v_lshl_add_u32 v2, v5, 5, v2
  v_and_b32 v5, 16, v1
  v_add_u32 v2, v2, v5
  v_cmp_ne_u32 s[56:57], 0, v5
  v_bfe_u32 v5, v1, 2, 1
  v_lshl_add_u32 v2, v5, 14, v2
  s_lshr_b32 s50, s44, 2
  s_lshl_b32 s50, s50, 15
  s_lshl_b32 s58, s45, 12
  s_add_u32 s50, s50, s58
  v_add_u32 v2, s50, v2
  v_and_b32 v5, 7, v1
  v_lshlrev_b32_e64 v5, 4, v5
  v_lshl_add_u32 v6, v3, 10, v5
  v_xor_b32 v3, 16, v2
  s_lshl_b32 s58, s53, 16
  s_lshl_b32 s50, s54, 7
  s_add_u32 s58, s58, s50
  s_lshl_b32 s50, s44, 13
  s_add_u32 s58, s58, s50
  v_mov_b32 v7, 162304
  v_mov_b32_e64 v8, 1
  s_setprio 0
  s_waitcnt vmcnt(6)
  v_mfma_f32_32x32x16_bf16 v[32:47], v[96:99], v[164:167], 0
  v_mfma_f32_32x32x16_bf16 v[48:63], v[96:99], v[168:171], 0
  s_add_u32 s51, s62, 262144
  s_add_u32 s52, s62, 0xffef0000
  s_min_u32 s51, s51, s52
  s_lshr_b32 s51, s51, 4
  buffer_load_dwordx4 v[128:131], v156, s[4:7], s51 offen sc1
  v_mfma_f32_32x32x16_bf16 v[64:79], v[100:103], v[164:167], 0
  buffer_load_dwordx4 v[132:135], v157, s[4:7], s51 offen sc1
  v_mfma_f32_32x32x16_bf16 v[80:95], v[100:103], v[168:171], 0
  s_waitcnt vmcnt(6)
  v_mfma_f32_32x32x16_bf16 v[32:47], v[104:107], v[172:175], v[32:47]
  v_mfma_f32_32x32x16_bf16 v[48:63], v[104:107], v[176:179], v[48:63]
  s_add_u32 s51, s62, 327680
  s_add_u32 s52, s62, 0xfff00000
  s_min_u32 s51, s51, s52
  s_lshr_b32 s51, s51, 4
  buffer_load_dwordx4 v[96:99], v156, s[4:7], s51 offen sc1
  v_mfma_f32_32x32x16_bf16 v[64:79], v[108:111], v[172:175], v[64:79]
  buffer_load_dwordx4 v[100:103], v157, s[4:7], s51 offen sc1
  v_mfma_f32_32x32x16_bf16 v[80:95], v[108:111], v[176:179], v[80:95]
  s_waitcnt vmcnt(6)
  v_mfma_f32_32x32x16_bf16 v[32:47], v[112:115], v[180:183], v[32:47]
  v_mfma_f32_32x32x16_bf16 v[48:63], v[112:115], v[184:187], v[48:63]
  s_add_u32 s51, s62, 393216
  s_add_u32 s52, s62, 0xfff10000
  s_min_u32 s51, s51, s52
  s_lshr_b32 s51, s51, 4
  buffer_load_dwordx4 v[104:107], v156, s[4:7], s51 offen sc1
  v_mfma_f32_32x32x16_bf16 v[64:79], v[116:119], v[180:183], v[64:79]
  buffer_load_dwordx4 v[108:111], v157, s[4:7], s51 offen sc1
  v_mfma_f32_32x32x16_bf16 v[80:95], v[116:119], v[184:187], v[80:95]
  s_waitcnt vmcnt(6)
  v_mfma_f32_32x32x16_bf16 v[32:47], v[120:123], v[188:191], v[32:47]
  v_mfma_f32_32x32x16_bf16 v[48:63], v[120:123], v[192:195], v[48:63]
  s_add_u32 s51, s62, 458752
  s_add_u32 s52, s62, 0xfff20000
  s_min_u32 s51, s51, s52
  s_lshr_b32 s51, s51, 4
  buffer_load_dwordx4 v[112:115], v156, s[4:7], s51 offen sc1
  v_mfma_f32_32x32x16_bf16 v[64:79], v[124:127], v[188:191], v[64:79]
  buffer_load_dwordx4 v[116:119], v157, s[4:7], s51 offen sc1
  v_mfma_f32_32x32x16_bf16 v[80:95], v[124:127], v[192:195], v[80:95]
  s_waitcnt vmcnt(6)
  v_mfma_f32_32x32x16_bf16 v[32:47], v[128:131], v[196:199], v[32:47]
  v_mfma_f32_32x32x16_bf16 v[48:63], v[128:131], v[200:203], v[48:63]
  s_add_u32 s51, s62, 524288
  s_add_u32 s52, s62, 0xfff30000
  s_min_u32 s51, s51, s52
  s_lshr_b32 s51, s51, 4
  buffer_load_dwordx4 v[120:123], v156, s[4:7], s51 offen sc1
  v_mfma_f32_32x32x16_bf16 v[64:79], v[132:135], v[196:199], v[64:79]
  buffer_load_dwordx4 v[124:127], v157, s[4:7], s51 offen sc1
  v_mfma_f32_32x32x16_bf16 v[80:95], v[132:135], v[200:203], v[80:95]
  s_waitcnt vmcnt(6)
  v_mfma_f32_32x32x16_bf16 v[32:47], v[96:99], v[220:223], v[32:47]
  v_mfma_f32_32x32x16_bf16 v[48:63], v[96:99], v[224:227], v[48:63]
  s_add_u32 s51, s62, 589824
  s_add_u32 s52, s62, 0xfff40000
  s_min_u32 s51, s51, s52
  s_lshr_b32 s51, s51, 4
  buffer_load_dwordx4 v[128:131], v156, s[4:7], s51 offen sc1
  v_mfma_f32_32x32x16_bf16 v[64:79], v[100:103], v[220:223], v[64:79]
  buffer_load_dwordx4 v[132:135], v157, s[4:7], s51 offen sc1
  v_mfma_f32_32x32x16_bf16 v[80:95], v[100:103], v[224:227], v[80:95]
  s_waitcnt vmcnt(6)
  v_mfma_f32_32x32x16_bf16 v[32:47], v[104:107], v[228:231], v[32:47]
  v_mfma_f32_32x32x16_bf16 v[48:63], v[104:107], v[232:235], v[48:63]
  s_add_u32 s51, s62, 655360
  s_add_u32 s52, s62, 0xfff50000
  s_min_u32 s51, s51, s52
  s_lshr_b32 s51, s51, 4
  buffer_load_dwordx4 v[96:99], v156, s[4:7], s51 offen sc1
  v_mfma_f32_32x32x16_bf16 v[64:79], v[108:111], v[228:231], v[64:79]
  buffer_load_dwordx4 v[100:103], v157, s[4:7], s51 offen sc1
  v_mfma_f32_32x32x16_bf16 v[80:95], v[108:111], v[232:235], v[80:95]
  s_waitcnt vmcnt(6)
  v_mfma_f32_32x32x16_bf16 v[32:47], v[112:115], v[236:239], v[32:47]
  v_mfma_f32_32x32x16_bf16 v[48:63], v[112:115], v[240:243], v[48:63]
  s_add_u32 s51, s62, 720896
  s_add_u32 s52, s62, 0xfff60000
  s_min_u32 s51, s51, s52
  s_lshr_b32 s51, s51, 4
  buffer_load_dwordx4 v[104:107], v156, s[4:7], s51 offen sc1
  v_mfma_f32_32x32x16_bf16 v[64:79], v[116:119], v[236:239], v[64:79]
  buffer_load_dwordx4 v[108:111], v157, s[4:7], s51 offen sc1
  v_mfma_f32_32x32x16_bf16 v[80:95], v[116:119], v[240:243], v[80:95]
  s_waitcnt vmcnt(6)
  v_mfma_f32_32x32x16_bf16 v[32:47], v[120:123], v[244:247], v[32:47]
  ds_read_b64_tr_b16 v[20:21], v152 offset:28672
  ds_read_b64_tr_b16 v[22:23], v152 offset:32768
  ds_read_b64_tr_b16 v[24:25], v153 offset:28672
  ds_read_b64_tr_b16 v[26:27], v153 offset:32768
  v_mfma_f32_32x32x16_bf16 v[48:63], v[120:123], v[248:251], v[48:63]
  s_add_u32 s51, s62, 786432
  s_add_u32 s52, s62, 0xfff70000
  s_min_u32 s51, s51, s52
  s_lshr_b32 s51, s51, 4
  buffer_load_dwordx4 v[112:115], v156, s[4:7], s51 offen sc1
  v_mfma_f32_32x32x16_bf16 v[64:79], v[124:127], v[244:247], v[64:79]
  buffer_load_dwordx4 v[116:119], v157, s[4:7], s51 offen sc1
  v_mfma_f32_32x32x16_bf16 v[80:95], v[124:127], v[248:251], v[80:95]
  s_waitcnt vmcnt(6) lgkmcnt(0)
  v_mfma_f32_32x32x16_bf16 v[32:47], v[128:131], v[20:23], v[32:47]
  ds_read_b64_tr_b16 v[12:13], v152 offset:36864
  ds_read_b64_tr_b16 v[14:15], v152 offset:40960
  ds_read_b64_tr_b16 v[16:17], v153 offset:36864
  ds_read_b64_tr_b16 v[18:19], v153 offset:40960
  v_mfma_f32_32x32x16_bf16 v[48:63], v[128:131], v[24:27], v[48:63]
  s_add_u32 s51, s62, 851968
  s_add_u32 s52, s62, 0xfff80000
  s_min_u32 s51, s51, s52
  s_lshr_b32 s51, s51, 4
  buffer_load_dwordx4 v[120:123], v156, s[4:7], s51 offen sc1
  v_mfma_f32_32x32x16_bf16 v[64:79], v[132:135], v[20:23], v[64:79]
  buffer_load_dwordx4 v[124:127], v157, s[4:7], s51 offen sc1
  v_mfma_f32_32x32x16_bf16 v[80:95], v[132:135], v[24:27], v[80:95]
  s_waitcnt vmcnt(6) lgkmcnt(0)
  v_mfma_f32_32x32x16_bf16 v[32:47], v[96:99], v[12:15], v[32:47]
  ds_read_b64_tr_b16 v[20:21], v150 offset:16384
  ds_read_b64_tr_b16 v[22:23], v150 offset:20480
  ds_read_b64_tr_b16 v[24:25], v151 offset:16384
  ds_read_b64_tr_b16 v[26:27], v151 offset:20480
  v_mfma_f32_32x32x16_bf16 v[48:63], v[96:99], v[16:19], v[48:63]
  s_add_u32 s51, s62, 917504
  s_add_u32 s52, s62, 0xfff90000
  s_min_u32 s51, s51, s52
  s_lshr_b32 s51, s51, 4
  buffer_load_dwordx4 v[128:131], v156, s[4:7], s51 offen sc1
  v_mfma_f32_32x32x16_bf16 v[64:79], v[100:103], v[12:15], v[64:79]
  buffer_load_dwordx4 v[132:135], v157, s[4:7], s51 offen sc1
  ds_read_b64_tr_b16 v[164:165], v154 offset:24576
  ds_read_b64_tr_b16 v[166:167], v150 offset:24576
  ds_read_b64_tr_b16 v[168:169], v155 offset:24576
  ds_read_b64_tr_b16 v[170:171], v151 offset:24576
  v_mfma_f32_32x32x16_bf16 v[80:95], v[100:103], v[16:19], v[80:95]
  s_waitcnt vmcnt(6) lgkmcnt(4)
  v_mfma_f32_32x32x16_bf16 v[32:47], v[104:107], v[20:23], v[32:47]
  ds_read_b64_tr_b16 v[12:13], v150 offset:45056
  ds_read_b64_tr_b16 v[14:15], v150 offset:49152
  ds_read_b64_tr_b16 v[16:17], v151 offset:45056
  ds_read_b64_tr_b16 v[18:19], v151 offset:49152
  v_mfma_f32_32x32x16_bf16 v[48:63], v[104:107], v[24:27], v[48:63]
  s_add_u32 s51, s62, 983040
  s_add_u32 s52, s62, 0xfffa0000
  s_min_u32 s51, s51, s52
  s_lshr_b32 s51, s51, 4
  buffer_load_dwordx4 v[96:99], v156, s[4:7], s51 offen sc1
  v_mfma_f32_32x32x16_bf16 v[64:79], v[108:111], v[20:23], v[64:79]
  buffer_load_dwordx4 v[100:103], v157, s[4:7], s51 offen sc1
  ds_read_b64_tr_b16 v[172:173], v150 offset:53248
  ds_read_b64_tr_b16 v[174:175], v152 offset:16384
  ds_read_b64_tr_b16 v[176:177], v151 offset:53248
  ds_read_b64_tr_b16 v[178:179], v153 offset:16384
  v_mfma_f32_32x32x16_bf16 v[80:95], v[108:111], v[24:27], v[80:95]
  s_waitcnt vmcnt(6) lgkmcnt(4)
  v_mfma_f32_32x32x16_bf16 v[32:47], v[112:115], v[12:15], v[32:47]
  ds_read_b64_tr_b16 v[20:21], v150 offset:0
  ds_read_b64_tr_b16 v[22:23], v150 offset:4096
  ds_read_b64_tr_b16 v[24:25], v151 offset:0
  ds_read_b64_tr_b16 v[26:27], v151 offset:4096
  v_mfma_f32_32x32x16_bf16 v[48:63], v[112:115], v[16:19], v[48:63]
  s_add_u32 s51, s62, 1048576
  s_add_u32 s52, s62, 0xfffb0000
  s_min_u32 s51, s51, s52
  s_lshr_b32 s51, s51, 4
  buffer_load_dwordx4 v[104:107], v156, s[4:7], s51 offen sc1
  v_mfma_f32_32x32x16_bf16 v[64:79], v[116:119], v[12:15], v[64:79]
  buffer_load_dwordx4 v[108:111], v157, s[4:7], s51 offen sc1
  ds_read_b64_tr_b16 v[180:181], v150 offset:57344
  ds_read_b64_tr_b16 v[182:183], v150 offset:61440
  ds_read_b64_tr_b16 v[184:185], v151 offset:57344
  ds_read_b64_tr_b16 v[186:187], v151 offset:61440
  v_mfma_f32_32x32x16_bf16 v[80:95], v[116:119], v[16:19], v[80:95]
  s_waitcnt vmcnt(6) lgkmcnt(4)
  v_mfma_f32_32x32x16_bf16 v[32:47], v[120:123], v[20:23], v[32:47]
  ds_read_b64_tr_b16 v[12:13], v150 offset:8192
  ds_read_b64_tr_b16 v[14:15], v150 offset:12288
  ds_read_b64_tr_b16 v[16:17], v151 offset:8192
  ds_read_b64_tr_b16 v[18:19], v151 offset:12288
  v_mfma_f32_32x32x16_bf16 v[48:63], v[120:123], v[24:27], v[48:63]
  s_add_u32 s51, s62, 1114112
  s_add_u32 s52, s62, 0xfffc0000
  s_min_u32 s51, s51, s52
  s_lshr_b32 s51, s51, 4
  buffer_load_dwordx4 v[112:115], v156, s[4:7], s51 offen sc1
  v_mfma_f32_32x32x16_bf16 v[64:79], v[124:127], v[20:23], v[64:79]
  buffer_load_dwordx4 v[116:119], v157, s[4:7], s51 offen sc1
  ds_read_b64_tr_b16 v[188:189], v152 offset:0
  ds_read_b64_tr_b16 v[190:191], v152 offset:4096
  ds_read_b64_tr_b16 v[192:193], v153 offset:0
  ds_read_b64_tr_b16 v[194:195], v153 offset:4096
  v_mfma_f32_32x32x16_bf16 v[80:95], v[124:127], v[24:27], v[80:95]
  s_waitcnt vmcnt(6) lgkmcnt(4)
  v_mfma_f32_32x32x16_bf16 v[32:47], v[128:131], v[12:15], v[32:47]
  ds_read_b64_tr_b16 v[20:21], v150 offset:28672
  ds_read_b64_tr_b16 v[22:23], v150 offset:32768
  ds_read_b64_tr_b16 v[24:25], v151 offset:28672
  ds_read_b64_tr_b16 v[26:27], v151 offset:32768
  v_mfma_f32_32x32x16_bf16 v[48:63], v[128:131], v[16:19], v[48:63]
  s_add_u32 s51, s62, 1179648
  s_add_u32 s52, s62, 0xfffd0000
  s_min_u32 s51, s51, s52
  s_lshr_b32 s51, s51, 4
  buffer_load_dwordx4 v[120:123], v156, s[4:7], s51 offen sc1
  v_mfma_f32_32x32x16_bf16 v[64:79], v[132:135], v[12:15], v[64:79]
  buffer_load_dwordx4 v[124:127], v157, s[4:7], s51 offen sc1
  ds_read_b64_tr_b16 v[196:197], v152 offset:8192
  ds_read_b64_tr_b16 v[198:199], v152 offset:12288
  ds_read_b64_tr_b16 v[200:201], v153 offset:8192
  ds_read_b64_tr_b16 v[202:203], v153 offset:12288
  v_mfma_f32_32x32x16_bf16 v[80:95], v[132:135], v[16:19], v[80:95]
  s_waitcnt vmcnt(6) lgkmcnt(4)
  v_mfma_f32_32x32x16_bf16 v[32:47], v[96:99], v[20:23], v[32:47]
  ds_read_b64_tr_b16 v[12:13], v150 offset:36864
  ds_read_b64_tr_b16 v[14:15], v150 offset:40960
  ds_read_b64_tr_b16 v[16:17], v151 offset:36864
  ds_read_b64_tr_b16 v[18:19], v151 offset:40960
  v_mfma_f32_32x32x16_bf16 v[48:63], v[96:99], v[24:27], v[48:63]
  s_add_u32 s51, s62, 1245184
  s_add_u32 s52, s62, 0xfffe0000
  s_min_u32 s51, s51, s52
  s_lshr_b32 s51, s51, 4
  buffer_load_dwordx4 v[128:131], v156, s[4:7], s51 offen sc1
  v_mfma_f32_32x32x16_bf16 v[64:79], v[100:103], v[20:23], v[64:79]
  buffer_load_dwordx4 v[132:135], v157, s[4:7], s51 offen sc1
  ds_read_b64_tr_b16 v[220:221], v152 offset:20480
  ds_read_b64_tr_b16 v[222:223], v152 offset:24576
  ds_read_b64_tr_b16 v[224:225], v153 offset:20480
  ds_read_b64_tr_b16 v[226:227], v153 offset:24576
  v_mfma_f32_32x32x16_bf16 v[80:95], v[100:103], v[24:27], v[80:95]
  s_waitcnt vmcnt(6) lgkmcnt(4)
  v_mfma_f32_32x32x16_bf16 v[32:47], v[104:107], v[12:15], v[32:47]
  ds_read_b64_tr_b16 v[20:21], v152 offset:49152
  ds_read_b64_tr_b16 v[22:23], v152 offset:53248
  ds_read_b64_tr_b16 v[24:25], v153 offset:49152
  ds_read_b64_tr_b16 v[26:27], v153 offset:53248
  v_mfma_f32_32x32x16_bf16 v[48:63], v[104:107], v[16:19], v[48:63]
  s_add_u32 s51, s62, 1310720
  s_add_u32 s52, s62, 0xffff0000
  s_min_u32 s51, s51, s52
  s_lshr_b32 s51, s51, 4
  buffer_load_dwordx4 v[96:99], v156, s[4:7], s51 offen sc1
  v_mfma_f32_32x32x16_bf16 v[64:79], v[108:111], v[12:15], v[64:79]
  buffer_load_dwordx4 v[100:103], v157, s[4:7], s51 offen sc1
  v_mfma_f32_32x32x16_bf16 v[80:95], v[108:111], v[16:19], v[80:95]
  s_waitcnt vmcnt(6) lgkmcnt(0)
  v_mfma_f32_32x32x16_bf16 v[32:47], v[112:115], v[20:23], v[32:47]
  ds_read_b64_tr_b16 v[12:13], v152 offset:57344
  ds_read_b64_tr_b16 v[14:15], v152 offset:61440
  ds_read_b64_tr_b16 v[16:17], v153 offset:57344
  ds_read_b64_tr_b16 v[18:19], v153 offset:61440
  v_mfma_f32_32x32x16_bf16 v[48:63], v[112:115], v[24:27], v[48:63]
  s_and_b32 s51, s45, 2
  s_lshl_b32 s51, s51, 14
  s_sub_u32 s51, 1376256, s51
  s_lshr_b32 s51, s51, 4
  s_mov_b64 exec, s[0:1]
  buffer_load_dwordx4 v[104:107], v156, s[4:7], s51 offen sc1
  buffer_load_dwordx4 v[108:111], v157, s[4:7], s51 offen sc1
  s_mov_b64 exec, -1
  v_mfma_f32_32x32x16_bf16 v[64:79], v[116:119], v[20:23], v[64:79]
  s_nop 0
  v_mfma_f32_32x32x16_bf16 v[80:95], v[116:119], v[24:27], v[80:95]
  s_waitcnt vmcnt(6) lgkmcnt(0)
  v_mfma_f32_32x32x16_bf16 v[32:47], v[120:123], v[12:15], v[32:47]
  ds_read_b64_tr_b16 v[20:21], v154 offset:0
  ds_read_b64_tr_b16 v[22:23], v154 offset:4096
  ds_read_b64_tr_b16 v[24:25], v155 offset:0
  ds_read_b64_tr_b16 v[26:27], v155 offset:4096
  v_mfma_f32_32x32x16_bf16 v[48:63], v[120:123], v[16:19], v[48:63]
  s_add_u32 s51, s101, 0
  s_and_b32 s51, s51, 458752
  s_lshl_b32 s51, s51, 2
  buffer_load_dwordx4 v[112:115], v160, s[4:7], s51 offen offset:0 sc1
  v_mfma_f32_32x32x16_bf16 v[64:79], v[124:127], v[12:15], v[64:79]
  s_add_u32 s51, s101, 65536
  s_and_b32 s51, s51, 458752
  s_lshl_b32 s51, s51, 2
  buffer_load_dwordx4 v[116:119], v160, s[4:7], s51 offen offset:0 sc1
  v_mfma_f32_32x32x16_bf16 v[80:95], v[124:127], v[16:19], v[80:95]
  s_waitcnt vmcnt(6) lgkmcnt(0)
  v_mfma_f32_32x32x16_bf16 v[32:47], v[128:131], v[20:23], v[32:47]
  ds_read_b64_tr_b16 v[12:13], v154 offset:8192
  ds_read_b64_tr_b16 v[14:15], v154 offset:12288
  ds_read_b64_tr_b16 v[16:17], v155 offset:8192
  ds_read_b64_tr_b16 v[18:19], v155 offset:12288
  v_mfma_f32_32x32x16_bf16 v[48:63], v[128:131], v[24:27], v[48:63]
  s_add_u32 s51, s101, 131072
  s_and_b32 s51, s51, 458752
  s_lshl_b32 s51, s51, 2
  buffer_load_dwordx4 v[120:123], v160, s[4:7], s51 offen offset:0 sc1
  v_mfma_f32_32x32x16_bf16 v[64:79], v[132:135], v[20:23], v[64:79]
  s_add_u32 s51, s101, 196608
  s_and_b32 s51, s51, 458752
  s_lshl_b32 s51, s51, 2
  buffer_load_dwordx4 v[124:127], v160, s[4:7], s51 offen offset:0 sc1
  v_mfma_f32_32x32x16_bf16 v[80:95], v[132:135], v[24:27], v[80:95]
  s_waitcnt vmcnt(6) lgkmcnt(0)
  v_mfma_f32_32x32x16_bf16 v[32:47], v[96:99], v[12:15], v[32:47]
  ds_read_b64_tr_b16 v[20:21], v154 offset:16384
  ds_read_b64_tr_b16 v[22:23], v154 offset:20480
  ds_read_b64_tr_b16 v[24:25], v155 offset:16384
  ds_read_b64_tr_b16 v[26:27], v155 offset:20480
  v_mfma_f32_32x32x16_bf16 v[48:63], v[96:99], v[16:19], v[48:63]
  s_add_u32 s51, s101, 262144
  s_and_b32 s51, s51, 458752
  s_lshl_b32 s51, s51, 2
  buffer_load_dwordx4 v[128:131], v160, s[4:7], s51 offen offset:0 sc1
  v_mfma_f32_32x32x16_bf16 v[64:79], v[100:103], v[12:15], v[64:79]
  s_add_u32 s51, s101, 327680
  s_and_b32 s51, s51, 458752
  s_lshl_b32 s51, s51, 2
  buffer_load_dwordx4 v[132:135], v160, s[4:7], s51 offen offset:0 sc1
  v_mfma_f32_32x32x16_bf16 v[80:95], v[100:103], v[16:19], v[80:95]
  s_waitcnt vmcnt(6) lgkmcnt(0)
  s_add_u32 s51, s101, 393216
  s_and_b32 s51, s51, 458752
  s_lshl_b32 s51, s51, 2
  buffer_load_dwordx4 v[96:99], v160, s[4:7], s51 offen offset:0 sc1
  s_add_u32 s51, s101, 458752
  s_and_b32 s51, s51, 458752
  s_lshl_b32 s51, s51, 2
  buffer_load_dwordx4 v[100:103], v160, s[4:7], s51 offen offset:0 sc1
  s_cmp_ge_u32 s45, 2
  s_cbranch_scc1 G_SK21
  v_mfma_f32_32x32x16_bf16 v[32:47], v[104:107], v[20:23], v[32:47]
  v_mfma_f32_32x32x16_bf16 v[48:63], v[104:107], v[24:27], v[48:63]
  v_mfma_f32_32x32x16_bf16 v[64:79], v[108:111], v[20:23], v[64:79]
  v_mfma_f32_32x32x16_bf16 v[80:95], v[108:111], v[24:27], v[80:95]
G_SK21:
  s_waitcnt vmcnt(6)
  v_or_b32 v162, v112, v116
  v_and_b32_e64 v162, 1, v162
  v_cmp_eq_u32 vcc, 1, v162
  s_cbranch_vccnz G_RT22
G_OK22:
  v_mfma_f32_32x32x16_bf16 v[32:47], v[112:115], v[204:207], v[32:47]
  v_mfma_f32_32x32x16_bf16 v[48:63], v[112:115], v[208:211], v[48:63]
  s_add_u32 s51, s101, 0
  s_and_b32 s51, s51, 458752
  s_lshl_b32 s51, s51, 2
  buffer_load_dwordx4 v[104:107], v160, s[4:7], s51 offen offset:1024 sc1
  v_mfma_f32_32x32x16_bf16 v[32:47], v[116:119], v[212:215], v[32:47]
  s_add_u32 s51, s101, 65536
  s_and_b32 s51, s51, 458752
  s_lshl_b32 s51, s51, 2
  buffer_load_dwordx4 v[108:111], v160, s[4:7], s51 offen offset:1024 sc1
  s_waitcnt vmcnt(6)
  v_or_b32_e64 v162, v120, v124
  v_and_b32 v162, 1, v162
  v_cmp_eq_u32 vcc, 1, v162
  v_mfma_f32_32x32x16_bf16 v[48:63], v[116:119], v[216:219], v[48:63]
  s_cbranch_vccnz G_RT23
G_OK23:
  v_mfma_f32_32x32x16_bf16 v[32:47], v[120:123], v[164:167], v[32:47]
  v_mfma_f32_32x32x16_bf16 v[48:63], v[120:123], v[168:171], v[48:63]
  s_add_u32 s51, s101, 131072
  s_and_b32 s51, s51, 458752
  s_lshl_b32 s51, s51, 2
  buffer_load_dwordx4 v[112:115], v160, s[4:7], s51 offen offset:1024 sc1
  v_mfma_f32_32x32x16_bf16 v[32:47], v[124:127], v[172:175], v[32:47]
  s_add_u32 s51, s101, 196608
  s_and_b32 s51, s51, 458752
  s_lshl_b32 s51, s51, 2
  buffer_load_dwordx4 v[116:119], v160, s[4:7], s51 offen offset:1024 sc1
  s_waitcnt vmcnt(6)
  v_or_b32_e64 v162, v128, v132
  v_and_b32 v162, 1, v162
  v_cmp_eq_u32 vcc, 1, v162
  v_mfma_f32_32x32x16_bf16 v[48:63], v[124:127], v[176:179], v[48:63]
  s_cbranch_vccnz G_RT24
G_OK24:
  v_mfma_f32_32x32x16_bf16 v[32:47], v[128:131], v[180:183], v[32:47]
  v_mfma_f32_32x32x16_bf16 v[48:63], v[128:131], v[184:187], v[48:63]
  s_add_u32 s51, s101, 262144
  s_and_b32 s51, s51, 458752
  s_lshl_b32 s51, s51, 2
  buffer_load_dwordx4 v[120:123], v160, s[4:7], s51 offen offset:1024 sc1
  v_mfma_f32_32x32x16_bf16 v[32:47], v[132:135], v[188:191], v[32:47]
  s_add_u32 s51, s101, 327680
  s_and_b32 s51, s51, 458752
  s_lshl_b32 s51, s51, 2
  buffer_load_dwordx4 v[124:127], v160, s[4:7], s51 offen offset:1024 sc1
  s_waitcnt vmcnt(6)
  v_or_b32_e64 v162, v96, v100
  v_and_b32 v162, 1, v162
  v_cmp_eq_u32 vcc, 1, v162
  v_mfma_f32_32x32x16_bf16 v[48:63], v[132:135], v[192:195], v[48:63]
  s_cbranch_vccnz G_RT25
G_OK25:
  v_mfma_f32_32x32x16_bf16 v[32:47], v[96:99], v[196:199], v[32:47]
  s_mov_b32 m0, s98
  v_mfma_f32_32x32x16_bf16 v[48:63], v[96:99], v[200:203], v[48:63]
  s_add_u32 s51, s101, 393216
  s_and_b32 s51, s51, 458752
  s_lshl_b32 s51, s51, 2
  buffer_load_dwordx4 v[128:131], v160, s[4:7], s51 offen offset:1024 sc1
  v_mfma_f32_32x32x16_bf16 v[32:47], v[100:103], v[220:223], v[32:47]
  s_add_u32 s51, s101, 458752
  s_and_b32 s51, s51, 458752
  s_lshl_b32 s51, s51, 2
  buffer_load_dwordx4 v[132:135], v160, s[4:7], s51 offen offset:1024 sc1
  s_waitcnt vmcnt(6)
  v_or_b32 v162, v104, v108
  v_and_b32 v162, 1, v162
  v_cmp_eq_u32 vcc, 1, v162
  v_mfma_f32_32x32x16_bf16 v[48:63], v[100:103], v[224:227], v[48:63]
  s_cbranch_vccnz G_RT26
G_OK26:
  v_mfma_f32_32x32x16_bf16 v[64:79], v[104:107], v[204:207], v[64:79]
  v_mfma_f32_32x32x16_bf16 v[80:95], v[104:107], v[208:211], v[80:95]
  v_mfma_f32_32x32x16_bf16 v[64:79], v[108:111], v[212:215], v[64:79]
  ds_write_addtid_b32 v32 offset:0
  ds_write_addtid_b32 v33 offset:256
  ds_write_addtid_b32 v34 offset:512
  s_waitcnt vmcnt(4)
  v_or_b32_e64 v162, v112, v116
  v_and_b32 v162, 1, v162
  v_cmp_eq_u32 vcc, 1, v162
  v_mfma_f32_32x32x16_bf16 v[80:95], v[108:111], v[216:219], v[80:95]
  ds_write_addtid_b32 v35 offset:768
  ds_write_addtid_b32 v36 offset:4096
  s_cbranch_vccnz G_RT27
G_OK27:
  v_mfma_f32_32x32x16_bf16 v[64:79], v[112:115], v[164:167], v[64:79]
  ds_write_addtid_b32 v37 offset:4352
  ds_write_addtid_b32 v38 offset:4608
  ds_write_addtid_b32 v39 offset:4864
  v_mfma_f32_32x32x16_bf16 v[80:95], v[112:115], v[168:171], v[80:95]
  ds_write_addtid_b32 v40 offset:8192
  ds_write_addtid_b32 v41 offset:8448
  v_mfma_f32_32x32x16_bf16 v[64:79], v[116:119], v[172:175], v[64:79]
  ds_write_addtid_b32 v42 offset:8704
  ds_write_addtid_b32 v43 offset:8960
  ds_write_addtid_b32 v44 offset:12288
  s_waitcnt vmcnt(2)
  v_or_b32_e64 v162, v120, v124
  v_and_b32 v162, 1, v162
  v_cmp_eq_u32 vcc, 1, v162
  v_mfma_f32_32x32x16_bf16 v[80:95], v[116:119], v[176:179], v[80:95]
  ds_write_addtid_b32 v45 offset:12544
  ds_write_addtid_b32 v46 offset:12800
  s_cbranch_vccnz G_RT28
G_OK28:
  v_mfma_f32_32x32x16_bf16 v[64:79], v[120:123], v[180:183], v[64:79]
  ds_write_addtid_b32 v47 offset:13056
  ds_write_addtid_b32 v48 offset:16384
  ds_write_addtid_b32 v49 offset:16640
  v_mfma_f32_32x32x16_bf16 v[80:95], v[120:123], v[184:187], v[80:95]
  ds_write_addtid_b32 v50 offset:16896
  ds_write_addtid_b32 v51 offset:17152
  v_mfma_f32_32x32x16_bf16 v[64:79], v[124:127], v[188:191], v[64:79]
  ds_write_addtid_b32 v52 offset:20480
  ds_write_addtid_b32 v53 offset:20736
  ds_write_addtid_b32 v54 offset:20992
  s_waitcnt vmcnt(0)
  v_or_b32_e64 v162, v128, v132
  v_and_b32 v162, 1, v162
  v_cmp_eq_u32 vcc, 1, v162
  v_mfma_f32_32x32x16_bf16 v[80:95], v[124:127], v[192:195], v[80:95]
  ds_write_addtid_b32 v55 offset:21248
  ds_write_addtid_b32 v56 offset:24576
  s_cbranch_vccnz G_RT29
G_OK29:
  v_mfma_f32_32x32x16_bf16 v[64:79], v[128:131], v[196:199], v[64:79]
  ds_write_addtid_b32 v57 offset:24832
  ds_write_addtid_b32 v58 offset:25088
  ds_write_addtid_b32 v59 offset:25344
  v_mfma_f32_32x32x16_bf16 v[80:95], v[128:131], v[200:203], v[80:95]
  ds_write_addtid_b32 v60 offset:28672
  ds_write_addtid_b32 v61 offset:28928
  v_mfma_f32_32x32x16_bf16 v[64:79], v[132:135], v[220:223], v[64:79]
  ds_write_addtid_b32 v62 offset:29184
  ds_write_addtid_b32 v63 offset:29440
  v_mfma_f32_32x32x16_bf16 v[80:95], v[132:135], v[224:227], v[80:95]
  s_nop 8
  ds_write_addtid_b32 v64 offset:32768
  ds_write_addtid_b32 v65 offset:33024
  ds_write_addtid_b32 v66 offset:33280
  ds_write_addtid_b32 v67 offset:33536
  ds_write_addtid_b32 v68 offset:36864
  ds_write_addtid_b32 v69 offset:37120
  ds_write_addtid_b32 v70 offset:37376
  ds_write_addtid_b32 v71 offset:37632
  ds_write_addtid_b32 v72 offset:40960
  ds_write_addtid_b32 v73 offset:41216
  ds_write_addtid_b32 v74 offset:41472
  ds_write_addtid_b32 v75 offset:41728
  ds_write_addtid_b32 v76 offset:45056
  ds_write_addtid_b32 v77 offset:45312
  ds_write_addtid_b32 v78 offset:45568
  ds_write_addtid_b32 v79 offset:45824
  ds_write_addtid_b32 v80 offset:49152
  ds_write_addtid_b32 v81 offset:49408
  ds_write_addtid_b32 v82 offset:49664
  ds_write_addtid_b32 v83 offset:49920
  ds_write_addtid_b32 v84 offset:53248
  ds_write_addtid_b32 v85 offset:53504
  ds_write_addtid_b32 v86 offset:53760
  ds_write_addtid_b32 v87 offset:54016
  ds_write_addtid_b32 v88 offset:57344
  ds_write_addtid_b32 v89 offset:57600
  ds_write_addtid_b32 v90 offset:57856
  ds_write_addtid_b32 v91 offset:58112
  ds_write_addtid_b32 v92 offset:61440
  ds_write_addtid_b32 v93 offset:61696
  ds_write_addtid_b32 v94 offset:61952
  ds_write_addtid_b32 v95 offset:62208
  s_setprio 1
  s_waitcnt lgkmcnt(0)
  s_barrier
  ds_read_b128 v[16:19], v2 offset:0
  ds_read_b128 v[20:23], v3 offset:0
  ds_read_b128 v[24:27], v2 offset:1024
  ds_read_b128 v[28:31], v3 offset:1024
  ds_read_b128 v[32:35], v2 offset:2048
  ds_read_b128 v[36:39], v3 offset:2048
  ds_read_b128 v[40:43], v2 offset:3072
  ds_read_b128 v[44:47], v3 offset:3072
  s_waitcnt lgkmcnt(4)
  v_pk_add_f32 v[16:17], v[16:17], v[24:25]
  v_pk_add_f32 v[18:19], v[18:19], v[26:27]
  v_pk_add_f32 v[20:21], v[20:21], v[28:29]
  v_pk_add_f32 v[22:23], v[22:23], v[30:31]
  s_waitcnt lgkmcnt(0)
  v_pk_add_f32 v[32:33], v[32:33], v[40:41]
  v_pk_add_f32 v[34:35], v[34:35], v[42:43]
  v_pk_add_f32 v[36:37], v[36:37], v[44:45]
  v_pk_add_f32 v[38:39], v[38:39], v[46:47]
  v_pk_add_f32 v[16:17], v[16:17], v[32:33]
  v_pk_add_f32 v[18:19], v[18:19], v[34:35]
  v_pk_add_f32 v[20:21], v[20:21], v[36:37]
  v_pk_add_f32 v[22:23], v[22:23], v[38:39]
  v_cvt_pk_bf16_f32 v28, v16, v17
  v_cvt_pk_bf16_f32 v29, v18, v19
  v_cvt_pk_bf16_f32 v30, v20, v21
  v_cvt_pk_bf16_f32 v31, v22, v23
  v_cndmask_b32 v24, v28, v30, s[56:57]
  v_cndmask_b32 v25, v29, v31, s[56:57]
  v_cndmask_b32 v26, v30, v28, s[56:57]
  v_cndmask_b32 v27, v31, v29, s[56:57]
  buffer_store_dwordx4 v[24:27], v6, s[32:35], s58 offen nt
  s_endpgm
.fill 28, 4, 0xBF800000
G_L4:
  s_waitcnt lgkmcnt(4)
  v_mfma_f32_16x16x32_bf16 v[32:35], v[24:27], v[128:131], 0
  s_barrier
  ds_read_b64_tr_b16 v[20:21], v7 offset:28672
  v_mfma_f32_16x16x32_bf16 v[36:39], v[24:27], v[132:135], 0
  ds_read_b64_tr_b16 v[22:23], v7 offset:28928
  v_cvt_pk_bf16_f32 v58, v60, v61
  v_cvt_pk_bf16_f32 v59, v62, v63
  v_mfma_f32_16x16x32_bf16 v[40:43], v[28:31], v[128:131], 0
  ds_read_b64_tr_b16 v[24:25], v8 offset:28672
  ds_read_b64_tr_b16 v[26:27], v8 offset:28928
  v_mfma_f32_16x16x32_bf16 v[44:47], v[28:31], v[132:135], 0
  v_permlane16_swap_b32 v56, v58
  v_permlane16_swap_b32 v57, v59
  s_waitcnt lgkmcnt(4)
  v_mfma_f32_16x16x32_bf16 v[32:35], v[12:15], v[136:139], v[32:35]
  ds_read_b64_tr_b16 v[28:29], v7 offset:29696
  ds_read_b64_tr_b16 v[30:31], v7 offset:29952
  v_mfma_f32_16x16x32_bf16 v[36:39], v[12:15], v[140:143], v[36:39]
  v_or_b32 v56, s91, v56
  buffer_store_dwordx4 v[56:59], v0, s[4:7], s79 offen sc1
  v_mfma_f32_16x16x32_bf16 v[40:43], v[16:19], v[136:139], v[40:43]
  ds_read_b64_tr_b16 v[12:13], v8 offset:29696
  ds_read_b64_tr_b16 v[14:15], v8 offset:29952
  v_cvt_pk_bf16_f32 v64, v64, v65
  v_mfma_f32_16x16x32_bf16 v[44:47], v[16:19], v[140:143], v[44:47]
  v_cvt_pk_bf16_f32 v65, v66, v67
  v_cvt_pk_bf16_f32 v66, v68, v69
  v_cvt_pk_bf16_f32 v67, v70, v71
  s_waitcnt lgkmcnt(4)
  v_mfma_f32_16x16x32_bf16 v[80:83], v[20:23], v[144:147], v[80:83]
  ds_read_b64_tr_b16 v[16:17], v7 offset:31744
  ds_read_b64_tr_b16 v[18:19], v7 offset:32000
  v_permlane16_swap_b32 v64, v66
  v_mfma_f32_16x16x32_bf16 v[84:87], v[20:23], v[148:151], v[84:87]
  v_permlane16_swap_b32 v65, v67
  v_or_b32 v64, s92, v64
  buffer_store_dwordx4 v[64:67], v0, s[4:7], s80 offen sc1
  v_mfma_f32_16x16x32_bf16 v[96:99], v[24:27], v[144:147], v[96:99]
  ds_read_b64_tr_b16 v[20:21], v8 offset:31744
  ds_read_b64_tr_b16 v[22:23], v8 offset:32000
  v_cvt_pk_bf16_f32 v72, v72, v73
  v_mfma_f32_16x16x32_bf16 v[100:103], v[24:27], v[148:151], v[100:103]
  v_cvt_pk_bf16_f32 v73, v74, v75
  v_cvt_pk_bf16_f32 v74, v76, v77
  s_waitcnt lgkmcnt(4)
  v_mfma_f32_16x16x32_bf16 v[112:115], v[28:31], v[144:147], v[112:115]
  ds_read_b64_tr_b16 v[24:25], v7 offset:32768
  ds_read_b64_tr_b16 v[26:27], v7 offset:33024
  v_mfma_f32_16x16x32_bf16 v[116:119], v[28:31], v[148:151], v[116:119]
  v_cvt_pk_bf16_f32 v75, v78, v79
  v_permlane16_swap_b32 v72, v74
  s_nop 0
  v_permlane16_swap_b32 v73, v75
  v_mfma_f32_16x16x32_bf16 v[32:35], v[12:15], v[144:147], v[32:35]
  ds_read_b64_tr_b16 v[28:29], v8 offset:32768
  ds_read_b64_tr_b16 v[30:31], v8 offset:33024
  v_mfma_f32_16x16x32_bf16 v[36:39], v[12:15], v[148:151], v[36:39]
  v_or_b32_e64 v72, s92, v72
  buffer_store_dwordx4 v[72:75], v0, s[4:7], s81 offen sc1
  s_waitcnt lgkmcnt(4)
  v_mfma_f32_16x16x32_bf16 v[88:91], v[16:19], v[144:147], v[88:91]
  ds_read_b64_tr_b16 v[12:13], v7 offset:40960
  ds_read_b64_tr_b16 v[14:15], v7 offset:41216
  v_mfma_f32_16x16x32_bf16 v[92:95], v[16:19], v[148:151], v[92:95]
  v_mfma_f32_16x16x32_bf16 v[104:107], v[20:23], v[144:147], v[104:107]
  ds_read_b64_tr_b16 v[16:17], v8 offset:40960
  ds_read_b64_tr_b16 v[18:19], v8 offset:41216
  v_mfma_f32_16x16x32_bf16 v[108:111], v[20:23], v[148:151], v[108:111]
  s_waitcnt lgkmcnt(4)
  v_mfma_f32_16x16x32_bf16 v[120:123], v[24:27], v[144:147], v[120:123]
  ds_read_b64_tr_b16 v[20:21], v7 offset:41984
  ds_read_b64_tr_b16 v[22:23], v7 offset:42240
  v_mfma_f32_16x16x32_bf16 v[124:127], v[24:27], v[148:151], v[124:127]
  v_mov_b32 v6, 162304
  v_mfma_f32_16x16x32_bf16 v[40:43], v[28:31], v[144:147], v[40:43]
  ds_read_b64_tr_b16 v[24:25], v8 offset:41984
  ds_read_b64_tr_b16 v[26:27], v8 offset:42240
  v_mfma_f32_16x16x32_bf16 v[44:47], v[28:31], v[148:151], v[44:47]
  s_and_b32 s50, s46, 1
  s_waitcnt lgkmcnt(4)
  v_mfma_f32_16x16x32_bf16 v[80:83], v[12:15], v[152:155], v[80:83]
  ds_read_b64_tr_b16 v[28:29], v7 offset:44032
  ds_read_b64_tr_b16 v[30:31], v7 offset:44288
  v_mfma_f32_16x16x32_bf16 v[84:87], v[12:15], v[156:159], v[84:87]
  v_mfma_f32_16x16x32_bf16 v[96:99], v[16:19], v[152:155], v[96:99]
  ds_read_b64_tr_b16 v[12:13], v8 offset:44032
  ds_read_b64_tr_b16 v[14:15], v8 offset:44288
  v_mfma_f32_16x16x32_bf16 v[100:103], v[16:19], v[156:159], v[100:103]
  s_lshl_b32 s50, s50, 2
  s_waitcnt lgkmcnt(4)
  v_mfma_f32_16x16x32_bf16 v[112:115], v[20:23], v[152:155], v[112:115]
  ds_read_b64_tr_b16 v[16:17], v7 offset:45056
  ds_read_b64_tr_b16 v[18:19], v7 offset:45312
  v_mfma_f32_16x16x32_bf16 v[116:119], v[20:23], v[156:159], v[116:119]
  v_mfma_f32_16x16x32_bf16 v[32:35], v[24:27], v[152:155], v[32:35]
  ds_read_b64_tr_b16 v[20:21], v8 offset:45056
  ds_read_b64_tr_b16 v[22:23], v8 offset:45312
  v_mfma_f32_16x16x32_bf16 v[36:39], v[24:27], v[156:159], v[36:39]
  s_add_u32 s50, s50, s45
  s_waitcnt lgkmcnt(4)
  v_mfma_f32_16x16x32_bf16 v[88:91], v[28:31], v[152:155], v[88:91]
  s_barrier
  ds_read_b64_tr_b16 v[24:25], v9 offset:0
  v_mfma_f32_16x16x32_bf16 v[92:95], v[28:31], v[156:159], v[92:95]
  ds_read_b64_tr_b16 v[26:27], v9 offset:256
  v_mfma_f32_16x16x32_bf16 v[104:107], v[12:15], v[152:155], v[104:107]
  ds_read_b64_tr_b16 v[28:29], v10 offset:0
  ds_read_b64_tr_b16 v[30:31], v10 offset:256
  v_mfma_f32_16x16x32_bf16 v[108:111], v[12:15], v[156:159], v[108:111]
  s_lshl_b32 s50, s50, 7
  s_waitcnt lgkmcnt(4)
  v_mfma_f32_16x16x32_bf16 v[120:123], v[16:19], v[152:155], v[120:123]
  ds_read_b64_tr_b16 v[12:13], v9 offset:1024
  ds_read_b64_tr_b16 v[14:15], v9 offset:1280
  v_mfma_f32_16x16x32_bf16 v[124:127], v[16:19], v[156:159], v[124:127]
  s_add_u32 s50, s50, 160768
  v_mfma_f32_16x16x32_bf16 v[40:43], v[20:23], v[152:155], v[40:43]
  ds_read_b64_tr_b16 v[16:17], v10 offset:1024
  ds_read_b64_tr_b16 v[18:19], v10 offset:1280
  v_mfma_f32_16x16x32_bf16 v[44:47], v[20:23], v[156:159], v[44:47]
  s_waitcnt lgkmcnt(4)
  v_mfma_f32_16x16x32_bf16 v[80:83], v[24:27], v[160:163], v[80:83]
  ds_read_b64_tr_b16 v[20:21], v9 offset:3072
  ds_read_b64_tr_b16 v[22:23], v9 offset:3328
  v_mfma_f32_16x16x32_bf16 v[84:87], v[24:27], v[164:167], v[84:87]
  v_bfe_u32 v3, v0, 4, 4
  v_mfma_f32_16x16x32_bf16 v[96:99], v[28:31], v[160:163], v[96:99]
  ds_read_b64_tr_b16 v[24:25], v10 offset:3072
  ds_read_b64_tr_b16 v[26:27], v10 offset:3328
  v_mfma_f32_16x16x32_bf16 v[100:103], v[28:31], v[164:167], v[100:103]
  s_waitcnt lgkmcnt(4)
  v_mfma_f32_16x16x32_bf16 v[112:115], v[12:15], v[160:163], v[112:115]
  ds_read_b64_tr_b16 v[28:29], v9 offset:4096
  ds_read_b64_tr_b16 v[30:31], v9 offset:4352
  v_mfma_f32_16x16x32_bf16 v[116:119], v[12:15], v[164:167], v[116:119]
  v_lshl_add_u32 v3, v3, 2, s50
  v_mfma_f32_16x16x32_bf16 v[32:35], v[16:19], v[160:163], v[32:35]
  ds_read_b64_tr_b16 v[12:13], v10 offset:4096
  ds_read_b64_tr_b16 v[14:15], v10 offset:4352
  v_mfma_f32_16x16x32_bf16 v[36:39], v[16:19], v[164:167], v[36:39]
  s_waitcnt lgkmcnt(4)
  v_mfma_f32_16x16x32_bf16 v[88:91], v[20:23], v[160:163], v[88:91]
  ds_read_b64_tr_b16 v[16:17], v9 offset:12288
  ds_read_b64_tr_b16 v[18:19], v9 offset:12544
  v_mfma_f32_16x16x32_bf16 v[92:95], v[20:23], v[164:167], v[92:95]
  v_mfma_f32_16x16x32_bf16 v[104:107], v[24:27], v[160:163], v[104:107]
  ds_read_b64_tr_b16 v[20:21], v10 offset:12288
  ds_read_b64_tr_b16 v[22:23], v10 offset:12544
  v_mfma_f32_16x16x32_bf16 v[108:111], v[24:27], v[164:167], v[108:111]
  s_waitcnt lgkmcnt(4)
  v_mfma_f32_16x16x32_bf16 v[120:123], v[28:31], v[160:163], v[120:123]
  ds_read_b64_tr_b16 v[24:25], v9 offset:13312
  ds_read_b64_tr_b16 v[26:27], v9 offset:13568
  v_mfma_f32_16x16x32_bf16 v[124:127], v[28:31], v[164:167], v[124:127]
  v_mfma_f32_16x16x32_bf16 v[40:43], v[12:15], v[160:163], v[40:43]
  ds_read_b64_tr_b16 v[28:29], v10 offset:13312
  ds_read_b64_tr_b16 v[30:31], v10 offset:13568
  v_mfma_f32_16x16x32_bf16 v[44:47], v[12:15], v[164:167], v[44:47]
  s_waitcnt lgkmcnt(4)
  v_mfma_f32_16x16x32_bf16 v[80:83], v[16:19], v[168:171], v[80:83]
  ds_read_b64_tr_b16 v[12:13], v9 offset:15360
  ds_read_b64_tr_b16 v[14:15], v9 offset:15616
  v_mfma_f32_16x16x32_bf16 v[84:87], v[16:19], v[172:175], v[84:87]
  v_mfma_f32_16x16x32_bf16 v[96:99], v[20:23], v[168:171], v[96:99]
  ds_read_b64_tr_b16 v[16:17], v10 offset:15360
  ds_read_b64_tr_b16 v[18:19], v10 offset:15616
  v_mfma_f32_16x16x32_bf16 v[100:103], v[20:23], v[172:175], v[100:103]
  s_waitcnt lgkmcnt(4)
  v_mfma_f32_16x16x32_bf16 v[112:115], v[24:27], v[168:171], v[112:115]
  ds_read_b64_tr_b16 v[20:21], v9 offset:16384
  ds_read_b64_tr_b16 v[22:23], v9 offset:16640
  v_mfma_f32_16x16x32_bf16 v[116:119], v[24:27], v[172:175], v[116:119]
  v_mfma_f32_16x16x32_bf16 v[32:35], v[28:31], v[168:171], v[32:35]
  ds_read_b64_tr_b16 v[24:25], v10 offset:16384
  ds_read_b64_tr_b16 v[26:27], v10 offset:16640
  v_mfma_f32_16x16x32_bf16 v[36:39], v[28:31], v[172:175], v[36:39]
  s_waitcnt lgkmcnt(4)
  v_mfma_f32_16x16x32_bf16 v[88:91], v[12:15], v[168:171], v[88:91]
  s_barrier
  ds_read_b64_tr_b16 v[28:29], v9 offset:28672
  v_mfma_f32_16x16x32_bf16 v[92:95], v[12:15], v[172:175], v[92:95]
  ds_read_b64_tr_b16 v[30:31], v9 offset:28928
  v_mfma_f32_16x16x32_bf16 v[104:107], v[16:19], v[168:171], v[104:107]
  ds_read_b64_tr_b16 v[12:13], v10 offset:28672
  ds_read_b64_tr_b16 v[14:15], v10 offset:28928
  v_mfma_f32_16x16x32_bf16 v[108:111], v[16:19], v[172:175], v[108:111]
  s_waitcnt lgkmcnt(4)
  v_mfma_f32_16x16x32_bf16 v[120:123], v[20:23], v[168:171], v[120:123]
  ds_read_b64_tr_b16 v[16:17], v9 offset:29696
  ds_read_b64_tr_b16 v[18:19], v9 offset:29952
  v_mfma_f32_16x16x32_bf16 v[124:127], v[20:23], v[172:175], v[124:127]
  v_mfma_f32_16x16x32_bf16 v[40:43], v[24:27], v[168:171], v[40:43]
  ds_read_b64_tr_b16 v[20:21], v10 offset:29696
  ds_read_b64_tr_b16 v[22:23], v10 offset:29952
  v_mfma_f32_16x16x32_bf16 v[44:47], v[24:27], v[172:175], v[44:47]
  s_waitcnt lgkmcnt(4)
  v_mfma_f32_16x16x32_bf16 v[80:83], v[28:31], v[176:179], v[80:83]
  ds_read_b64_tr_b16 v[24:25], v9 offset:31744
  ds_read_b64_tr_b16 v[26:27], v9 offset:32000
  s_lshl_b32 s50, s46, 4
  s_add_u32 s50, s50, s47
  s_lshl_b32 s50, s50, 5
  s_add_u32 s50, s50, s45
  v_mfma_f32_16x16x32_bf16 v[84:87], v[28:31], v[180:183], v[84:87]
  s_lshl_b32 s50, s50, 2
  s_add_u32 s50, s50, 14680064
  v_mov_b32_e64 v5, 1
  s_mov_b64 exec, 1
  s_waitcnt vmcnt(0)
  buffer_store_dword v5, off, s[4:7], s50 sc1
  s_mov_b64 exec, -1
  v_mfma_f32_16x16x32_bf16 v[96:99], v[12:15], v[176:179], v[96:99]
  ds_read_b64_tr_b16 v[28:29], v10 offset:31744
  ds_read_b64_tr_b16 v[30:31], v10 offset:32000
  v_mfma_f32_16x16x32_bf16 v[100:103], v[12:15], v[180:183], v[100:103]
  s_waitcnt lgkmcnt(4)
  v_mfma_f32_16x16x32_bf16 v[112:115], v[16:19], v[176:179], v[112:115]
  ds_read_b64_tr_b16 v[12:13], v9 offset:32768
  ds_read_b64_tr_b16 v[14:15], v9 offset:33024
  v_mfma_f32_16x16x32_bf16 v[116:119], v[16:19], v[180:183], v[116:119]
  v_lshrrev_b32_e64 v147, 4, v0
  v_bfe_u32 v162, v147, 4, 1
  v_mfma_f32_16x16x32_bf16 v[32:35], v[20:23], v[176:179], v[32:35]
  ds_read_b64_tr_b16 v[16:17], v10 offset:32768
  ds_read_b64_tr_b16 v[18:19], v10 offset:33024
  v_mfma_f32_16x16x32_bf16 v[36:39], v[20:23], v[180:183], v[36:39]
  v_lshlrev_b32 v162, 2, v162
  s_waitcnt lgkmcnt(4)
  v_mfma_f32_16x16x32_bf16 v[88:91], v[24:27], v[176:179], v[88:91]
  ds_read_b64_tr_b16 v[20:21], v9 offset:40960
  ds_read_b64_tr_b16 v[22:23], v9 offset:41216
  v_mfma_f32_16x16x32_bf16 v[92:95], v[24:27], v[180:183], v[92:95]
  v_and_b32 v163, 7, v147
  v_xor_b32 v162, v162, v163
  v_mfma_f32_16x16x32_bf16 v[104:107], v[28:31], v[176:179], v[104:107]
  ds_read_b64_tr_b16 v[24:25], v10 offset:40960
  ds_read_b64_tr_b16 v[26:27], v10 offset:41216
  v_mfma_f32_16x16x32_bf16 v[108:111], v[28:31], v[180:183], v[108:111]
  v_lshlrev_b32 v162, 4, v162
  s_waitcnt lgkmcnt(4)
  v_mfma_f32_16x16x32_bf16 v[120:123], v[12:15], v[176:179], v[120:123]
  ds_read_b64_tr_b16 v[28:29], v9 offset:41984
  ds_read_b64_tr_b16 v[30:31], v9 offset:42240
  v_mfma_f32_16x16x32_bf16 v[124:127], v[12:15], v[180:183], v[124:127]
  v_lshrrev_b32_e64 v163, 3, v147
  v_mfma_f32_16x16x32_bf16 v[40:43], v[16:19], v[176:179], v[40:43]
  ds_read_b64_tr_b16 v[12:13], v10 offset:41984
  ds_read_b64_tr_b16 v[14:15], v10 offset:42240
  v_mfma_f32_16x16x32_bf16 v[44:47], v[16:19], v[180:183], v[44:47]
  v_lshl_add_u32 v148, v163, 10, v162
  v_add_u32 v148, s99, v148
  s_waitcnt lgkmcnt(4)
  v_mfma_f32_16x16x32_bf16 v[80:83], v[20:23], v[184:187], v[80:83]
  ds_read_b64_tr_b16 v[16:17], v9 offset:44032
  ds_read_b64_tr_b16 v[18:19], v9 offset:44288
  v_mfma_f32_16x16x32_bf16 v[84:87], v[20:23], v[188:191], v[84:87]
  v_add_u32 v149, 8192, v148
  v_mfma_f32_16x16x32_bf16 v[96:99], v[24:27], v[184:187], v[96:99]
  ds_read_b64_tr_b16 v[20:21], v10 offset:44032
  ds_read_b64_tr_b16 v[22:23], v10 offset:44288
  v_mfma_f32_16x16x32_bf16 v[100:103], v[24:27], v[188:191], v[100:103]
  v_lshrrev_b32 v163, 5, v147
  s_waitcnt lgkmcnt(4)
  v_mfma_f32_16x16x32_bf16 v[112:115], v[28:31], v[184:187], v[112:115]
  ds_read_b64_tr_b16 v[24:25], v9 offset:45056
  ds_read_b64_tr_b16 v[26:27], v9 offset:45312
  v_mfma_f32_16x16x32_bf16 v[116:119], v[28:31], v[188:191], v[116:119]
  v_lshl_add_u32 v158, v163, 12, v148
  v_add_u32 v159, 4096, v158
  v_mfma_f32_16x16x32_bf16 v[32:35], v[12:15], v[184:187], v[32:35]
  ds_read_b64_tr_b16 v[28:29], v10 offset:45056
  ds_read_b64_tr_b16 v[30:31], v10 offset:45312
  v_mfma_f32_16x16x32_bf16 v[36:39], v[12:15], v[188:191], v[36:39]
  v_lshrrev_b32 v162, 5, v147
  s_waitcnt lgkmcnt(4)
  v_mfma_f32_16x16x32_bf16 v[88:91], v[16:19], v[184:187], v[88:91]
  s_barrier
  ds_read_b64_tr_b16 v[12:13], v7 offset:0
  v_mfma_f32_16x16x32_bf16 v[92:95], v[16:19], v[188:191], v[92:95]
  ds_read_b64_tr_b16 v[14:15], v7 offset:256
  v_bfe_u32 v163, v147, 2, 2
  v_mfma_f32_16x16x32_bf16 v[104:107], v[20:23], v[184:187], v[104:107]
  ds_read_b64_tr_b16 v[16:17], v8 offset:0
  ds_read_b64_tr_b16 v[18:19], v8 offset:256
  v_mfma_f32_16x16x32_bf16 v[108:111], v[20:23], v[188:191], v[108:111]
  v_lshl_add_u32 v162, v162, 2, v163
  v_lshlrev_b32_e64 v150, 7, v162
  s_waitcnt lgkmcnt(4)
  v_mfma_f32_16x16x32_bf16 v[120:123], v[24:27], v[184:187], v[120:123]
  ds_read_b64_tr_b16 v[20:21], v7 offset:1024
  ds_read_b64_tr_b16 v[22:23], v7 offset:1280
  v_mfma_f32_16x16x32_bf16 v[124:127], v[24:27], v[188:191], v[124:127]
  v_bfe_u32 v162, v147, 3, 1
  v_mfma_f32_16x16x32_bf16 v[40:43], v[28:31], v[184:187], v[40:43]
  ds_read_b64_tr_b16 v[24:25], v8 offset:1024
  ds_read_b64_tr_b16 v[26:27], v8 offset:1280
  v_mfma_f32_16x16x32_bf16 v[44:47], v[28:31], v[188:191], v[44:47]
  v_lshl_add_u32 v150, v162, 6, v150
  s_waitcnt lgkmcnt(4)
  v_mfma_f32_16x16x32_bf16 v[80:83], v[12:15], v[192:195], v[80:83]
  ds_read_b64_tr_b16 v[28:29], v7 offset:3072
  ds_read_b64_tr_b16 v[30:31], v7 offset:3328
  v_mfma_f32_16x16x32_bf16 v[84:87], v[12:15], v[196:199], v[84:87]
  v_bfe_u32 v162, v147, 4, 1
  v_lshl_add_u32 v150, v162, 5, v150
  v_mfma_f32_16x16x32_bf16 v[96:99], v[16:19], v[192:195], v[96:99]
  ds_read_b64_tr_b16 v[12:13], v8 offset:3072
  ds_read_b64_tr_b16 v[14:15], v8 offset:3328
  v_mfma_f32_16x16x32_bf16 v[100:103], v[16:19], v[196:199], v[100:103]
  v_and_b32_e64 v162, 3, v147
  s_waitcnt lgkmcnt(4)
  v_mfma_f32_16x16x32_bf16 v[112:115], v[20:23], v[192:195], v[112:115]
  ds_read_b64_tr_b16 v[16:17], v7 offset:4096
  ds_read_b64_tr_b16 v[18:19], v7 offset:4352
  v_mfma_f32_16x16x32_bf16 v[116:119], v[20:23], v[196:199], v[116:119]
  v_lshl_add_u32 v150, v162, 3, v150
  v_mfma_f32_16x16x32_bf16 v[32:35], v[24:27], v[192:195], v[32:35]
  ds_read_b64_tr_b16 v[20:21], v8 offset:4096
  ds_read_b64_tr_b16 v[22:23], v8 offset:4352
  v_mfma_f32_16x16x32_bf16 v[36:39], v[24:27], v[196:199], v[36:39]
  v_add_u32_e64 v150, s98, v150
  v_add_u32 v152, 65536, v150
  s_waitcnt lgkmcnt(4)
  v_mfma_f32_16x16x32_bf16 v[88:91], v[28:31], v[192:195], v[88:91]
  ds_read_b64_tr_b16 v[24:25], v7 offset:12288
  ds_read_b64_tr_b16 v[26:27], v7 offset:12544
  v_mfma_f32_16x16x32_bf16 v[92:95], v[28:31], v[196:199], v[92:95]
  v_add_u32 v154, 131072, v150
  v_mfma_f32_16x16x32_bf16 v[104:107], v[12:15], v[192:195], v[104:107]
  ds_read_b64_tr_b16 v[28:29], v8 offset:12288
  ds_read_b64_tr_b16 v[30:31], v8 offset:12544
  v_mfma_f32_16x16x32_bf16 v[108:111], v[12:15], v[196:199], v[108:111]
  v_xor_b32_e64 v151, 64, v150
  s_waitcnt lgkmcnt(4)
  v_mfma_f32_16x16x32_bf16 v[120:123], v[16:19], v[192:195], v[120:123]
  ds_read_b64_tr_b16 v[12:13], v7 offset:13312
  ds_read_b64_tr_b16 v[14:15], v7 offset:13568
  v_mfma_f32_16x16x32_bf16 v[124:127], v[16:19], v[196:199], v[124:127]
  v_xor_b32 v153, 64, v152
  v_xor_b32 v155, 64, v154
  v_mfma_f32_16x16x32_bf16 v[40:43], v[20:23], v[192:195], v[40:43]
  ds_read_b64_tr_b16 v[16:17], v8 offset:13312
  ds_read_b64_tr_b16 v[18:19], v8 offset:13568
  v_mfma_f32_16x16x32_bf16 v[44:47], v[20:23], v[196:199], v[44:47]
  s_mul_i32 s50, s53, 176128
  s_waitcnt lgkmcnt(4)
  v_mfma_f32_16x16x32_bf16 v[80:83], v[24:27], v[200:203], v[80:83]
  ds_read_b64_tr_b16 v[20:21], v7 offset:15360
  ds_read_b64_tr_b16 v[22:23], v7 offset:15616
  v_mfma_f32_16x16x32_bf16 v[84:87], v[24:27], v[204:207], v[84:87]
  s_add_u32 s50, s50, s98
  v_mfma_f32_16x16x32_bf16 v[96:99], v[28:31], v[200:203], v[96:99]
  ds_read_b64_tr_b16 v[24:25], v8 offset:15360
  ds_read_b64_tr_b16 v[26:27], v8 offset:15616
  v_mfma_f32_16x16x32_bf16 v[100:103], v[28:31], v[204:207], v[100:103]
  s_add_u32 s50, s50, 6291456
  v_add_u32 v156, s50, v0
  s_waitcnt lgkmcnt(4)
  v_mfma_f32_16x16x32_bf16 v[112:115], v[12:15], v[200:203], v[112:115]
  ds_read_b64_tr_b16 v[28:29], v7 offset:16384
  ds_read_b64_tr_b16 v[30:31], v7 offset:16640
  v_mfma_f32_16x16x32_bf16 v[116:119], v[12:15], v[204:207], v[116:119]
  v_add_u32 v157, 88064, v156
  v_mfma_f32_16x16x32_bf16 v[32:35], v[16:19], v[200:203], v[32:35]
  ds_read_b64_tr_b16 v[12:13], v8 offset:16384
  ds_read_b64_tr_b16 v[14:15], v8 offset:16640
  v_mfma_f32_16x16x32_bf16 v[36:39], v[16:19], v[204:207], v[36:39]
  s_lshl_b32 s50, s46, 2
  s_waitcnt lgkmcnt(4)
  v_mfma_f32_16x16x32_bf16 v[88:91], v[20:23], v[200:203], v[88:91]
  s_barrier
  ds_read_b64_tr_b16 v[16:17], v7 offset:28672
  v_mfma_f32_16x16x32_bf16 v[92:95], v[20:23], v[204:207], v[92:95]
  ds_read_b64_tr_b16 v[18:19], v7 offset:28928
  s_add_u32 s50, s50, s45
  s_mul_i32 s56, s50, 88064
  v_mfma_f32_16x16x32_bf16 v[104:107], v[24:27], v[200:203], v[104:107]
  ds_read_b64_tr_b16 v[20:21], v8 offset:28672
  ds_read_b64_tr_b16 v[22:23], v8 offset:28928
  v_mfma_f32_16x16x32_bf16 v[108:111], v[24:27], v[204:207], v[108:111]
  s_lshl_b32 s50, s48, 11
  s_waitcnt lgkmcnt(4)
  v_mfma_f32_16x16x32_bf16 v[120:123], v[28:31], v[200:203], v[120:123]
  ds_read_b64_tr_b16 v[24:25], v7 offset:29696
  ds_read_b64_tr_b16 v[26:27], v7 offset:29952
  v_mfma_f32_16x16x32_bf16 v[124:127], v[28:31], v[204:207], v[124:127]
  s_add_u32 s56, s56, s50
  v_mfma_f32_16x16x32_bf16 v[40:43], v[12:15], v[200:203], v[40:43]
  ds_read_b64_tr_b16 v[28:29], v8 offset:29696
  ds_read_b64_tr_b16 v[30:31], v8 offset:29952
  v_mfma_f32_16x16x32_bf16 v[44:47], v[12:15], v[204:207], v[44:47]
  s_add_u32 s56, s56, 6291456
  s_add_u32 s58, s56, 4096
  s_waitcnt lgkmcnt(4)
  v_mfma_f32_16x16x32_bf16 v[80:83], v[16:19], v[208:211], v[80:83]
  ds_read_b64_tr_b16 v[12:13], v7 offset:31744
  ds_read_b64_tr_b16 v[14:15], v7 offset:32000
  v_mfma_f32_16x16x32_bf16 v[84:87], v[16:19], v[212:215], v[84:87]
  s_mov_b32 s55, 0xbfb8aa3b
  v_mfma_f32_16x16x32_bf16 v[96:99], v[20:23], v[208:211], v[96:99]
  ds_read_b64_tr_b16 v[16:17], v8 offset:31744
  ds_read_b64_tr_b16 v[18:19], v8 offset:32000
  v_mfma_f32_16x16x32_bf16 v[100:103], v[20:23], v[212:215], v[100:103]
  s_lshl_b32 s50, s45, 5
  s_waitcnt lgkmcnt(4)
  v_mfma_f32_16x16x32_bf16 v[112:115], v[24:27], v[208:211], v[112:115]
  ds_read_b64_tr_b16 v[20:21], v7 offset:32768
  ds_read_b64_tr_b16 v[22:23], v7 offset:33024
  v_mfma_f32_16x16x32_bf16 v[116:119], v[24:27], v[212:215], v[116:119]
  s_add_u32 s50, s50, s53
  s_lshl_b32 s50, s50, 11
  v_mfma_f32_16x16x32_bf16 v[32:35], v[28:31], v[208:211], v[32:35]
  ds_read_b64_tr_b16 v[24:25], v8 offset:32768
  ds_read_b64_tr_b16 v[26:27], v8 offset:33024
  v_mfma_f32_16x16x32_bf16 v[36:39], v[28:31], v[212:215], v[36:39]
  v_add_u32 v160, s50, v0
  s_waitcnt lgkmcnt(4)
  v_mfma_f32_16x16x32_bf16 v[88:91], v[12:15], v[208:211], v[88:91]
  ds_read_b64_tr_b16 v[28:29], v7 offset:40960
  ds_read_b64_tr_b16 v[30:31], v7 offset:41216
  v_mfma_f32_16x16x32_bf16 v[92:95], v[12:15], v[212:215], v[92:95]
  v_mov_b32_e64 v1, 1
  v_mfma_f32_16x16x32_bf16 v[104:107], v[16:19], v[208:211], v[104:107]
  ds_read_b64_tr_b16 v[12:13], v8 offset:40960
  ds_read_b64_tr_b16 v[14:15], v8 offset:41216
  v_mfma_f32_16x16x32_bf16 v[108:111], v[16:19], v[212:215], v[108:111]
  v_and_b32_e64 v162, 31, v147
  v_lshlrev_b32 v146, 2, v162
  s_waitcnt lgkmcnt(4)
  v_mfma_f32_16x16x32_bf16 v[120:123], v[20:23], v[208:211], v[120:123]
  ds_read_b64_tr_b16 v[16:17], v7 offset:41984
  ds_read_b64_tr_b16 v[18:19], v7 offset:42240
  v_mfma_f32_16x16x32_bf16 v[124:127], v[20:23], v[212:215], v[124:127]
  s_lshl_b32 s61, s53, 7
  v_mfma_f32_16x16x32_bf16 v[40:43], v[24:27], v[208:211], v[40:43]
  ds_read_b64_tr_b16 v[20:21], v8 offset:41984
  ds_read_b64_tr_b16 v[22:23], v8 offset:42240
  v_mfma_f32_16x16x32_bf16 v[44:47], v[24:27], v[212:215], v[44:47]
  s_add_u32 s61, s61, 14712832
  s_waitcnt lgkmcnt(4)
  v_mfma_f32_16x16x32_bf16 v[80:83], v[28:31], v[216:219], v[80:83]
  ds_read_b64_tr_b16 v[24:25], v7 offset:44032
  ds_read_b64_tr_b16 v[26:27], v7 offset:44288
  v_mfma_f32_16x16x32_bf16 v[84:87], v[28:31], v[220:223], v[84:87]
  v_mfma_f32_16x16x32_bf16 v[96:99], v[12:15], v[216:219], v[96:99]
  ds_read_b32 v2, v6 offset:4
  ds_read_b64_tr_b16 v[28:29], v8 offset:44032
  v_mfma_f32_16x16x32_bf16 v[100:103], v[12:15], v[220:223], v[100:103]
  ds_read_b64_tr_b16 v[30:31], v8 offset:44288
  s_waitcnt lgkmcnt(5)
  v_mfma_f32_16x16x32_bf16 v[112:115], v[16:19], v[216:219], v[112:115]
  ds_read_b64_tr_b16 v[12:13], v7 offset:45056
  ds_read_b64_tr_b16 v[14:15], v7 offset:45312
  v_mfma_f32_16x16x32_bf16 v[116:119], v[16:19], v[220:223], v[116:119]
  v_mfma_f32_16x16x32_bf16 v[32:35], v[20:23], v[216:219], v[32:35]
  ds_read_b64_tr_b16 v[16:17], v8 offset:45056
  ds_read_b64_tr_b16 v[18:19], v8 offset:45312
  v_mfma_f32_16x16x32_bf16 v[36:39], v[20:23], v[220:223], v[36:39]
  s_waitcnt lgkmcnt(4)
  v_mfma_f32_16x16x32_bf16 v[88:91], v[24:27], v[216:219], v[88:91]
  v_cmp_ne_u32 vcc, 4, v2
  v_mfma_f32_16x16x32_bf16 v[92:95], v[24:27], v[220:223], v[92:95]
  s_cbranch_vccnz G_W14L
G_R14L:
  ds_read_b64_tr_b16 v[20:21], v9 offset:0
  ds_read_b64_tr_b16 v[22:23], v9 offset:256
  v_mfma_f32_16x16x32_bf16 v[104:107], v[28:31], v[216:219], v[104:107]
  ds_read_b64_tr_b16 v[24:25], v10 offset:0
  ds_read_b64_tr_b16 v[26:27], v10 offset:256
  v_mfma_f32_16x16x32_bf16 v[108:111], v[28:31], v[220:223], v[108:111]
  s_waitcnt lgkmcnt(4)
  v_mfma_f32_16x16x32_bf16 v[120:123], v[12:15], v[216:219], v[120:123]
  ds_read_b64_tr_b16 v[28:29], v9 offset:1024
  ds_read_b64_tr_b16 v[30:31], v9 offset:1280
  v_mfma_f32_16x16x32_bf16 v[124:127], v[12:15], v[220:223], v[124:127]
  v_mfma_f32_16x16x32_bf16 v[40:43], v[16:19], v[216:219], v[40:43]
  ds_read_b64_tr_b16 v[12:13], v10 offset:1024
  ds_read_b64_tr_b16 v[14:15], v10 offset:1280
  v_mfma_f32_16x16x32_bf16 v[44:47], v[16:19], v[220:223], v[44:47]
  s_waitcnt lgkmcnt(4)
  v_mfma_f32_16x16x32_bf16 v[80:83], v[20:23], v[224:227], v[80:83]
  ds_read_b64_tr_b16 v[16:17], v9 offset:3072
  ds_read_b64_tr_b16 v[18:19], v9 offset:3328
  v_mfma_f32_16x16x32_bf16 v[84:87], v[20:23], v[228:231], v[84:87]
  ds_read_b64_tr_b16 v[164:165], v152 offset:49152
  ds_read_b64_tr_b16 v[166:167], v152 offset:53248
  v_mfma_f32_16x16x32_bf16 v[96:99], v[24:27], v[224:227], v[96:99]
  ds_read_b64_tr_b16 v[20:21], v10 offset:3072
  ds_read_b64_tr_b16 v[22:23], v10 offset:3328
  v_mfma_f32_16x16x32_bf16 v[100:103], v[24:27], v[228:231], v[100:103]
  ds_read_b64_tr_b16 v[168:169], v153 offset:49152
  ds_read_b64_tr_b16 v[170:171], v153 offset:53248
  s_waitcnt lgkmcnt(8)
  v_mfma_f32_16x16x32_bf16 v[112:115], v[28:31], v[224:227], v[112:115]
  ds_read_b64_tr_b16 v[24:25], v9 offset:4096
  ds_read_b64_tr_b16 v[26:27], v9 offset:4352
  v_mfma_f32_16x16x32_bf16 v[116:119], v[28:31], v[228:231], v[116:119]
  ds_read_b64_tr_b16 v[172:173], v152 offset:57344
  ds_read_b64_tr_b16 v[174:175], v152 offset:61440
  v_mfma_f32_16x16x32_bf16 v[32:35], v[12:15], v[224:227], v[32:35]
  ds_read_b64_tr_b16 v[28:29], v10 offset:4096
  ds_read_b64_tr_b16 v[30:31], v10 offset:4352
  v_mfma_f32_16x16x32_bf16 v[36:39], v[12:15], v[228:231], v[36:39]
  ds_read_b64_tr_b16 v[176:177], v153 offset:57344
  ds_read_b64_tr_b16 v[178:179], v153 offset:61440
  s_waitcnt lgkmcnt(10)
  v_mfma_f32_16x16x32_bf16 v[88:91], v[16:19], v[224:227], v[88:91]
  ds_read_b64_tr_b16 v[12:13], v9 offset:12288
  ds_read_b64_tr_b16 v[14:15], v9 offset:12544
  v_mfma_f32_16x16x32_bf16 v[92:95], v[16:19], v[228:231], v[92:95]
  ds_read_b64_tr_b16 v[180:181], v154 offset:0
  ds_read_b64_tr_b16 v[182:183], v154 offset:4096
  v_mfma_f32_16x16x32_bf16 v[104:107], v[20:23], v[224:227], v[104:107]
  ds_read_b64_tr_b16 v[16:17], v10 offset:12288
  ds_read_b64_tr_b16 v[18:19], v10 offset:12544
  v_mfma_f32_16x16x32_bf16 v[108:111], v[20:23], v[228:231], v[108:111]
  ds_read_b64_tr_b16 v[184:185], v155 offset:0
  ds_read_b64_tr_b16 v[186:187], v155 offset:4096
  s_waitcnt lgkmcnt(10)
  v_mfma_f32_16x16x32_bf16 v[120:123], v[24:27], v[224:227], v[120:123]
  ds_read_b64_tr_b16 v[20:21], v9 offset:13312
  ds_read_b64_tr_b16 v[22:23], v9 offset:13568
  v_mfma_f32_16x16x32_bf16 v[124:127], v[24:27], v[228:231], v[124:127]
  ds_read_b64_tr_b16 v[188:189], v154 offset:8192
  ds_read_b64_tr_b16 v[190:191], v154 offset:12288
  v_mfma_f32_16x16x32_bf16 v[40:43], v[28:31], v[224:227], v[40:43]
  ds_read_b64_tr_b16 v[24:25], v10 offset:13312
  ds_read_b64_tr_b16 v[26:27], v10 offset:13568
  v_mfma_f32_16x16x32_bf16 v[44:47], v[28:31], v[228:231], v[44:47]
  ds_read_b64_tr_b16 v[192:193], v155 offset:8192
  ds_read_b64_tr_b16 v[194:195], v155 offset:12288
  s_waitcnt lgkmcnt(10)
  v_mfma_f32_16x16x32_bf16 v[80:83], v[12:15], v[232:235], v[80:83]
  ds_read_b64_tr_b16 v[28:29], v9 offset:15360
  ds_read_b64_tr_b16 v[30:31], v9 offset:15616
  v_mfma_f32_16x16x32_bf16 v[84:87], v[12:15], v[236:239], v[84:87]
  ds_read_b64_tr_b16 v[196:197], v154 offset:16384
  ds_read_b64_tr_b16 v[198:199], v154 offset:20480
  v_mfma_f32_16x16x32_bf16 v[96:99], v[16:19], v[232:235], v[96:99]
  ds_read_b32 v2, v6 offset:36
  ds_read_b64_tr_b16 v[12:13], v10 offset:15360
  ds_read_b64_tr_b16 v[14:15], v10 offset:15616
  v_mfma_f32_16x16x32_bf16 v[100:103], v[16:19], v[236:239], v[100:103]
  ds_read_b64_tr_b16 v[200:201], v155 offset:16384
  ds_read_b64_tr_b16 v[202:203], v155 offset:20480
  s_waitcnt lgkmcnt(11)
  v_mfma_f32_16x16x32_bf16 v[112:115], v[20:23], v[232:235], v[112:115]
  ds_read_b64_tr_b16 v[16:17], v9 offset:16384
  ds_read_b64_tr_b16 v[18:19], v9 offset:16640
  v_mfma_f32_16x16x32_bf16 v[116:119], v[20:23], v[236:239], v[116:119]
  s_mov_b64 exec, 1
  ds_add_u32 v6, v1 offset:8
  s_mov_b64 exec, -1
  v_mfma_f32_16x16x32_bf16 v[32:35], v[24:27], v[232:235], v[32:35]
  ds_read_b64_tr_b16 v[20:21], v10 offset:16384
  ds_read_b64_tr_b16 v[22:23], v10 offset:16640
  v_mfma_f32_16x16x32_bf16 v[36:39], v[24:27], v[236:239], v[36:39]
  s_waitcnt lgkmcnt(7)
  v_mfma_f32_16x16x32_bf16 v[88:91], v[28:31], v[232:235], v[88:91]
  v_cmp_ne_u32 vcc, 4, v2
  v_mfma_f32_16x16x32_bf16 v[92:95], v[28:31], v[236:239], v[92:95]
  s_cbranch_vccnz G_W15L
G_R15L:
  ds_read_b64_tr_b16 v[24:25], v9 offset:28672
  ds_read_b64_tr_b16 v[26:27], v9 offset:28928
  v_mfma_f32_16x16x32_bf16 v[104:107], v[12:15], v[232:235], v[104:107]
  ds_read_b64_tr_b16 v[28:29], v10 offset:28672
  ds_read_b64_tr_b16 v[30:31], v10 offset:28928
  v_mfma_f32_16x16x32_bf16 v[108:111], v[12:15], v[236:239], v[108:111]
  s_waitcnt lgkmcnt(4)
  v_mfma_f32_16x16x32_bf16 v[120:123], v[16:19], v[232:235], v[120:123]
  ds_read_b64_tr_b16 v[12:13], v9 offset:29696
  ds_read_b64_tr_b16 v[14:15], v9 offset:29952
  v_mfma_f32_16x16x32_bf16 v[124:127], v[16:19], v[236:239], v[124:127]
  v_mfma_f32_16x16x32_bf16 v[40:43], v[20:23], v[232:235], v[40:43]
  ds_read_b64_tr_b16 v[16:17], v10 offset:29696
  ds_read_b64_tr_b16 v[18:19], v10 offset:29952
  v_mfma_f32_16x16x32_bf16 v[44:47], v[20:23], v[236:239], v[44:47]
  s_waitcnt lgkmcnt(4)
  v_mfma_f32_16x16x32_bf16 v[80:83], v[24:27], v[240:243], v[80:83]
  ds_read_b64_tr_b16 v[20:21], v9 offset:31744
  ds_read_b64_tr_b16 v[22:23], v9 offset:32000
  v_mfma_f32_16x16x32_bf16 v[84:87], v[24:27], v[244:247], v[84:87]
  v_mfma_f32_16x16x32_bf16 v[96:99], v[28:31], v[240:243], v[96:99]
  ds_read_b64_tr_b16 v[24:25], v10 offset:31744
  ds_read_b64_tr_b16 v[26:27], v10 offset:32000
  v_mfma_f32_16x16x32_bf16 v[100:103], v[28:31], v[244:247], v[100:103]
  s_waitcnt lgkmcnt(4)
  v_mfma_f32_16x16x32_bf16 v[112:115], v[12:15], v[240:243], v[112:115]
  ds_read_b64_tr_b16 v[28:29], v9 offset:32768
  ds_read_b64_tr_b16 v[30:31], v9 offset:33024
  v_mfma_f32_16x16x32_bf16 v[116:119], v[12:15], v[244:247], v[116:119]
  v_mfma_f32_16x16x32_bf16 v[32:35], v[16:19], v[240:243], v[32:35]
  ds_read_b64_tr_b16 v[12:13], v10 offset:32768
  ds_read_b64_tr_b16 v[14:15], v10 offset:33024
  v_mfma_f32_16x16x32_bf16 v[36:39], v[16:19], v[244:247], v[36:39]
  s_waitcnt lgkmcnt(4)
  v_mfma_f32_16x16x32_bf16 v[88:91], v[20:23], v[240:243], v[88:91]
  ds_read_b64_tr_b16 v[16:17], v9 offset:40960
  ds_read_b64_tr_b16 v[18:19], v9 offset:41216
  v_mfma_f32_16x16x32_bf16 v[92:95], v[20:23], v[244:247], v[92:95]
  v_mfma_f32_16x16x32_bf16 v[104:107], v[24:27], v[240:243], v[104:107]
  ds_read_b64_tr_b16 v[20:21], v10 offset:40960
  ds_read_b64_tr_b16 v[22:23], v10 offset:41216
  v_mfma_f32_16x16x32_bf16 v[108:111], v[24:27], v[244:247], v[108:111]
  s_waitcnt lgkmcnt(4)
  v_mfma_f32_16x16x32_bf16 v[120:123], v[28:31], v[240:243], v[120:123]
  ds_read_b64_tr_b16 v[24:25], v9 offset:41984
  ds_read_b64_tr_b16 v[26:27], v9 offset:42240
  v_mfma_f32_16x16x32_bf16 v[124:127], v[28:31], v[244:247], v[124:127]
  v_mfma_f32_16x16x32_bf16 v[40:43], v[12:15], v[240:243], v[40:43]
  ds_read_b64_tr_b16 v[28:29], v10 offset:41984
  ds_read_b64_tr_b16 v[30:31], v10 offset:42240
  v_mfma_f32_16x16x32_bf16 v[44:47], v[12:15], v[244:247], v[44:47]
  s_waitcnt lgkmcnt(4)
  v_mfma_f32_16x16x32_bf16 v[80:83], v[16:19], v[248:251], v[80:83]
  ds_read_b64_tr_b16 v[12:13], v9 offset:44032
  ds_read_b64_tr_b16 v[14:15], v9 offset:44288
  v_mfma_f32_16x16x32_bf16 v[84:87], v[16:19], v[252:255], v[84:87]
  v_mfma_f32_16x16x32_bf16 v[96:99], v[20:23], v[248:251], v[96:99]
  ds_read_b64_tr_b16 v[16:17], v10 offset:44032
  ds_read_b64_tr_b16 v[18:19], v10 offset:44288
  v_mfma_f32_16x16x32_bf16 v[100:103], v[20:23], v[252:255], v[100:103]
  s_waitcnt lgkmcnt(4)
  v_mfma_f32_16x16x32_bf16 v[112:115], v[24:27], v[248:251], v[112:115]
  ds_read_b64_tr_b16 v[20:21], v9 offset:45056
  ds_read_b64_tr_b16 v[22:23], v9 offset:45312
  v_mfma_f32_16x16x32_bf16 v[116:119], v[24:27], v[252:255], v[116:119]
  v_mfma_f32_16x16x32_bf16 v[32:35], v[28:31], v[248:251], v[32:35]
  ds_read_b64_tr_b16 v[24:25], v10 offset:45056
  ds_read_b64_tr_b16 v[26:27], v10 offset:45312
  v_mfma_f32_16x16x32_bf16 v[36:39], v[28:31], v[252:255], v[36:39]
  s_waitcnt lgkmcnt(4)
  v_mfma_f32_16x16x32_bf16 v[88:91], v[12:15], v[248:251], v[88:91]
  v_mfma_f32_16x16x32_bf16 v[92:95], v[12:15], v[252:255], v[92:95]
  s_mov_b64 exec, 1
  ds_add_u32 v6, v1 offset:0
  s_mov_b64 exec, -1
  v_mfma_f32_16x16x32_bf16 v[104:107], v[16:19], v[248:251], v[104:107]
  v_mfma_f32_16x16x32_bf16 v[108:111], v[16:19], v[252:255], v[108:111]
  s_waitcnt lgkmcnt(1)
  v_mfma_f32_16x16x32_bf16 v[120:123], v[20:23], v[248:251], v[120:123]
  v_mfma_f32_16x16x32_bf16 v[124:127], v[20:23], v[252:255], v[124:127]
  v_mfma_f32_16x16x32_bf16 v[40:43], v[24:27], v[248:251], v[40:43]
  v_mfma_f32_16x16x32_bf16 v[44:47], v[24:27], v[252:255], v[44:47]
  v_mov_b32 v132, s55
  v_mov_b32_e64 v133, s55
  ds_read_b32 v2, v6 offset:48
  ds_read2_b32 v[134:135], v3 offset0:0 offset1:16
  v_pk_mul_f32 v[88:89], v[80:81], v[88:89]
  v_pk_mul_f32 v[90:91], v[82:83], v[90:91]
  v_pk_mul_f32 v[92:93], v[84:85], v[92:93]
  v_pk_mul_f32 v[94:95], v[86:87], v[94:95]
  v_pk_mul_f32 v[80:81], v[80:81], v[132:133]
  v_pk_mul_f32 v[82:83], v[82:83], v[132:133]
  v_pk_mul_f32 v[84:85], v[84:85], v[132:133]
  v_pk_mul_f32 v[86:87], v[86:87], v[132:133]
  v_exp_f32 v80, v80
  v_exp_f32 v81, v81
  v_exp_f32 v82, v82
  v_exp_f32 v83, v83
  v_exp_f32 v84, v84
  v_exp_f32 v85, v85
  v_exp_f32 v86, v86
  v_exp_f32 v87, v87
  s_waitcnt lgkmcnt(0)
  v_cmp_ne_u32 vcc, 4, v2
  s_cbranch_vccnz G_WGL
G_RGL:
  v_exp_f32 v134, v134
  v_exp_f32 v135, v135
  v_add_f32 v134, 1.0, v134
  v_add_f32_e64 v135, 1.0, v135
  v_min_f32 v128, 0x7e967699, v134
  v_min_f32 v129, 0x7e967699, v134
  v_min_f32 v130, 0x7e967699, v135
  v_min_f32 v131, 0x7e967699, v135
  v_pk_fma_f32 v[80:81], v[80:81], v[128:129], v[128:129]
  v_pk_fma_f32 v[82:83], v[82:83], v[128:129], v[128:129]
  v_pk_fma_f32 v[84:85], v[84:85], v[130:131], v[130:131]
  v_pk_fma_f32 v[86:87], v[86:87], v[130:131], v[130:131]
  v_rcp_f32 v80, v80
  v_rcp_f32 v81, v81
  v_rcp_f32 v82, v82
  v_rcp_f32 v83, v83
  v_rcp_f32 v84, v84
  v_rcp_f32 v85, v85
  v_rcp_f32 v86, v86
  v_rcp_f32 v87, v87
  v_pk_mul_f32 v[104:105], v[96:97], v[104:105]
  v_pk_mul_f32 v[106:107], v[98:99], v[106:107]
  v_pk_mul_f32 v[108:109], v[100:101], v[108:109]
  v_pk_mul_f32 v[110:111], v[102:103], v[110:111]
  v_pk_mul_f32 v[96:97], v[96:97], v[132:133]
  v_pk_mul_f32 v[98:99], v[98:99], v[132:133]
  v_pk_mul_f32 v[100:101], v[100:101], v[132:133]
  v_pk_mul_f32 v[102:103], v[102:103], v[132:133]
  v_exp_f32 v96, v96
  v_exp_f32 v97, v97
  v_exp_f32 v98, v98
  v_exp_f32 v99, v99
  v_exp_f32 v100, v100
  v_exp_f32 v101, v101
  v_exp_f32 v102, v102
  v_exp_f32 v103, v103
  v_pk_fma_f32 v[96:97], v[96:97], v[128:129], v[128:129]
  v_pk_fma_f32 v[98:99], v[98:99], v[128:129], v[128:129]
  v_pk_fma_f32 v[100:101], v[100:101], v[130:131], v[130:131]
  v_pk_fma_f32 v[102:103], v[102:103], v[130:131], v[130:131]
  v_rcp_f32 v96, v96
  v_rcp_f32 v97, v97
  v_rcp_f32 v98, v98
  v_rcp_f32 v99, v99
  v_rcp_f32 v100, v100
  v_rcp_f32 v101, v101
  v_rcp_f32 v102, v102
  v_rcp_f32 v103, v103
  v_pk_mul_f32 v[80:81], v[80:81], v[88:89]
  v_pk_mul_f32 v[82:83], v[82:83], v[90:91]
  v_pk_mul_f32 v[84:85], v[84:85], v[92:93]
  v_pk_mul_f32 v[86:87], v[86:87], v[94:95]
  v_cvt_pk_bf16_f32 v88, v80, v81
  v_cvt_pk_bf16_f32 v90, v84, v85
  v_cvt_pk_bf16_f32 v89, v82, v83
  v_cvt_pk_bf16_f32 v91, v86, v87
  v_permlane16_swap_b32 v88, v90
  s_nop 0
  v_permlane16_swap_b32 v89, v91
  buffer_store_dwordx4 v[88:91], v0, s[4:7], s56 offen offset:0 sc1
  v_pk_mul_f32 v[120:121], v[112:113], v[120:121]
  v_pk_mul_f32 v[122:123], v[114:115], v[122:123]
  v_pk_mul_f32 v[124:125], v[116:117], v[124:125]
  v_pk_mul_f32 v[126:127], v[118:119], v[126:127]
  v_pk_mul_f32 v[112:113], v[112:113], v[132:133]
  v_pk_mul_f32 v[114:115], v[114:115], v[132:133]
  v_pk_mul_f32 v[116:117], v[116:117], v[132:133]
  v_pk_mul_f32 v[118:119], v[118:119], v[132:133]
  v_exp_f32 v112, v112
  v_exp_f32 v113, v113
  v_exp_f32 v114, v114
  v_exp_f32 v115, v115
  v_exp_f32 v116, v116
  v_exp_f32 v117, v117
  v_exp_f32 v118, v118
  v_exp_f32_e64 v119, v119
  v_pk_fma_f32 v[112:113], v[112:113], v[128:129], v[128:129]
  v_pk_fma_f32 v[114:115], v[114:115], v[128:129], v[128:129]
  v_pk_fma_f32 v[116:117], v[116:117], v[130:131], v[130:131]
  v_pk_fma_f32 v[118:119], v[118:119], v[130:131], v[130:131]
  v_rcp_f32 v112, v112
  v_rcp_f32 v113, v113
  v_rcp_f32 v114, v114
  v_rcp_f32 v115, v115
  v_rcp_f32 v116, v116
  v_rcp_f32 v117, v117
  v_rcp_f32 v118, v118
  v_rcp_f32 v119, v119
  v_pk_mul_f32 v[96:97], v[96:97], v[104:105]
  v_pk_mul_f32 v[98:99], v[98:99], v[106:107]
  v_pk_mul_f32 v[100:101], v[100:101], v[108:109]
  v_pk_mul_f32 v[102:103], v[102:103], v[110:111]
  v_cvt_pk_bf16_f32 v104, v96, v97
  v_cvt_pk_bf16_f32 v106, v100, v101
  v_cvt_pk_bf16_f32 v105, v98, v99
  v_cvt_pk_bf16_f32 v107, v102, v103
  v_permlane16_swap_b32 v104, v106
  s_nop 0
  v_permlane16_swap_b32 v105, v107
  buffer_store_dwordx4 v[104:107], v0, s[4:7], s56 offen offset:1024 sc1
  v_pk_mul_f32 v[40:41], v[32:33], v[40:41]
  v_pk_mul_f32 v[42:43], v[34:35], v[42:43]
  v_pk_mul_f32 v[44:45], v[36:37], v[44:45]
  v_pk_mul_f32 v[46:47], v[38:39], v[46:47]
  v_pk_mul_f32 v[32:33], v[32:33], v[132:133]
  v_pk_mul_f32 v[34:35], v[34:35], v[132:133]
  v_pk_mul_f32 v[36:37], v[36:37], v[132:133]
  v_pk_mul_f32 v[38:39], v[38:39], v[132:133]
  v_exp_f32 v32, v32
  v_exp_f32 v33, v33
  v_exp_f32 v34, v34
  v_exp_f32 v35, v35
  v_exp_f32 v36, v36
  v_exp_f32 v37, v37
  v_exp_f32 v38, v38
  v_exp_f32_e64 v39, v39
  v_pk_mul_f32 v[112:113], v[112:113], v[120:121]
  v_pk_mul_f32 v[114:115], v[114:115], v[122:123]
  v_pk_mul_f32 v[116:117], v[116:117], v[124:125]
  v_pk_mul_f32 v[118:119], v[118:119], v[126:127]
  v_cvt_pk_bf16_f32 v120, v112, v113
  v_cvt_pk_bf16_f32 v122, v116, v117
  v_cvt_pk_bf16_f32 v121, v114, v115
  v_cvt_pk_bf16_f32 v123, v118, v119
  v_permlane16_swap_b32 v120, v122
  s_nop 0
  v_permlane16_swap_b32 v121, v123
  buffer_store_dwordx4 v[120:123], v0, s[4:7], s56 offen offset:2048 sc1
  v_pk_fma_f32 v[32:33], v[32:33], v[128:129], v[128:129]
  v_pk_fma_f32 v[34:35], v[34:35], v[128:129], v[128:129]
  v_pk_fma_f32 v[36:37], v[36:37], v[130:131], v[130:131]
  v_pk_fma_f32 v[38:39], v[38:39], v[130:131], v[130:131]
  v_rcp_f32 v32, v32
  v_rcp_f32 v33, v33
  v_rcp_f32 v34, v34
  v_rcp_f32 v35, v35
  v_rcp_f32 v36, v36
  v_rcp_f32 v37, v37
  v_rcp_f32 v38, v38
  v_rcp_f32_e64 v39, v39
  v_pk_mul_f32 v[32:33], v[32:33], v[40:41]
  v_pk_mul_f32 v[34:35], v[34:35], v[42:43]
  v_pk_mul_f32 v[36:37], v[36:37], v[44:45]
  v_pk_mul_f32 v[38:39], v[38:39], v[46:47]
  v_cvt_pk_bf16_f32 v40, v32, v33
  v_cvt_pk_bf16_f32 v42, v36, v37
  v_cvt_pk_bf16_f32 v41, v34, v35
  v_cvt_pk_bf16_f32 v43, v38, v39
  v_permlane16_swap_b32 v40, v42
  s_nop 0
  v_permlane16_swap_b32 v41, v43
  buffer_store_dwordx4 v[40:43], v0, s[4:7], s56 offen offset:3072 sc1
  s_branch G_PT
G_W14:
  s_mov_b32 s52, 3200000
LP28:
  ds_read_b32 v2, v6 offset:4
  s_waitcnt lgkmcnt(0)
  v_cmp_ne_u32 vcc, 4, v2
  s_cbranch_vccz LP28_D
  s_sleep 1
  s_sub_u32 s52, s52, 1
  s_cmp_lg_u32 s52, 0
  s_cbranch_scc1 LP28
LP28_D:
  s_branch G_R14
G_W15:
  s_mov_b32 s52, 3200000
LP29:
  ds_read_b32 v2, v6 offset:36
  s_waitcnt lgkmcnt(0)
  v_cmp_ne_u32 vcc, 4, v2
  s_cbranch_vccz LP29_D
  s_sleep 1
  s_sub_u32 s52, s52, 1
  s_cmp_lg_u32 s52, 0
  s_cbranch_scc1 LP29
LP29_D:
  s_branch G_R15
G_WG:
  s_mov_b32 s52, 3200000
LP30:
  ds_read_b32 v2, v6 offset:48
  s_waitcnt lgkmcnt(0)
  v_cmp_ne_u32 vcc, 4, v2
  s_cbranch_vccz LP30_D
  s_sleep 1
  s_sub_u32 s52, s52, 1
  s_cmp_lg_u32 s52, 0
  s_cbranch_scc1 LP30
LP30_D:
  ds_read_b32 v2, v6 offset:48
  ds_read2_b32 v[134:135], v3 offset0:0 offset1:16
  s_waitcnt lgkmcnt(0)
  s_branch G_RG
G_RT22:
  s_mov_b32 s59, 200000
G_RL22:
  s_sleep 1
  s_add_u32 s51, s101, 0
  s_and_b32 s51, s51, 458752
  s_lshl_b32 s51, s51, 2
  buffer_load_dwordx4 v[112:115], v160, s[4:7], s51 offen offset:0 sc1
  s_add_u32 s51, s101, 65536
  s_and_b32 s51, s51, 458752
  s_lshl_b32 s51, s51, 2
  buffer_load_dwordx4 v[116:119], v160, s[4:7], s51 offen offset:0 sc1
  s_waitcnt vmcnt(0)
  v_or_b32 v162, v112, v116
  v_and_b32 v162, 1, v162
  v_cmp_eq_u32 vcc, 1, v162
  s_cbranch_vccz G_OK22
  s_sub_u32 s59, s59, 1
  s_cmp_lg_u32 s59, 0
  s_cbranch_scc1 G_RL22
  s_branch G_OK22
G_RT23:
  s_mov_b32 s59, 200000
G_RL23:
  s_sleep 1
  s_add_u32 s51, s101, 131072
  s_and_b32 s51, s51, 458752
  s_lshl_b32 s51, s51, 2
  buffer_load_dwordx4 v[120:123], v160, s[4:7], s51 offen offset:0 sc1
  s_add_u32 s51, s101, 196608
  s_and_b32 s51, s51, 458752
  s_lshl_b32 s51, s51, 2
  buffer_load_dwordx4 v[124:127], v160, s[4:7], s51 offen offset:0 sc1
  s_waitcnt vmcnt(0)
  v_or_b32 v162, v120, v124
  v_and_b32 v162, 1, v162
  v_cmp_eq_u32 vcc, 1, v162
  s_cbranch_vccz G_OK23
  s_sub_u32 s59, s59, 1
  s_cmp_lg_u32 s59, 0
  s_cbranch_scc1 G_RL23
  s_branch G_OK23
G_RT24:
  s_mov_b32 s59, 200000
G_RL24:
  s_sleep 1
  s_add_u32 s51, s101, 262144
  s_and_b32 s51, s51, 458752
  s_lshl_b32 s51, s51, 2
  buffer_load_dwordx4 v[128:131], v160, s[4:7], s51 offen offset:0 sc1
  s_add_u32 s51, s101, 327680
  s_and_b32 s51, s51, 458752
  s_lshl_b32 s51, s51, 2
  buffer_load_dwordx4 v[132:135], v160, s[4:7], s51 offen offset:0 sc1
  s_waitcnt vmcnt(0)
  v_or_b32 v162, v128, v132
  v_and_b32 v162, 1, v162
  v_cmp_eq_u32 vcc, 1, v162
  s_cbranch_vccz G_OK24
  s_sub_u32 s59, s59, 1
  s_cmp_lg_u32 s59, 0
  s_cbranch_scc1 G_RL24
  s_branch G_OK24
G_RT25:
  s_mov_b32 s59, 200000
G_RL25:
  s_sleep 1
  s_add_u32 s51, s101, 393216
  s_and_b32 s51, s51, 458752
  s_lshl_b32 s51, s51, 2
  buffer_load_dwordx4 v[96:99], v160, s[4:7], s51 offen offset:0 sc1
  s_add_u32 s51, s101, 458752
  s_and_b32 s51, s51, 458752
  s_lshl_b32 s51, s51, 2
  buffer_load_dwordx4 v[100:103], v160, s[4:7], s51 offen offset:0 sc1
  s_waitcnt vmcnt(0)
  v_or_b32 v162, v96, v100
  v_and_b32 v162, 1, v162
  v_cmp_eq_u32 vcc, 1, v162
  s_cbranch_vccz G_OK25
  s_sub_u32 s59, s59, 1
  s_cmp_lg_u32 s59, 0
  s_cbranch_scc1 G_RL25
  s_branch G_OK25
G_RT26:
  s_mov_b32 s59, 200000
G_RL26:
  s_sleep 1
  s_add_u32 s51, s101, 0
  s_and_b32 s51, s51, 458752
  s_lshl_b32 s51, s51, 2
  buffer_load_dwordx4 v[104:107], v160, s[4:7], s51 offen offset:1024 sc1
  s_add_u32 s51, s101, 65536
  s_and_b32 s51, s51, 458752
  s_lshl_b32 s51, s51, 2
  buffer_load_dwordx4 v[108:111], v160, s[4:7], s51 offen offset:1024 sc1
  s_waitcnt vmcnt(0)
  v_or_b32 v162, v104, v108
  v_and_b32_e64 v162, 1, v162
  v_cmp_eq_u32 vcc, 1, v162
  s_cbranch_vccz G_OK26
  s_sub_u32 s59, s59, 1
  s_cmp_lg_u32 s59, 0
  s_cbranch_scc1 G_RL26
  s_branch G_OK26
G_RT27:
  s_mov_b32 s59, 200000
G_RL27:
  s_sleep 1
  s_add_u32 s51, s101, 131072
  s_and_b32 s51, s51, 458752
  s_lshl_b32 s51, s51, 2
  buffer_load_dwordx4 v[112:115], v160, s[4:7], s51 offen offset:1024 sc1
  s_add_u32 s51, s101, 196608
  s_and_b32 s51, s51, 458752
  s_lshl_b32 s51, s51, 2
  buffer_load_dwordx4 v[116:119], v160, s[4:7], s51 offen offset:1024 sc1
  s_waitcnt vmcnt(0)
  v_or_b32 v162, v112, v116
  v_and_b32 v162, 1, v162
  v_cmp_eq_u32 vcc, 1, v162
  s_cbranch_vccz G_OK27
  s_sub_u32 s59, s59, 1
  s_cmp_lg_u32 s59, 0
  s_cbranch_scc1 G_RL27
  s_branch G_OK27
G_RT28:
  s_mov_b32 s59, 200000
G_RL28:
  s_sleep 1
  s_add_u32 s51, s101, 262144
  s_and_b32 s51, s51, 458752
  s_lshl_b32 s51, s51, 2
  buffer_load_dwordx4 v[120:123], v160, s[4:7], s51 offen offset:1024 sc1
  s_add_u32 s51, s101, 327680
  s_and_b32 s51, s51, 458752
  s_lshl_b32 s51, s51, 2
  buffer_load_dwordx4 v[124:127], v160, s[4:7], s51 offen offset:1024 sc1
  s_waitcnt vmcnt(0)
  v_or_b32 v162, v120, v124
  v_and_b32 v162, 1, v162
  v_cmp_eq_u32 vcc, 1, v162
  s_cbranch_vccz G_OK28
  s_sub_u32 s59, s59, 1
  s_cmp_lg_u32 s59, 0
  s_cbranch_scc1 G_RL28
  s_branch G_OK28
G_RT29:
  s_mov_b32 s59, 200000
G_RL29:
  s_sleep 1
  s_add_u32 s51, s101, 393216
  s_and_b32 s51, s51, 458752
  s_lshl_b32 s51, s51, 2
  buffer_load_dwordx4 v[128:131], v160, s[4:7], s51 offen offset:1024 sc1
  s_add_u32 s51, s101, 458752
  s_and_b32 s51, s51, 458752
  s_lshl_b32 s51, s51, 2
  buffer_load_dwordx4 v[132:135], v160, s[4:7], s51 offen offset:1024 sc1
  s_waitcnt vmcnt(0)
  v_or_b32 v162, v128, v132
  v_and_b32 v162, 1, v162
  v_cmp_eq_u32 vcc, 1, v162
  s_cbranch_vccz G_OK29
  s_sub_u32 s59, s59, 1
  s_cmp_lg_u32 s59, 0
  s_cbranch_scc1 G_RL29
  s_branch G_OK29
G_W14L:
  s_mov_b32 s52, 3200000
LP31:
  ds_read_b32 v2, v6 offset:4
  s_waitcnt lgkmcnt(0)
  v_cmp_ne_u32 vcc, 4, v2
  s_cbranch_vccz LP31_D
  s_sleep 1
  s_sub_u32 s52, s52, 1
  s_cmp_lg_u32 s52, 0
  s_cbranch_scc1 LP31
LP31_D:
  s_branch G_R14L
G_W15L:
  s_mov_b32 s52, 3200000
LP32:
  ds_read_b32 v2, v6 offset:36
  s_waitcnt lgkmcnt(0)
  v_cmp_ne_u32 vcc, 4, v2
  s_cbranch_vccz LP32_D
  s_sleep 1
  s_sub_u32 s52, s52, 1
  s_cmp_lg_u32 s52, 0
  s_cbranch_scc1 LP32
LP32_D:
  s_branch G_R15L
G_WGL:
  s_mov_b32 s52, 3200000
LP33:
  ds_read_b32 v2, v6 offset:48
  s_waitcnt lgkmcnt(0)
  v_cmp_ne_u32 vcc, 4, v2
  s_cbranch_vccz LP33_D
  s_sleep 1
  s_sub_u32 s52, s52, 1
  s_cmp_lg_u32 s52, 0
  s_cbranch_scc1 LP33
LP33_D:
  ds_read_b32 v2, v6 offset:48
  ds_read2_b32 v[134:135], v3 offset0:0 offset1:16
  s_waitcnt lgkmcnt(0)
  s_branch G_RGL
  s_endpgm
.fill 8192, 4, 0xBF800000
.section .rodata,"a"
.p2align 6
.amdhsa_kernel gated_mix__sliding_block__swiglu_ffn__prompt_kernel
  .amdhsa_next_free_vgpr 256
  .amdhsa_next_free_sgpr 102
  .amdhsa_accum_offset 256
  .amdhsa_group_segment_fixed_size 0
  .amdhsa_kernarg_size 88
  .amdhsa_user_sgpr_count 2
  .amdhsa_user_sgpr_kernarg_segment_ptr 1
  .amdhsa_system_sgpr_workgroup_id_x 1
.end_amdhsa_kernel
```
